```python
import torch

def _softmax(x, axis=-1):
    return torch.softmax(x, dim=axis)
def _gelu(x):
    return torch.nn.functional.gelu(x, approximate="tanh")
def _silu(x):
    return torch.nn.functional.silu(x)
def _sigmoid(x):
    return torch.sigmoid(x)
def _layernorm(x, axis=-1, eps=1e-5):
    m = x.mean(dim=axis, keepdim=True)
    v = x.var(dim=axis, keepdim=True, unbiased=False)
    return (x - m) / torch.sqrt(v + eps)
def _scatter_add(tgt, idx, src, axis=0):
    return tgt.clone().index_add_(axis, idx, src)
def _segment_sum(src, seg, n):
    out = torch.zeros((n,) + src.shape[1:], dtype=src.dtype)
    return out.index_add_(0, seg, src)
def _pad(x, pw):
    flat = tuple(v for pair in reversed(pw) for v in pair)
    return torch.nn.functional.pad(x, flat)

kernel_name = 'concat_heads__gqa_block_cached__gqa_block_cached__near_ridge'

def setup_inputs():

    _w = (lambda a: (lambda t: t.to(torch.bfloat16) if t.is_floating_point() else t)(torch.as_tensor(a)))
    def _A_setup():
        B, Sq, D = 8, 64, 448
        Hq, Hkv, Sk, Dh = 16, 8, 1024, 256
        assert Hq % Hkv == 0, (Hq, Hkv)
        return {
            "x": _w((lambda *s: torch.randn(*s, dtype=torch.bfloat16) * 0.8)(B, Sq, D)),
            "k_cache": _w((lambda *s: torch.randn(*s, dtype=torch.bfloat16) * 0.8)(B, Hkv, Sk, Dh)),
            "v_cache": _w((lambda *s: torch.randn(*s, dtype=torch.bfloat16) * 0.05)(B, Hkv, Sk, Dh)),
            "wq": _w((lambda *s: torch.randn(*s, dtype=torch.bfloat16) * 0.8)(D, Hq * Dh) * (D ** -0.5)),
            "wo": _w((lambda *s: torch.randn(*s, dtype=torch.bfloat16) * 0.05)(Hq * Dh, D) * ((Hq * Dh) ** -0.5)),
        }
    _A_in = _A_setup()

    def _B_setup():
        B, Sq, D = 8, 64, 448
        Hq, Hkv, Sk, Dh = 16, 8, 1024, 256
        assert Hq % Hkv == 0, (Hq, Hkv)
        return {
            "x": _w((lambda *s: torch.randn(*s, dtype=torch.bfloat16) * 0.8)(B, Sq, D)),
            "k_cache": _w((lambda *s: torch.randn(*s, dtype=torch.bfloat16) * 0.8)(B, Hkv, Sk, Dh)),
            "v_cache": _w((lambda *s: torch.randn(*s, dtype=torch.bfloat16) * 0.05)(B, Hkv, Sk, Dh)),
            "wq": _w((lambda *s: torch.randn(*s, dtype=torch.bfloat16) * 0.8)(D, Hq * Dh) * (D ** -0.5)),
            "wo": _w((lambda *s: torch.randn(*s, dtype=torch.bfloat16) * 0.05)(Hq * Dh, D) * ((Hq * Dh) ** -0.5)),
        }
    _B_in = _B_setup()

    return {
        "A_x": _A_in["x"],
        "A_k_cache": _A_in["k_cache"],
        "A_v_cache": _A_in["v_cache"],
        "A_wq": _A_in["wq"],
        "A_wo": _A_in["wo"],
        "B_x": _B_in["x"],
        "B_k_cache": _B_in["k_cache"],
        "B_v_cache": _B_in["v_cache"],
        "B_wq": _B_in["wq"],
        "B_wo": _B_in["wo"],
    }

def reference(A_x, A_k_cache, A_v_cache, A_wq, A_wo, B_x, B_k_cache, B_v_cache, B_wq, B_wo):
    def _A_ref(x, k_cache, v_cache, wq, wo):
        B, Sq, D = x.shape
        Hq, Dh = 16, 256
        Hkv = k_cache.shape[1]
        rep = Hq // Hkv
        q = (lambda x, *d: x.permute(*d))((x @ wq).reshape(B, Sq, Hq, Dh), 0, 2, 1, 3)
        k = (lambda x, n, axis: torch.repeat_interleave(x, n, dim=axis))(k_cache, rep, axis=1)
        v = (lambda x, n, axis: torch.repeat_interleave(x, n, dim=axis))(v_cache, rep, axis=1)
        scores = torch.einsum("bhqd,bhkd->bhqk", q, k) * (Dh ** -0.5)
        p = _softmax(scores, axis=-1)
        o = torch.einsum("bhqk,bhkd->bhqd", p, v)
        return (lambda x, *d: x.permute(*d))(o, 0, 2, 1, 3).reshape(B, Sq, Hq * Dh) @ wo

    def _B_ref(x, k_cache, v_cache, wq, wo):
        B, Sq, D = x.shape
        Hq, Dh = 16, 256
        Hkv = k_cache.shape[1]
        rep = Hq // Hkv
        q = (lambda x, *d: x.permute(*d))((x @ wq).reshape(B, Sq, Hq, Dh), 0, 2, 1, 3)
        k = (lambda x, n, axis: torch.repeat_interleave(x, n, dim=axis))(k_cache, rep, axis=1)
        v = (lambda x, n, axis: torch.repeat_interleave(x, n, dim=axis))(v_cache, rep, axis=1)
        scores = torch.einsum("bhqd,bhkd->bhqk", q, k) * (Dh ** -0.5)
        p = _softmax(scores, axis=-1)
        o = torch.einsum("bhqk,bhkd->bhqd", p, v)
        return (lambda x, *d: x.permute(*d))(o, 0, 2, 1, 3).reshape(B, Sq, Hq * Dh) @ wo

    a = _A_ref(A_x, A_k_cache, A_v_cache, A_wq, A_wo)
    b = _B_ref(B_x, B_k_cache, B_v_cache, B_wq, B_wo)
    return torch.concatenate([a, b], axis=-1)
```

```asm
; @launch grid=(256,1,1) block=(512,1,1) lds=163840
.amdgcn_target "amdgcn-amd-amdhsa--gfx950"
.text
.globl concat_heads__gqa_block_cached__gqa_block_cached__near_ridge_kernel
.p2align 8
.type concat_heads__gqa_block_cached__gqa_block_cached__near_ridge_kernel,@function
concat_heads__gqa_block_cached__gqa_block_cached__near_ridge_kernel:
    s_cmp_ge_u32 s2, 256
    s_cbranch_scc1 L_END
    s_load_dwordx16 s[4:19], s[0:1], 0
    s_load_dwordx8 s[20:27], s[0:1], 64
    s_load_dwordx2 s[28:29], s[0:1], 96
    v_lshrrev_b32 v27, 6, v0
    v_and_b32 v0, 63, v0
    v_readfirstlane_b32 s64, v27
    s_and_b32 s70, s2, 7
    s_lshr_b32 s71, s2, 3
    s_lshr_b32 s74, s70, 2
    s_and_b32 s70, s70, 3
    s_lshl_b32 s70, s70, 1
    s_lshr_b32 s83, s71, 4
    s_add_u32 s75, s70, s83
    s_bfe_u32 s76, s71, 196609
    s_and_b32 s77, s71, 1
    s_lshl_b32 s85, s71, 3
    s_lshl_b32 s79, s74, 3
    s_add_u32 s79, s79, s76
    s_lshl_b32 s80, s75, 1
    s_add_u32 s80, s80, s77
    s_and_b32 s81, s64, 1
    s_bfe_u32 s82, s64, 65537
    s_lshr_b32 s67, s64, 2
    s_and_b32 s78, s64, 3
    s_mul_i32 s65, s78, 1088
    s_mul_i32 s66, s78, 1040
    s_mov_b32 s68, 1035512379
    s_mul_i32 s70, s76, 7
    s_lshr_b32 s70, s70, 3
    s_lshl_b32 s30, s70, 19
    v_lshlrev_b32 v18, 4, v0
    s_lshl_b32 s70, s70, 3
    v_add_u32 v26, s70, v0
    v_subrev_u32 v27, 56, v26
    v_cmp_gt_u32 vcc, 56, v26
    s_nop 1
    v_cndmask_b32 v26, v27, v26, vcc
    s_mul_i32 s70, s64, 896
    v_lshl_add_u32 v13, v26, 4, s70
    v_mov_b32 v26, 1073741824
    v_cmp_gt_u32 vcc, 56, v0
    s_nop 1
    v_cndmask_b32 v13, v26, v13, vcc
    v_lshrrev_b32 v27, 5, v0
    v_and_b32 v26, 15, v0
    v_lshlrev_b32 v26, 4, v26
    v_lshrrev_b32 v28, 4, v0
    v_lshl_add_u32 v29, v28, 17, v26
    s_lshl_b32 s70, s78, 13
    s_lshl_b32 s71, s67, 8
    s_add_u32 s70, s70, s71
    v_add_u32 v2, s70, v29
    v_lshl_add_u32 v29, v28, 11, v26
    s_lshl_b32 s70, s78, 9
    s_xor_b32 s71, s67, s74
    s_lshl_b32 s71, s71, 15
    s_add_u32 s70, s70, s71
    v_add_u32 v4, s70, v29
    v_and_b32 v26, 31, v0
    v_lshlrev_b32 v26, 4, v26
    v_lshl_add_u32 v26, v27, 13, v26
    v_add_u32 v3, s70, v26
    s_mul_i32 s84, s64, 1040
    s_waitcnt lgkmcnt(0)
    s_add_u32 s71, s85, s64
    s_lshl_b32 s71, s71, 6
    s_getpc_b64 s[72:73]
L_PC:
    s_add_u32 s72, s72, s71
    s_addc_u32 s73, s73, 0
    s_load_dword s31, s[72:73], 0
    s_load_dword s31, s[72:73], 16384
    s_load_dword s31, s[72:73], 32768
    s_cmp_eq_u32 s74, 0
    s_cselect_b64 s[4:5], s[4:5], s[14:15]
    s_cselect_b64 s[6:7], s[6:7], s[16:17]
    s_cselect_b64 s[8:9], s[8:9], s[18:19]
    s_cselect_b64 s[10:11], s[10:11], s[20:21]
    s_cselect_b64 s[12:13], s[12:13], s[22:23]
    s_mul_i32 s70, s76, 57344
    s_add_u32 s32, s4, s70
    s_addc_u32 s33, s5, 0
    s_mov_b32 s34, 57344
    s_mov_b32 s35, 131072
    s_add_u32 m0, s84, 0
    s_mov_b32 s69, 0
    buffer_load_dwordx4 v13, s[32:35], s69 offen lds
    s_add_u32 m0, s84, 8320
    s_mov_b32 s69, 7168
    buffer_load_dwordx4 v13, s[32:35], s69 offen lds
    s_add_u32 m0, s84, 17408
    s_mov_b32 s69, 14336
    buffer_load_dwordx4 v13, s[32:35], s69 offen lds
    s_add_u32 m0, s84, 25728
    s_mov_b32 s69, 21504
    buffer_load_dwordx4 v13, s[32:35], s69 offen lds
    s_add_u32 m0, s84, 34816
    s_mov_b32 s69, 28672
    buffer_load_dwordx4 v13, s[32:35], s69 offen lds
    s_add_u32 m0, s84, 43136
    s_mov_b32 s69, 35840
    buffer_load_dwordx4 v13, s[32:35], s69 offen lds
    s_add_u32 m0, s84, 52224
    s_mov_b32 s69, 43008
    buffer_load_dwordx4 v13, s[32:35], s69 offen lds
    s_add_u32 m0, s84, 60544
    s_mov_b32 s69, 50176
    buffer_load_dwordx4 v13, s[32:35], s69 offen lds
    s_mov_b32 s52, s28
    s_mov_b32 s53, s29
    s_mov_b32 s54, 33554432
    s_mov_b32 s55, 131072
    s_lshl_b32 s70, s79, 7
    s_add_u32 s70, s70, 26214400
    v_mov_b32 v26, s70
    buffer_load_dwordx2 v[10:11], v26, s[52:55], 0 offen sc1
    s_lshl_b32 s70, s80, 9
    s_add_u32 s44, s10, s70
    s_addc_u32 s45, s11, 0
    s_mov_b32 s46, 3662336
    s_mov_b32 s47, 131072
    s_cmp_eq_u32 s67, 1
    s_cbranch_scc1 L_INIT_1
    s_add_u32 m0, s65, 87040
    s_add_u32 s69, s30, 0
    buffer_load_dwordx4 v2, s[44:47], s69 offen lds
    s_add_u32 m0, s65, 91392
    s_add_u32 s69, s30, 32768
    buffer_load_dwordx4 v2, s[44:47], s69 offen lds
    s_add_u32 m0, s65, 95744
    s_add_u32 s69, s30, 65536
    buffer_load_dwordx4 v2, s[44:47], s69 offen lds
    s_add_u32 m0, s65, 100096
    s_add_u32 s69, s30, 98304
    buffer_load_dwordx4 v2, s[44:47], s69 offen lds
    s_add_u32 s30, s30, 524288
    s_cmp_eq_u32 s30, 3670016
    s_cselect_b32 s30, 0, s30
    s_add_u32 m0, s65, 121856
    s_add_u32 s69, s30, 0
    buffer_load_dwordx4 v2, s[44:47], s69 offen lds
    s_add_u32 m0, s65, 126208
    s_add_u32 s69, s30, 32768
    buffer_load_dwordx4 v2, s[44:47], s69 offen lds
    s_add_u32 m0, s65, 130560
    s_add_u32 s69, s30, 65536
    buffer_load_dwordx4 v2, s[44:47], s69 offen lds
    s_add_u32 m0, s65, 134912
    s_add_u32 s69, s30, 98304
    buffer_load_dwordx4 v2, s[44:47], s69 offen lds
    s_add_u32 s30, s30, 524288
    s_cmp_eq_u32 s30, 3670016
    s_cselect_b32 s30, 0, s30
    s_branch L_COMMON2
L_INIT_1:
    s_add_u32 m0, s65, 69632
    s_add_u32 s69, s30, 0
    buffer_load_dwordx4 v2, s[44:47], s69 offen lds
    s_add_u32 m0, s65, 73984
    s_add_u32 s69, s30, 32768
    buffer_load_dwordx4 v2, s[44:47], s69 offen lds
    s_add_u32 m0, s65, 78336
    s_add_u32 s69, s30, 65536
    buffer_load_dwordx4 v2, s[44:47], s69 offen lds
    s_add_u32 m0, s65, 82688
    s_add_u32 s69, s30, 98304
    buffer_load_dwordx4 v2, s[44:47], s69 offen lds
    s_add_u32 s30, s30, 524288
    s_cmp_eq_u32 s30, 3670016
    s_cselect_b32 s30, 0, s30
    s_add_u32 m0, s65, 104448
    s_add_u32 s69, s30, 0
    buffer_load_dwordx4 v2, s[44:47], s69 offen lds
    s_add_u32 m0, s65, 108800
    s_add_u32 s69, s30, 32768
    buffer_load_dwordx4 v2, s[44:47], s69 offen lds
    s_add_u32 m0, s65, 113152
    s_add_u32 s69, s30, 65536
    buffer_load_dwordx4 v2, s[44:47], s69 offen lds
    s_add_u32 m0, s65, 117504
    s_add_u32 s69, s30, 98304
    buffer_load_dwordx4 v2, s[44:47], s69 offen lds
    s_add_u32 s30, s30, 524288
    s_cmp_eq_u32 s30, 3670016
    s_cselect_b32 s30, 0, s30
    s_add_u32 m0, s65, 139264
    s_add_u32 s69, s30, 0
    buffer_load_dwordx4 v2, s[44:47], s69 offen lds
    s_add_u32 m0, s65, 143616
    s_add_u32 s69, s30, 32768
    buffer_load_dwordx4 v2, s[44:47], s69 offen lds
    s_add_u32 m0, s65, 147968
    s_add_u32 s69, s30, 65536
    buffer_load_dwordx4 v2, s[44:47], s69 offen lds
    s_add_u32 m0, s65, 152320
    s_add_u32 s69, s30, 98304
    buffer_load_dwordx4 v2, s[44:47], s69 offen lds
    s_add_u32 s30, s30, 524288
    s_cmp_eq_u32 s30, 3670016
    s_cselect_b32 s30, 0, s30
L_COMMON2:
    s_lshl_b32 s70, s76, 3
    s_add_u32 s70, s70, s75
    s_lshl_b32 s83, s70, 19
    s_add_u32 s36, s6, s83
    s_addc_u32 s37, s7, 0
    s_mov_b32 s38, 524288
    s_mov_b32 s39, 131072
    s_add_u32 s40, s8, s83
    s_addc_u32 s41, s9, 0
    s_mov_b32 s42, 524288
    s_mov_b32 s43, 131072
    s_mul_i32 s70, s80, 229376
    s_add_u32 s48, s12, s70
    s_addc_u32 s49, s13, 0
    s_mov_b32 s50, 229376
    s_mov_b32 s51, 131072
    s_mov_b32 s56, s24
    s_mov_b32 s57, s25
    s_mov_b32 s58, 917504
    s_mov_b32 s59, 131072
    s_and_b32 s70, s76, 1
    s_cmp_eq_u32 s70, 0
    s_mov_b32 s71, 1985229328
    s_cselect_b32 s71, 1985229328, s71
    s_cmp_eq_u32 s77, 0
    s_cselect_b32 s71, 1985229328, s71
    s_add_u32 s70, s76, s75
    s_bfe_u32 s22, s71, 196608
    s_add_u32 s22, s22, s70
    s_and_b32 s22, s22, 7
    s_lshl_b32 s22, s22, 16
    s_bfe_u32 s23, s71, 196612
    s_add_u32 s23, s23, s70
    s_and_b32 s23, s23, 7
    s_lshl_b32 s23, s23, 16
    s_bfe_u32 s24, s71, 196616
    s_add_u32 s24, s24, s70
    s_and_b32 s24, s24, 7
    s_lshl_b32 s24, s24, 16
    s_bfe_u32 s25, s71, 196620
    s_add_u32 s25, s25, s70
    s_and_b32 s25, s25, 7
    s_lshl_b32 s25, s25, 16
    s_bfe_u32 s26, s71, 196624
    s_add_u32 s26, s26, s70
    s_and_b32 s26, s26, 7
    s_lshl_b32 s26, s26, 16
    s_bfe_u32 s27, s71, 196628
    s_add_u32 s27, s27, s70
    s_and_b32 s27, s27, 7
    s_lshl_b32 s27, s27, 16
    s_bfe_u32 s28, s71, 196632
    s_add_u32 s28, s28, s70
    s_and_b32 s28, s28, 7
    s_lshl_b32 s28, s28, 16
    s_bfe_u32 s29, s71, 196636
    s_add_u32 s29, s29, s70
    s_and_b32 s29, s29, 7
    s_lshl_b32 s29, s29, 16
    s_lshl_b32 s70, s76, 3
    s_add_u32 s70, s70, s64
    s_mul_i32 s70, s70, 3584
    v_lshl_add_u32 v5, v0, 7, s70
    v_mov_b32 v6, 1073741824
    v_cmp_gt_u32 vcc, 28, v0
    s_nop 1
    v_cndmask_b32 v5, v6, v5, vcc
    s_mov_b32 m0, 158720
    s_nop 0
    buffer_load_dword v5, s[48:51], 0 offen lds
    v_bfe_u32 v26, v0, 2, 2
    v_and_b32 v27, 3, v0
    v_bfe_u32 v28, v0, 4, 1
    v_lshrrev_b32 v29, 5, v0
    v_lshrrev_b32 v5, 3, v0
    v_mul_u32_u24 v5, 3584, v5
    v_and_b32 v6, 7, v0
    v_lshl_add_u32 v5, v6, 4, v5
    s_mul_i32 s70, s78, 896
    v_add_u32 v1, s70, v5
    v_and_b32 v5, 1, v27
    v_lshlrev_b32 v5, 4, v5
    v_lshl_add_u32 v5, v28, 5, v5
    v_lshrrev_b32 v6, 1, v27
    v_lshl_add_u32 v5, v6, 3, v5
    v_lshl_add_u32 v6, v29, 3, v26
    v_mul_u32_u24 v6, 1088, v6
    s_lshl_b32 s70, s82, 7
    v_add3_u32 v14, v6, v5, s70
    v_mul_u32_u24 v6, 1088, v26
    v_lshl_add_u32 v15, v29, 7, v6
    s_lshl_b32 s71, s82, 6
    v_add3_u32 v15, v15, v5, s71
    v_lshl_add_u32 v6, v29, 8, v6
    v_lshl_add_u32 v6, v28, 5, v6
    v_lshl_add_u32 v6, v27, 3, v6
    v_add_u32 v16, s70, v6
    s_sub_u32 s70, 128, s70
    v_add_u32 v30, s70, v6
    v_and_b32 v5, 15, v0
    v_mul_u32_u24 v5, 1040, v5
    v_lshl_add_u32 v5, v29, 4, v5
    v_lshl_add_u32 v17, v28, 9, v5
    v_mul_u32_u24 v6, 17408, v28
    s_mul_i32 s70, s81, 34816
    v_add3_u32 v20, v6, v5, s70
    s_mul_i32 s70, s81, 6144
    s_add_u32 s70, s70, 104448
    v_add_u32 v19, s70, v18
    s_mul_i32 s70, s64, 6144
    s_add_u32 s70, s70, 104448
    v_add_u32 v31, s70, v18
    s_lshl_b32 s70, s79, 4
    s_add_u32 s70, s70, s80
    s_mul_i32 s70, s70, 57344
    s_lshl_b32 s71, s82, 12
    s_add_u32 s70, s70, s71
    s_lshl_b32 s71, s81, 11
    s_add_u32 s70, s70, s71
    v_add_u32 v21, s70, v18
    s_lshl_b32 s70, s74, 1
    s_or_b32 s70, s70, s67
    s_and_b32 s70, s70, 1
    s_cmp_eq_u32 s70, 1
    s_cbranch_scc1 L_MAIN_1
L_MAIN_0:
    s_nop 1
    s_waitcnt vmcnt(8)
    s_barrier
    s_setprio 0
    ds_read_b128 v[128:131], v20
    ds_read_b128 v[132:135], v20 offset:32
    ds_read_b128 v[136:139], v20 offset:64
    ds_read_b128 v[140:143], v20 offset:96
    ds_read_b128 v[144:147], v20 offset:128
    ds_read_b128 v[148:151], v20 offset:160
    ds_read_b128 v[152:155], v20 offset:192
    s_waitcnt vmcnt(4)
    s_barrier
    s_setprio 0
    v_add_u32 v22, 87040, v14
    ds_read_b64_tr_b16 v[96:97], v22
    ds_read_b64_tr_b16 v[98:99], v22 offset:4352
    ds_read_b64_tr_b16 v[100:101], v22 offset:64
    ds_read_b64_tr_b16 v[102:103], v22 offset:4416
    ds_read_b64_tr_b16 v[104:105], v22 offset:256
    ds_read_b64_tr_b16 v[106:107], v22 offset:4608
    ds_read_b64_tr_b16 v[108:109], v22 offset:320
    ds_read_b64_tr_b16 v[110:111], v22 offset:4672
    ds_read_b64_tr_b16 v[112:113], v22 offset:512
    ds_read_b64_tr_b16 v[114:115], v22 offset:4864
    ds_read_b64_tr_b16 v[116:117], v22 offset:576
    ds_read_b64_tr_b16 v[118:119], v22 offset:4928
    ds_read_b64_tr_b16 v[120:121], v22 offset:768
    ds_read_b64_tr_b16 v[122:123], v22 offset:5120
    ds_read_b64_tr_b16 v[124:125], v22 offset:832
    ds_read_b64_tr_b16 v[126:127], v22 offset:5184
    v_add_co_u32 v10, vcc, 1, v10
    s_nop 1
    v_addc_co_u32 v11, vcc, 0, v11, vcc
    s_add_u32 m0, s65, 69632
    s_add_u32 s69, s30, 0
    buffer_load_dwordx4 v2, s[44:47], s69 offen lds
    s_add_u32 m0, s65, 73984
    s_add_u32 s69, s30, 32768
    buffer_load_dwordx4 v2, s[44:47], s69 offen lds
    s_add_u32 m0, s65, 78336
    s_add_u32 s69, s30, 65536
    buffer_load_dwordx4 v2, s[44:47], s69 offen lds
    s_add_u32 m0, s65, 82688
    s_add_u32 s69, s30, 98304
    buffer_load_dwordx4 v2, s[44:47], s69 offen lds
    s_add_u32 s30, s30, 524288
    s_cmp_eq_u32 s30, 3670016
    s_cselect_b32 s30, 0, s30
    ds_read_b128 v[156:159], v20 offset:224
    ds_read_b128 v[160:163], v20 offset:256
    ds_read_b128 v[164:167], v20 offset:288
    ds_read_b128 v[168:171], v20 offset:320
    ds_read_b128 v[172:175], v20 offset:352
    ds_read_b128 v[176:179], v20 offset:384
    ds_read_b128 v[180:183], v20 offset:416
    s_waitcnt vmcnt(4) lgkmcnt(7)
    s_barrier
    s_setprio 1
    v_add_u32 v22, 121856, v14
    v_mfma_f32_32x32x16_bf16 v[32:47], v[96:99], v[128:131], 0
    ds_read_b64_tr_b16 v[96:97], v22
    ds_read_b64_tr_b16 v[98:99], v22 offset:4352
    v_mfma_f32_32x32x16_bf16 v[48:63], v[100:103], v[128:131], 0
    ds_read_b64_tr_b16 v[100:101], v22 offset:64
    ds_read_b64_tr_b16 v[102:103], v22 offset:4416
    v_mfma_f32_32x32x16_bf16 v[32:47], v[104:107], v[132:135], v[32:47]
    ds_read_b64_tr_b16 v[104:105], v22 offset:256
    ds_read_b64_tr_b16 v[106:107], v22 offset:4608
    v_mfma_f32_32x32x16_bf16 v[48:63], v[108:111], v[132:135], v[48:63]
    ds_read_b64_tr_b16 v[108:109], v22 offset:320
    ds_read_b64_tr_b16 v[110:111], v22 offset:4672
    v_mfma_f32_32x32x16_bf16 v[32:47], v[112:115], v[136:139], v[32:47]
    ds_read_b64_tr_b16 v[112:113], v22 offset:512
    ds_read_b64_tr_b16 v[114:115], v22 offset:4864
    v_mfma_f32_32x32x16_bf16 v[48:63], v[116:119], v[136:139], v[48:63]
    ds_read_b64_tr_b16 v[116:117], v22 offset:576
    ds_read_b64_tr_b16 v[118:119], v22 offset:4928
    v_mfma_f32_32x32x16_bf16 v[32:47], v[120:123], v[140:143], v[32:47]
    ds_read_b64_tr_b16 v[120:121], v22 offset:768
    ds_read_b64_tr_b16 v[122:123], v22 offset:5120
    v_mfma_f32_32x32x16_bf16 v[48:63], v[124:127], v[140:143], v[48:63]
    ds_read_b64_tr_b16 v[124:125], v22 offset:832
    ds_read_b64_tr_b16 v[126:127], v22 offset:5184
    s_barrier
    s_setprio 0
    s_add_u32 m0, s65, 104448
    s_add_u32 s69, s30, 0
    buffer_load_dwordx4 v2, s[44:47], s69 offen lds
    s_add_u32 m0, s65, 108800
    s_add_u32 s69, s30, 32768
    buffer_load_dwordx4 v2, s[44:47], s69 offen lds
    s_add_u32 m0, s65, 113152
    s_add_u32 s69, s30, 65536
    buffer_load_dwordx4 v2, s[44:47], s69 offen lds
    s_add_u32 m0, s65, 117504
    s_add_u32 s69, s30, 98304
    buffer_load_dwordx4 v2, s[44:47], s69 offen lds
    s_add_u32 s30, s30, 524288
    s_cmp_eq_u32 s30, 3670016
    s_cselect_b32 s30, 0, s30
    ds_read_b128 v[184:187], v20 offset:448
    ds_read_b128 v[188:191], v20 offset:480
    ds_read_b128 v[192:195], v20 offset:512
    ds_read_b128 v[196:199], v20 offset:544
    ds_read_b128 v[200:203], v20 offset:576
    ds_read_b128 v[204:207], v20 offset:608
    ds_read_b128 v[208:211], v20 offset:640
    s_waitcnt vmcnt(4) lgkmcnt(7)
    s_barrier
    s_setprio 1
    v_add_u32 v22, 69632, v14
    v_mfma_f32_32x32x16_bf16 v[32:47], v[96:99], v[144:147], v[32:47]
    ds_read_b64_tr_b16 v[96:97], v22
    ds_read_b64_tr_b16 v[98:99], v22 offset:4352
    v_mfma_f32_32x32x16_bf16 v[48:63], v[100:103], v[144:147], v[48:63]
    ds_read_b64_tr_b16 v[100:101], v22 offset:64
    ds_read_b64_tr_b16 v[102:103], v22 offset:4416
    v_mfma_f32_32x32x16_bf16 v[32:47], v[104:107], v[148:151], v[32:47]
    ds_read_b64_tr_b16 v[104:105], v22 offset:256
    ds_read_b64_tr_b16 v[106:107], v22 offset:4608
    v_mfma_f32_32x32x16_bf16 v[48:63], v[108:111], v[148:151], v[48:63]
    ds_read_b64_tr_b16 v[108:109], v22 offset:320
    ds_read_b64_tr_b16 v[110:111], v22 offset:4672
    v_mfma_f32_32x32x16_bf16 v[32:47], v[112:115], v[152:155], v[32:47]
    ds_read_b64_tr_b16 v[112:113], v22 offset:512
    ds_read_b64_tr_b16 v[114:115], v22 offset:4864
    v_mfma_f32_32x32x16_bf16 v[48:63], v[116:119], v[152:155], v[48:63]
    ds_read_b64_tr_b16 v[116:117], v22 offset:576
    ds_read_b64_tr_b16 v[118:119], v22 offset:4928
    v_mfma_f32_32x32x16_bf16 v[32:47], v[120:123], v[156:159], v[32:47]
    ds_read_b64_tr_b16 v[120:121], v22 offset:768
    ds_read_b64_tr_b16 v[122:123], v22 offset:5120
    v_mfma_f32_32x32x16_bf16 v[48:63], v[124:127], v[156:159], v[48:63]
    ds_read_b64_tr_b16 v[124:125], v22 offset:832
    ds_read_b64_tr_b16 v[126:127], v22 offset:5184
    s_barrier
    s_setprio 0
    s_add_u32 m0, s65, 139264
    s_add_u32 s69, s30, 0
    buffer_load_dwordx4 v2, s[44:47], s69 offen lds
    s_add_u32 m0, s65, 143616
    s_add_u32 s69, s30, 32768
    buffer_load_dwordx4 v2, s[44:47], s69 offen lds
    s_add_u32 m0, s65, 147968
    s_add_u32 s69, s30, 65536
    buffer_load_dwordx4 v2, s[44:47], s69 offen lds
    s_add_u32 m0, s65, 152320
    s_add_u32 s69, s30, 98304
    buffer_load_dwordx4 v2, s[44:47], s69 offen lds
    s_add_u32 s30, s30, 524288
    s_cmp_eq_u32 s30, 3670016
    s_cselect_b32 s30, 0, s30
    ds_read_b128 v[212:215], v20 offset:672
    ds_read_b128 v[216:219], v20 offset:704
    ds_read_b128 v[220:223], v20 offset:736
    ds_read_b128 v[224:227], v20 offset:768
    ds_read_b128 v[228:231], v20 offset:800
    ds_read_b128 v[232:235], v20 offset:832
    ds_read_b128 v[236:239], v20 offset:864
    s_waitcnt vmcnt(4) lgkmcnt(0)
    s_barrier
    s_setprio 1
    v_add_u32 v22, 104448, v14
    v_mfma_f32_32x32x16_bf16 v[32:47], v[96:99], v[160:163], v[32:47]
    ds_read_b64_tr_b16 v[96:97], v22
    ds_read_b64_tr_b16 v[98:99], v22 offset:4352
    v_mfma_f32_32x32x16_bf16 v[48:63], v[100:103], v[160:163], v[48:63]
    ds_read_b64_tr_b16 v[100:101], v22 offset:64
    ds_read_b64_tr_b16 v[102:103], v22 offset:4416
    v_mfma_f32_32x32x16_bf16 v[32:47], v[104:107], v[164:167], v[32:47]
    ds_read_b64_tr_b16 v[104:105], v22 offset:256
    ds_read_b64_tr_b16 v[106:107], v22 offset:4608
    v_mfma_f32_32x32x16_bf16 v[48:63], v[108:111], v[164:167], v[48:63]
    ds_read_b64_tr_b16 v[108:109], v22 offset:320
    ds_read_b64_tr_b16 v[110:111], v22 offset:4672
    v_mfma_f32_32x32x16_bf16 v[32:47], v[112:115], v[168:171], v[32:47]
    ds_read_b64_tr_b16 v[112:113], v22 offset:512
    ds_read_b64_tr_b16 v[114:115], v22 offset:4864
    v_mfma_f32_32x32x16_bf16 v[48:63], v[116:119], v[168:171], v[48:63]
    ds_read_b64_tr_b16 v[116:117], v22 offset:576
    ds_read_b64_tr_b16 v[118:119], v22 offset:4928
    v_mfma_f32_32x32x16_bf16 v[32:47], v[120:123], v[172:175], v[32:47]
    ds_read_b64_tr_b16 v[120:121], v22 offset:768
    ds_read_b64_tr_b16 v[122:123], v22 offset:5120
    v_mfma_f32_32x32x16_bf16 v[48:63], v[124:127], v[172:175], v[48:63]
    ds_read_b64_tr_b16 v[124:125], v22 offset:832
    ds_read_b64_tr_b16 v[126:127], v22 offset:5184
    s_barrier
    s_setprio 0
    s_add_u32 m0, s65, 0
    s_add_u32 s69, s30, 0
    buffer_load_dwordx4 v2, s[44:47], s69 offen lds
    s_add_u32 m0, s65, 4352
    s_add_u32 s69, s30, 32768
    buffer_load_dwordx4 v2, s[44:47], s69 offen lds
    s_add_u32 m0, s65, 8704
    s_add_u32 s69, s30, 65536
    buffer_load_dwordx4 v2, s[44:47], s69 offen lds
    s_add_u32 m0, s65, 13056
    s_add_u32 s69, s30, 98304
    buffer_load_dwordx4 v2, s[44:47], s69 offen lds
    s_add_u32 s30, s30, 524288
    s_cmp_eq_u32 s30, 3670016
    s_cselect_b32 s30, 0, s30
    s_add_u32 m0, s65, 17408
    s_add_u32 s69, s30, 0
    buffer_load_dwordx4 v2, s[44:47], s69 offen lds
    s_add_u32 m0, s65, 21760
    s_add_u32 s69, s30, 32768
    buffer_load_dwordx4 v2, s[44:47], s69 offen lds
    s_add_u32 m0, s65, 26112
    s_add_u32 s69, s30, 65536
    buffer_load_dwordx4 v2, s[44:47], s69 offen lds
    s_add_u32 m0, s65, 30464
    s_add_u32 s69, s30, 98304
    buffer_load_dwordx4 v2, s[44:47], s69 offen lds
    s_add_u32 s30, s30, 524288
    s_cmp_eq_u32 s30, 3670016
    s_cselect_b32 s30, 0, s30
    s_add_u32 m0, s66, 87040
    s_add_u32 s69, s22, 0
    buffer_load_dwordx4 v3, s[36:39], s69 offen nt lds
    s_add_u32 m0, s66, 91200
    s_add_u32 s69, s22, 2048
    buffer_load_dwordx4 v3, s[36:39], s69 offen nt lds
    s_add_u32 m0, s66, 95360
    s_add_u32 s69, s22, 4096
    buffer_load_dwordx4 v3, s[36:39], s69 offen nt lds
    s_add_u32 m0, s66, 99520
    s_add_u32 s69, s22, 6144
    buffer_load_dwordx4 v3, s[36:39], s69 offen nt lds
    s_add_u32 m0, s66, 52224
    s_add_u32 s69, s22, 16384
    buffer_load_dwordx4 v3, s[36:39], s69 offen nt lds
    s_add_u32 m0, s66, 56384
    s_add_u32 s69, s22, 18432
    buffer_load_dwordx4 v3, s[36:39], s69 offen nt lds
    s_add_u32 m0, s66, 60544
    s_add_u32 s69, s22, 20480
    buffer_load_dwordx4 v3, s[36:39], s69 offen nt lds
    s_add_u32 m0, s66, 64704
    s_add_u32 s69, s22, 22528
    buffer_load_dwordx4 v3, s[36:39], s69 offen nt lds
    s_waitcnt vmcnt(16) lgkmcnt(0)
    s_barrier
    s_setprio 1
    v_add_u32 v22, 139264, v14
    v_mfma_f32_32x32x16_bf16 v[32:47], v[96:99], v[176:179], v[32:47]
    ds_read_b64_tr_b16 v[96:97], v22
    ds_read_b64_tr_b16 v[98:99], v22 offset:4352
    v_mfma_f32_32x32x16_bf16 v[48:63], v[100:103], v[176:179], v[48:63]
    ds_read_b64_tr_b16 v[100:101], v22 offset:64
    ds_read_b64_tr_b16 v[102:103], v22 offset:4416
    v_mfma_f32_32x32x16_bf16 v[32:47], v[104:107], v[180:183], v[32:47]
    ds_read_b64_tr_b16 v[104:105], v22 offset:256
    ds_read_b64_tr_b16 v[106:107], v22 offset:4608
    v_mfma_f32_32x32x16_bf16 v[48:63], v[108:111], v[180:183], v[48:63]
    ds_read_b64_tr_b16 v[108:109], v22 offset:320
    ds_read_b64_tr_b16 v[110:111], v22 offset:4672
    v_mfma_f32_32x32x16_bf16 v[32:47], v[112:115], v[184:187], v[32:47]
    ds_read_b64_tr_b16 v[112:113], v22 offset:512
    ds_read_b64_tr_b16 v[114:115], v22 offset:4864
    v_mfma_f32_32x32x16_bf16 v[48:63], v[116:119], v[184:187], v[48:63]
    ds_read_b64_tr_b16 v[116:117], v22 offset:576
    ds_read_b64_tr_b16 v[118:119], v22 offset:4928
    v_mfma_f32_32x32x16_bf16 v[32:47], v[120:123], v[188:191], v[32:47]
    ds_read_b64_tr_b16 v[120:121], v22 offset:768
    ds_read_b64_tr_b16 v[122:123], v22 offset:5120
    v_mfma_f32_32x32x16_bf16 v[48:63], v[124:127], v[188:191], v[48:63]
    ds_read_b64_tr_b16 v[124:125], v22 offset:832
    ds_read_b64_tr_b16 v[126:127], v22 offset:5184
    s_barrier
    s_setprio 0
    s_add_u32 m0, s66, 121856
    s_add_u32 s69, s23, 0
    buffer_load_dwordx4 v3, s[36:39], s69 offen nt lds
    s_add_u32 m0, s66, 126016
    s_add_u32 s69, s23, 2048
    buffer_load_dwordx4 v3, s[36:39], s69 offen nt lds
    s_add_u32 m0, s66, 130176
    s_add_u32 s69, s23, 4096
    buffer_load_dwordx4 v3, s[36:39], s69 offen nt lds
    s_add_u32 m0, s66, 134336
    s_add_u32 s69, s23, 6144
    buffer_load_dwordx4 v3, s[36:39], s69 offen nt lds
    s_waitcnt vmcnt(16) lgkmcnt(0)
    s_barrier
    s_setprio 1
    v_add_u32 v22, 0, v14
    v_mfma_f32_32x32x16_bf16 v[32:47], v[96:99], v[192:195], v[32:47]
    ds_read_b64_tr_b16 v[96:97], v22
    ds_read_b64_tr_b16 v[98:99], v22 offset:4352
    v_mfma_f32_32x32x16_bf16 v[48:63], v[100:103], v[192:195], v[48:63]
    ds_read_b64_tr_b16 v[100:101], v22 offset:64
    ds_read_b64_tr_b16 v[102:103], v22 offset:4416
    v_mfma_f32_32x32x16_bf16 v[32:47], v[104:107], v[196:199], v[32:47]
    ds_read_b64_tr_b16 v[104:105], v22 offset:256
    ds_read_b64_tr_b16 v[106:107], v22 offset:4608
    v_mfma_f32_32x32x16_bf16 v[48:63], v[108:111], v[196:199], v[48:63]
    ds_read_b64_tr_b16 v[108:109], v22 offset:320
    ds_read_b64_tr_b16 v[110:111], v22 offset:4672
    v_mfma_f32_32x32x16_bf16 v[32:47], v[112:115], v[200:203], v[32:47]
    ds_read_b64_tr_b16 v[112:113], v22 offset:512
    ds_read_b64_tr_b16 v[114:115], v22 offset:4864
    v_mfma_f32_32x32x16_bf16 v[48:63], v[116:119], v[200:203], v[48:63]
    ds_read_b64_tr_b16 v[116:117], v22 offset:576
    ds_read_b64_tr_b16 v[118:119], v22 offset:4928
    v_mfma_f32_32x32x16_bf16 v[32:47], v[120:123], v[204:207], v[32:47]
    ds_read_b64_tr_b16 v[120:121], v22 offset:768
    ds_read_b64_tr_b16 v[122:123], v22 offset:5120
    v_mfma_f32_32x32x16_bf16 v[48:63], v[124:127], v[204:207], v[48:63]
    ds_read_b64_tr_b16 v[124:125], v22 offset:832
    ds_read_b64_tr_b16 v[126:127], v22 offset:5184
    s_barrier
    s_setprio 0
    s_waitcnt vmcnt(12) lgkmcnt(0)
    s_barrier
    s_setprio 1
    v_add_u32 v22, 17408, v14
    v_mfma_f32_32x32x16_bf16 v[32:47], v[96:99], v[208:211], v[32:47]
    ds_read_b64_tr_b16 v[96:97], v22
    ds_read_b64_tr_b16 v[98:99], v22 offset:4352
    v_mfma_f32_32x32x16_bf16 v[48:63], v[100:103], v[208:211], v[48:63]
    ds_read_b64_tr_b16 v[100:101], v22 offset:64
    ds_read_b64_tr_b16 v[102:103], v22 offset:4416
    v_mfma_f32_32x32x16_bf16 v[32:47], v[104:107], v[212:215], v[32:47]
    ds_read_b64_tr_b16 v[104:105], v22 offset:256
    ds_read_b64_tr_b16 v[106:107], v22 offset:4608
    v_mfma_f32_32x32x16_bf16 v[48:63], v[108:111], v[212:215], v[48:63]
    ds_read_b64_tr_b16 v[108:109], v22 offset:320
    ds_read_b64_tr_b16 v[110:111], v22 offset:4672
    v_mfma_f32_32x32x16_bf16 v[32:47], v[112:115], v[216:219], v[32:47]
    ds_read_b64_tr_b16 v[112:113], v22 offset:512
    ds_read_b64_tr_b16 v[114:115], v22 offset:4864
    v_mfma_f32_32x32x16_bf16 v[48:63], v[116:119], v[216:219], v[48:63]
    ds_read_b64_tr_b16 v[116:117], v22 offset:576
    ds_read_b64_tr_b16 v[118:119], v22 offset:4928
    v_mfma_f32_32x32x16_bf16 v[32:47], v[120:123], v[220:223], v[32:47]
    ds_read_b64_tr_b16 v[120:121], v22 offset:768
    ds_read_b64_tr_b16 v[122:123], v22 offset:5120
    v_mfma_f32_32x32x16_bf16 v[48:63], v[124:127], v[220:223], v[48:63]
    ds_read_b64_tr_b16 v[124:125], v22 offset:832
    ds_read_b64_tr_b16 v[126:127], v22 offset:5184
    s_barrier
    s_setprio 0
    s_waitcnt lgkmcnt(0)
    s_barrier
    s_setprio 1
    v_mfma_f32_32x32x16_bf16 v[32:47], v[96:99], v[224:227], v[32:47]
    v_mfma_f32_32x32x16_bf16 v[48:63], v[100:103], v[224:227], v[48:63]
    v_mfma_f32_32x32x16_bf16 v[32:47], v[104:107], v[228:231], v[32:47]
    v_mfma_f32_32x32x16_bf16 v[48:63], v[108:111], v[228:231], v[48:63]
    v_mfma_f32_32x32x16_bf16 v[32:47], v[112:115], v[232:235], v[32:47]
    v_mfma_f32_32x32x16_bf16 v[48:63], v[116:119], v[232:235], v[48:63]
    v_mfma_f32_32x32x16_bf16 v[32:47], v[120:123], v[236:239], v[32:47]
    v_mfma_f32_32x32x16_bf16 v[48:63], v[124:127], v[236:239], v[48:63]
    s_barrier
    s_setprio 0
    s_mul_i32 s70, s81, 17408
    s_add_u32 s70, s70, 0
    v_add_u32 v25, s70, v18
    s_lshl_b32 s71, s82, 12
    s_add_u32 s70, s70, s71
    v_add_u32 v24, s70, v18
    s_nop 2
    v_cvt_pk_bf16_f32 v64, v32, v33
    v_cvt_pk_bf16_f32 v65, v34, v35
    v_cvt_pk_bf16_f32 v66, v36, v37
    v_cvt_pk_bf16_f32 v67, v38, v39
    ds_write_b128 v24, v[64:67]
    v_cvt_pk_bf16_f32 v68, v40, v41
    v_cvt_pk_bf16_f32 v69, v42, v43
    v_cvt_pk_bf16_f32 v70, v44, v45
    v_cvt_pk_bf16_f32 v71, v46, v47
    ds_write_b128 v24, v[68:71] offset:1024
    v_cvt_pk_bf16_f32 v72, v48, v49
    v_cvt_pk_bf16_f32 v73, v50, v51
    v_cvt_pk_bf16_f32 v74, v52, v53
    v_cvt_pk_bf16_f32 v75, v54, v55
    ds_write_b128 v24, v[72:75] offset:2048
    v_cvt_pk_bf16_f32 v76, v56, v57
    v_cvt_pk_bf16_f32 v77, v58, v59
    v_cvt_pk_bf16_f32 v78, v60, v61
    v_cvt_pk_bf16_f32 v79, v62, v63
    ds_write_b128 v24, v[76:79] offset:3072
    s_waitcnt vmcnt(4) lgkmcnt(0)
    s_barrier
    s_setprio 0
    ds_read_b128 v[96:99], v25
    ds_read_b128 v[100:103], v25 offset:1024
    ds_read_b128 v[104:107], v25 offset:2048
    ds_read_b128 v[108:111], v25 offset:3072
    ds_read_b128 v[112:115], v25 offset:4096
    ds_read_b128 v[116:119], v25 offset:5120
    ds_read_b128 v[120:123], v25 offset:6144
    ds_read_b128 v[124:127], v25 offset:7168
    ds_read_b128 v[128:131], v25 offset:8192
    ds_read_b128 v[132:135], v25 offset:9216
    ds_read_b128 v[136:139], v25 offset:10240
    ds_read_b128 v[140:143], v25 offset:11264
    ds_read_b128 v[144:147], v25 offset:12288
    ds_read_b128 v[148:151], v25 offset:13312
    ds_read_b128 v[152:155], v25 offset:14336
    ds_read_b128 v[156:159], v25 offset:15360
    s_add_u32 m0, s66, 34816
    s_add_u32 s69, s23, 16384
    buffer_load_dwordx4 v3, s[36:39], s69 offen nt lds
    s_add_u32 m0, s66, 38976
    s_add_u32 s69, s23, 18432
    buffer_load_dwordx4 v3, s[36:39], s69 offen nt lds
    s_add_u32 m0, s66, 43136
    s_add_u32 s69, s23, 20480
    buffer_load_dwordx4 v3, s[36:39], s69 offen nt lds
    s_add_u32 m0, s66, 47296
    s_add_u32 s69, s23, 22528
    buffer_load_dwordx4 v3, s[36:39], s69 offen nt lds
    s_mul_i32 s70, s82, -34816
    s_add_u32 s70, s70, 87040
    v_add_u32 v22, s70, v17
    ds_read_b128 v[64:67], v22
    ds_read_b128 v[68:71], v22 offset:32
    ds_read_b128 v[72:75], v22 offset:64
    ds_read_b128 v[76:79], v22 offset:96
    ds_read_b128 v[80:83], v22 offset:128
    ds_read_b128 v[84:87], v22 offset:160
    s_waitcnt lgkmcnt(6)
    s_barrier
    s_setprio 1
    s_waitcnt lgkmcnt(5)
    v_mfma_f32_32x32x16_bf16 v[32:47], v[64:67], v[96:99], 0
    ds_read_b128 v[88:91], v22 offset:192
    s_waitcnt lgkmcnt(5)
    v_mfma_f32_32x32x16_bf16 v[32:47], v[68:71], v[100:103], v[32:47]
    ds_read_b128 v[92:95], v22 offset:224
    s_waitcnt lgkmcnt(5)
    v_mfma_f32_32x32x16_bf16 v[32:47], v[72:75], v[104:107], v[32:47]
    ds_read_b128 v[64:67], v22 offset:256
    s_waitcnt lgkmcnt(5)
    v_mfma_f32_32x32x16_bf16 v[32:47], v[76:79], v[108:111], v[32:47]
    ds_read_b128 v[68:71], v22 offset:288
    s_waitcnt lgkmcnt(5)
    v_mfma_f32_32x32x16_bf16 v[32:47], v[80:83], v[112:115], v[32:47]
    ds_read_b128 v[72:75], v22 offset:320
    s_waitcnt lgkmcnt(5)
    v_mfma_f32_32x32x16_bf16 v[32:47], v[84:87], v[116:119], v[32:47]
    ds_read_b128 v[76:79], v22 offset:352
    s_waitcnt lgkmcnt(5)
    v_mfma_f32_32x32x16_bf16 v[32:47], v[88:91], v[120:123], v[32:47]
    ds_read_b128 v[80:83], v22 offset:384
    s_waitcnt lgkmcnt(5)
    v_mfma_f32_32x32x16_bf16 v[32:47], v[92:95], v[124:127], v[32:47]
    ds_read_b128 v[84:87], v22 offset:416
    s_waitcnt lgkmcnt(5)
    v_mfma_f32_32x32x16_bf16 v[32:47], v[64:67], v[128:131], v[32:47]
    ds_read_b128 v[88:91], v22 offset:448
    s_waitcnt lgkmcnt(5)
    v_mfma_f32_32x32x16_bf16 v[32:47], v[68:71], v[132:135], v[32:47]
    ds_read_b128 v[92:95], v22 offset:480
    s_waitcnt lgkmcnt(5)
    v_mfma_f32_32x32x16_bf16 v[32:47], v[72:75], v[136:139], v[32:47]
    s_waitcnt lgkmcnt(4)
    v_mfma_f32_32x32x16_bf16 v[32:47], v[76:79], v[140:143], v[32:47]
    s_waitcnt lgkmcnt(3)
    v_mfma_f32_32x32x16_bf16 v[32:47], v[80:83], v[144:147], v[32:47]
    s_waitcnt lgkmcnt(2)
    v_mfma_f32_32x32x16_bf16 v[32:47], v[84:87], v[148:151], v[32:47]
    s_waitcnt lgkmcnt(1)
    v_mfma_f32_32x32x16_bf16 v[32:47], v[88:91], v[152:155], v[32:47]
    s_waitcnt lgkmcnt(0)
    v_mfma_f32_32x32x16_bf16 v[32:47], v[92:95], v[156:159], v[32:47]
    s_add_u32 m0, s66, 17408
    s_add_u32 s69, s24, 0
    buffer_load_dwordx4 v3, s[36:39], s69 offen nt lds
    s_add_u32 m0, s66, 21568
    s_add_u32 s69, s24, 2048
    buffer_load_dwordx4 v3, s[36:39], s69 offen nt lds
    s_add_u32 m0, s66, 25728
    s_add_u32 s69, s24, 4096
    buffer_load_dwordx4 v3, s[36:39], s69 offen nt lds
    s_add_u32 m0, s66, 29888
    s_add_u32 s69, s24, 6144
    buffer_load_dwordx4 v3, s[36:39], s69 offen nt lds
    s_waitcnt vmcnt(4)
    s_barrier
    s_setprio 0
    s_add_u32 m0, s66, 87040
    s_add_u32 s69, s24, 16384
    buffer_load_dwordx4 v3, s[36:39], s69 offen nt lds
    s_add_u32 m0, s66, 91200
    s_add_u32 s69, s24, 18432
    buffer_load_dwordx4 v3, s[36:39], s69 offen nt lds
    s_add_u32 m0, s66, 95360
    s_add_u32 s69, s24, 20480
    buffer_load_dwordx4 v3, s[36:39], s69 offen nt lds
    s_add_u32 m0, s66, 99520
    s_add_u32 s69, s24, 22528
    buffer_load_dwordx4 v3, s[36:39], s69 offen nt lds
    s_add_u32 m0, s66, 52224
    s_add_u32 s69, s25, 0
    buffer_load_dwordx4 v3, s[36:39], s69 offen nt lds
    s_add_u32 m0, s66, 56384
    s_add_u32 s69, s25, 2048
    buffer_load_dwordx4 v3, s[36:39], s69 offen nt lds
    s_add_u32 m0, s66, 60544
    s_add_u32 s69, s25, 4096
    buffer_load_dwordx4 v3, s[36:39], s69 offen nt lds
    s_add_u32 m0, s66, 64704
    s_add_u32 s69, s25, 6144
    buffer_load_dwordx4 v3, s[36:39], s69 offen nt lds
    v_max3_f32 v5, v32, v33, v34
    v_max3_f32 v6, v35, v36, v37
    v_max3_f32 v5, v5, v38, v39
    v_max3_f32 v6, v6, v40, v41
    v_max3_f32 v5, v5, v42, v43
    v_max3_f32 v6, v6, v44, v45
    v_max3_f32 v5, v5, v46, v47
    v_max_f32 v5, v5, v6
    v_mov_b32 v6, v5
    s_nop 1
    v_permlane32_swap_b32 v5, v6
    v_max_f32 v5, v5, v6
    v_mul_f32 v5, s68, v5
    v_ceil_f32 v8, v5
    v_add_f32 v5, 1090519040, v8
    v_mul_f32 v7, 1093759512, v5
    v_mov_b32 v9, 0
    v_mov_b32 v12, 0
    v_fma_f32 v32, v32, s68, -v8
    v_exp_f32 v32, v32
    v_fma_f32 v33, v33, s68, -v8
    v_exp_f32 v33, v33
    v_add_f32 v9, v9, v32
    v_fma_f32 v34, v34, s68, -v8
    v_exp_f32 v34, v34
    v_add_f32 v12, v12, v33
    v_cvt_pk_bf16_f32 v160, v32, v33
    v_fma_f32 v35, v35, s68, -v8
    v_exp_f32 v35, v35
    v_add_f32 v9, v9, v34
    v_fma_f32 v36, v36, s68, -v8
    v_exp_f32 v36, v36
    v_add_f32 v12, v12, v35
    v_cvt_pk_bf16_f32 v161, v34, v35
    v_fma_f32 v37, v37, s68, -v8
    v_exp_f32 v37, v37
    v_add_f32 v9, v9, v36
    v_fma_f32 v38, v38, s68, -v8
    v_exp_f32 v38, v38
    v_add_f32 v12, v12, v37
    v_cvt_pk_bf16_f32 v162, v36, v37
    v_fma_f32 v39, v39, s68, -v8
    v_exp_f32 v39, v39
    v_add_f32 v9, v9, v38
    v_fma_f32 v40, v40, s68, -v8
    v_exp_f32 v40, v40
    v_add_f32 v12, v12, v39
    v_cvt_pk_bf16_f32 v163, v38, v39
    v_fma_f32 v41, v41, s68, -v8
    v_exp_f32 v41, v41
    v_add_f32 v9, v9, v40
    v_fma_f32 v42, v42, s68, -v8
    v_exp_f32 v42, v42
    v_add_f32 v12, v12, v41
    v_cvt_pk_bf16_f32 v164, v40, v41
    v_fma_f32 v43, v43, s68, -v8
    v_exp_f32 v43, v43
    v_add_f32 v9, v9, v42
    v_fma_f32 v44, v44, s68, -v8
    v_exp_f32 v44, v44
    v_add_f32 v12, v12, v43
    v_cvt_pk_bf16_f32 v165, v42, v43
    v_fma_f32 v45, v45, s68, -v8
    v_exp_f32 v45, v45
    v_add_f32 v9, v9, v44
    v_fma_f32 v46, v46, s68, -v8
    v_exp_f32 v46, v46
    v_add_f32 v12, v12, v45
    v_cvt_pk_bf16_f32 v166, v44, v45
    v_fma_f32 v47, v47, s68, -v8
    v_exp_f32 v47, v47
    v_add_f32 v9, v9, v46
    v_add_f32 v12, v12, v47
    v_cvt_pk_bf16_f32 v167, v46, v47
    s_mul_i32 s70, s82, -87040
    s_add_u32 s70, s70, 121856
    v_add_u32 v22, s70, v17
    ds_read_b128 v[64:67], v22
    ds_read_b128 v[68:71], v22 offset:32
    ds_read_b128 v[72:75], v22 offset:64
    ds_read_b128 v[76:79], v22 offset:96
    ds_read_b128 v[80:83], v22 offset:128
    ds_read_b128 v[84:87], v22 offset:160
    s_barrier
    s_setprio 1
    s_waitcnt lgkmcnt(5)
    v_mfma_f32_32x32x16_bf16 v[48:63], v[64:67], v[96:99], 0
    ds_read_b128 v[88:91], v22 offset:192
    s_waitcnt lgkmcnt(5)
    v_mfma_f32_32x32x16_bf16 v[48:63], v[68:71], v[100:103], v[48:63]
    ds_read_b128 v[92:95], v22 offset:224
    s_waitcnt lgkmcnt(5)
    v_mfma_f32_32x32x16_bf16 v[48:63], v[72:75], v[104:107], v[48:63]
    ds_read_b128 v[64:67], v22 offset:256
    s_waitcnt lgkmcnt(5)
    v_mfma_f32_32x32x16_bf16 v[48:63], v[76:79], v[108:111], v[48:63]
    ds_read_b128 v[68:71], v22 offset:288
    s_waitcnt lgkmcnt(5)
    v_mfma_f32_32x32x16_bf16 v[48:63], v[80:83], v[112:115], v[48:63]
    ds_read_b128 v[72:75], v22 offset:320
    s_waitcnt lgkmcnt(5)
    v_mfma_f32_32x32x16_bf16 v[48:63], v[84:87], v[116:119], v[48:63]
    ds_read_b128 v[76:79], v22 offset:352
    s_waitcnt lgkmcnt(5)
    v_mfma_f32_32x32x16_bf16 v[48:63], v[88:91], v[120:123], v[48:63]
    ds_read_b128 v[80:83], v22 offset:384
    s_waitcnt lgkmcnt(5)
    v_mfma_f32_32x32x16_bf16 v[48:63], v[92:95], v[124:127], v[48:63]
    ds_read_b128 v[84:87], v22 offset:416
    s_waitcnt lgkmcnt(5)
    v_mfma_f32_32x32x16_bf16 v[48:63], v[64:67], v[128:131], v[48:63]
    ds_read_b128 v[88:91], v22 offset:448
    s_waitcnt lgkmcnt(5)
    v_mfma_f32_32x32x16_bf16 v[48:63], v[68:71], v[132:135], v[48:63]
    ds_read_b128 v[92:95], v22 offset:480
    s_waitcnt lgkmcnt(5)
    v_mfma_f32_32x32x16_bf16 v[48:63], v[72:75], v[136:139], v[48:63]
    s_waitcnt lgkmcnt(4)
    v_mfma_f32_32x32x16_bf16 v[48:63], v[76:79], v[140:143], v[48:63]
    s_waitcnt lgkmcnt(3)
    v_mfma_f32_32x32x16_bf16 v[48:63], v[80:83], v[144:147], v[48:63]
    s_waitcnt lgkmcnt(2)
    v_mfma_f32_32x32x16_bf16 v[48:63], v[84:87], v[148:151], v[48:63]
    s_waitcnt lgkmcnt(1)
    v_mfma_f32_32x32x16_bf16 v[48:63], v[88:91], v[152:155], v[48:63]
    s_waitcnt lgkmcnt(0)
    v_mfma_f32_32x32x16_bf16 v[48:63], v[92:95], v[156:159], v[48:63]
    s_waitcnt vmcnt(4)
    s_barrier
    s_setprio 0
    s_add_u32 m0, s66, 121856
    s_add_u32 s69, s25, 16384
    buffer_load_dwordx4 v3, s[36:39], s69 offen nt lds
    s_add_u32 m0, s66, 126016
    s_add_u32 s69, s25, 18432
    buffer_load_dwordx4 v3, s[36:39], s69 offen nt lds
    s_add_u32 m0, s66, 130176
    s_add_u32 s69, s25, 20480
    buffer_load_dwordx4 v3, s[36:39], s69 offen nt lds
    s_add_u32 m0, s66, 134336
    s_add_u32 s69, s25, 22528
    buffer_load_dwordx4 v3, s[36:39], s69 offen nt lds
    s_add_u32 m0, s66, 34816
    s_add_u32 s69, s26, 0
    buffer_load_dwordx4 v3, s[36:39], s69 offen nt lds
    s_add_u32 m0, s66, 38976
    s_add_u32 s69, s26, 2048
    buffer_load_dwordx4 v3, s[36:39], s69 offen nt lds
    s_add_u32 m0, s66, 43136
    s_add_u32 s69, s26, 4096
    buffer_load_dwordx4 v3, s[36:39], s69 offen nt lds
    s_add_u32 m0, s66, 47296
    s_add_u32 s69, s26, 6144
    buffer_load_dwordx4 v3, s[36:39], s69 offen nt lds
    v_max3_f32 v5, v48, v49, v50
    v_max3_f32 v6, v51, v52, v53
    v_max3_f32 v5, v5, v54, v55
    v_max3_f32 v6, v6, v56, v57
    v_max3_f32 v5, v5, v58, v59
    v_max3_f32 v6, v6, v60, v61
    v_max3_f32 v5, v5, v62, v63
    v_max_f32 v5, v5, v6
    v_cmp_gt_f32 vcc, v5, v7
    s_cbranch_vccz NR_100001
    s_call_b64 s[72:73], L_RARE
NR_100001:
    v_fma_f32 v48, v48, s68, -v8
    v_exp_f32 v48, v48
    v_fma_f32 v49, v49, s68, -v8
    v_exp_f32 v49, v49
    v_add_f32 v9, v9, v48
    v_fma_f32 v50, v50, s68, -v8
    v_exp_f32 v50, v50
    v_add_f32 v12, v12, v49
    v_cvt_pk_bf16_f32 v168, v48, v49
    v_fma_f32 v51, v51, s68, -v8
    v_exp_f32 v51, v51
    v_add_f32 v9, v9, v50
    v_fma_f32 v52, v52, s68, -v8
    v_exp_f32 v52, v52
    v_add_f32 v12, v12, v51
    v_cvt_pk_bf16_f32 v169, v50, v51
    v_fma_f32 v53, v53, s68, -v8
    v_exp_f32 v53, v53
    v_add_f32 v9, v9, v52
    v_fma_f32 v54, v54, s68, -v8
    v_exp_f32 v54, v54
    v_add_f32 v12, v12, v53
    v_cvt_pk_bf16_f32 v170, v52, v53
    v_fma_f32 v55, v55, s68, -v8
    v_exp_f32 v55, v55
    v_add_f32 v9, v9, v54
    v_fma_f32 v56, v56, s68, -v8
    v_exp_f32 v56, v56
    v_add_f32 v12, v12, v55
    v_cvt_pk_bf16_f32 v171, v54, v55
    v_fma_f32 v57, v57, s68, -v8
    v_exp_f32 v57, v57
    v_add_f32 v9, v9, v56
    v_fma_f32 v58, v58, s68, -v8
    v_exp_f32 v58, v58
    v_add_f32 v12, v12, v57
    v_cvt_pk_bf16_f32 v172, v56, v57
    v_fma_f32 v59, v59, s68, -v8
    v_exp_f32 v59, v59
    v_add_f32 v9, v9, v58
    v_fma_f32 v60, v60, s68, -v8
    v_exp_f32 v60, v60
    v_add_f32 v12, v12, v59
    v_cvt_pk_bf16_f32 v173, v58, v59
    v_fma_f32 v61, v61, s68, -v8
    v_exp_f32 v61, v61
    v_add_f32 v9, v9, v60
    v_fma_f32 v62, v62, s68, -v8
    v_exp_f32 v62, v62
    v_add_f32 v12, v12, v61
    v_cvt_pk_bf16_f32 v174, v60, v61
    v_fma_f32 v63, v63, s68, -v8
    v_exp_f32 v63, v63
    v_add_f32 v9, v9, v62
    v_add_f32 v12, v12, v63
    v_cvt_pk_bf16_f32 v175, v62, v63
    s_mul_i32 s70, s82, 69632
    s_add_u32 s70, s70, 17408
    v_add_u32 v22, s70, v17
    ds_read_b128 v[64:67], v22
    ds_read_b128 v[68:71], v22 offset:32
    ds_read_b128 v[72:75], v22 offset:64
    ds_read_b128 v[76:79], v22 offset:96
    ds_read_b128 v[80:83], v22 offset:128
    ds_read_b128 v[84:87], v22 offset:160
    s_barrier
    s_setprio 1
    s_waitcnt lgkmcnt(5)
    v_mfma_f32_32x32x16_bf16 v[32:47], v[64:67], v[96:99], 0
    ds_read_b128 v[88:91], v22 offset:192
    s_waitcnt lgkmcnt(5)
    v_mfma_f32_32x32x16_bf16 v[32:47], v[68:71], v[100:103], v[32:47]
    ds_read_b128 v[92:95], v22 offset:224
    s_waitcnt lgkmcnt(5)
    v_mfma_f32_32x32x16_bf16 v[32:47], v[72:75], v[104:107], v[32:47]
    ds_read_b128 v[64:67], v22 offset:256
    s_waitcnt lgkmcnt(5)
    v_mfma_f32_32x32x16_bf16 v[32:47], v[76:79], v[108:111], v[32:47]
    ds_read_b128 v[68:71], v22 offset:288
    s_waitcnt lgkmcnt(5)
    v_mfma_f32_32x32x16_bf16 v[32:47], v[80:83], v[112:115], v[32:47]
    ds_read_b128 v[72:75], v22 offset:320
    s_waitcnt lgkmcnt(5)
    v_mfma_f32_32x32x16_bf16 v[32:47], v[84:87], v[116:119], v[32:47]
    ds_read_b128 v[76:79], v22 offset:352
    s_waitcnt lgkmcnt(5)
    v_mfma_f32_32x32x16_bf16 v[32:47], v[88:91], v[120:123], v[32:47]
    ds_read_b128 v[80:83], v22 offset:384
    s_waitcnt lgkmcnt(5)
    v_mfma_f32_32x32x16_bf16 v[32:47], v[92:95], v[124:127], v[32:47]
    ds_read_b128 v[84:87], v22 offset:416
    s_waitcnt lgkmcnt(5)
    v_mfma_f32_32x32x16_bf16 v[32:47], v[64:67], v[128:131], v[32:47]
    ds_read_b128 v[88:91], v22 offset:448
    s_waitcnt lgkmcnt(5)
    v_mfma_f32_32x32x16_bf16 v[32:47], v[68:71], v[132:135], v[32:47]
    ds_read_b128 v[92:95], v22 offset:480
    s_waitcnt lgkmcnt(5)
    v_mfma_f32_32x32x16_bf16 v[32:47], v[72:75], v[136:139], v[32:47]
    s_waitcnt lgkmcnt(4)
    v_mfma_f32_32x32x16_bf16 v[32:47], v[76:79], v[140:143], v[32:47]
    s_waitcnt lgkmcnt(3)
    v_mfma_f32_32x32x16_bf16 v[32:47], v[80:83], v[144:147], v[32:47]
    s_waitcnt lgkmcnt(2)
    v_mfma_f32_32x32x16_bf16 v[32:47], v[84:87], v[148:151], v[32:47]
    s_waitcnt lgkmcnt(1)
    v_mfma_f32_32x32x16_bf16 v[32:47], v[88:91], v[152:155], v[32:47]
    s_waitcnt lgkmcnt(0)
    v_mfma_f32_32x32x16_bf16 v[32:47], v[92:95], v[156:159], v[32:47]
    s_waitcnt vmcnt(4)
    s_barrier
    s_setprio 0
    s_add_u32 m0, s66, 87040
    s_add_u32 s69, s26, 16384
    buffer_load_dwordx4 v3, s[36:39], s69 offen nt lds
    s_add_u32 m0, s66, 91200
    s_add_u32 s69, s26, 18432
    buffer_load_dwordx4 v3, s[36:39], s69 offen nt lds
    s_add_u32 m0, s66, 95360
    s_add_u32 s69, s26, 20480
    buffer_load_dwordx4 v3, s[36:39], s69 offen nt lds
    s_add_u32 m0, s66, 99520
    s_add_u32 s69, s26, 22528
    buffer_load_dwordx4 v3, s[36:39], s69 offen nt lds
    s_add_u32 m0, s66, 17408
    s_add_u32 s69, s27, 0
    buffer_load_dwordx4 v3, s[36:39], s69 offen nt lds
    s_add_u32 m0, s66, 21568
    s_add_u32 s69, s27, 2048
    buffer_load_dwordx4 v3, s[36:39], s69 offen nt lds
    s_add_u32 m0, s66, 25728
    s_add_u32 s69, s27, 4096
    buffer_load_dwordx4 v3, s[36:39], s69 offen nt lds
    s_add_u32 m0, s66, 29888
    s_add_u32 s69, s27, 6144
    buffer_load_dwordx4 v3, s[36:39], s69 offen nt lds
    v_max3_f32 v5, v32, v33, v34
    v_max3_f32 v6, v35, v36, v37
    v_max3_f32 v5, v5, v38, v39
    v_max3_f32 v6, v6, v40, v41
    v_max3_f32 v5, v5, v42, v43
    v_max3_f32 v6, v6, v44, v45
    v_max3_f32 v5, v5, v46, v47
    v_max_f32 v5, v5, v6
    v_cmp_gt_f32 vcc, v5, v7
    s_cbranch_vccz NR_100002
    s_call_b64 s[72:73], L_RARE
NR_100002:
    v_fma_f32 v32, v32, s68, -v8
    v_exp_f32 v32, v32
    v_fma_f32 v33, v33, s68, -v8
    v_exp_f32 v33, v33
    v_add_f32 v9, v9, v32
    v_fma_f32 v34, v34, s68, -v8
    v_exp_f32 v34, v34
    v_add_f32 v12, v12, v33
    v_cvt_pk_bf16_f32 v176, v32, v33
    v_fma_f32 v35, v35, s68, -v8
    v_exp_f32 v35, v35
    v_add_f32 v9, v9, v34
    v_fma_f32 v36, v36, s68, -v8
    v_exp_f32 v36, v36
    v_add_f32 v12, v12, v35
    v_cvt_pk_bf16_f32 v177, v34, v35
    v_fma_f32 v37, v37, s68, -v8
    v_exp_f32 v37, v37
    v_add_f32 v9, v9, v36
    v_fma_f32 v38, v38, s68, -v8
    v_exp_f32 v38, v38
    v_add_f32 v12, v12, v37
    v_cvt_pk_bf16_f32 v178, v36, v37
    v_fma_f32 v39, v39, s68, -v8
    v_exp_f32 v39, v39
    v_add_f32 v9, v9, v38
    v_fma_f32 v40, v40, s68, -v8
    v_exp_f32 v40, v40
    v_add_f32 v12, v12, v39
    v_cvt_pk_bf16_f32 v179, v38, v39
    v_fma_f32 v41, v41, s68, -v8
    v_exp_f32 v41, v41
    v_add_f32 v9, v9, v40
    v_fma_f32 v42, v42, s68, -v8
    v_exp_f32 v42, v42
    v_add_f32 v12, v12, v41
    v_cvt_pk_bf16_f32 v180, v40, v41
    v_fma_f32 v43, v43, s68, -v8
    v_exp_f32 v43, v43
    v_add_f32 v9, v9, v42
    v_fma_f32 v44, v44, s68, -v8
    v_exp_f32 v44, v44
    v_add_f32 v12, v12, v43
    v_cvt_pk_bf16_f32 v181, v42, v43
    v_fma_f32 v45, v45, s68, -v8
    v_exp_f32 v45, v45
    v_add_f32 v9, v9, v44
    v_fma_f32 v46, v46, s68, -v8
    v_exp_f32 v46, v46
    v_add_f32 v12, v12, v45
    v_cvt_pk_bf16_f32 v182, v44, v45
    v_fma_f32 v47, v47, s68, -v8
    v_exp_f32 v47, v47
    v_add_f32 v9, v9, v46
    v_add_f32 v12, v12, v47
    v_cvt_pk_bf16_f32 v183, v46, v47
    s_mul_i32 s70, s82, 69632
    s_add_u32 s70, s70, 52224
    v_add_u32 v22, s70, v17
    ds_read_b128 v[64:67], v22
    ds_read_b128 v[68:71], v22 offset:32
    ds_read_b128 v[72:75], v22 offset:64
    ds_read_b128 v[76:79], v22 offset:96
    ds_read_b128 v[80:83], v22 offset:128
    ds_read_b128 v[84:87], v22 offset:160
    s_barrier
    s_setprio 1
    s_waitcnt lgkmcnt(5)
    v_mfma_f32_32x32x16_bf16 v[48:63], v[64:67], v[96:99], 0
    ds_read_b128 v[88:91], v22 offset:192
    s_waitcnt lgkmcnt(5)
    v_mfma_f32_32x32x16_bf16 v[48:63], v[68:71], v[100:103], v[48:63]
    ds_read_b128 v[92:95], v22 offset:224
    s_waitcnt lgkmcnt(5)
    v_mfma_f32_32x32x16_bf16 v[48:63], v[72:75], v[104:107], v[48:63]
    ds_read_b128 v[64:67], v22 offset:256
    s_waitcnt lgkmcnt(5)
    v_mfma_f32_32x32x16_bf16 v[48:63], v[76:79], v[108:111], v[48:63]
    ds_read_b128 v[68:71], v22 offset:288
    s_waitcnt lgkmcnt(5)
    v_mfma_f32_32x32x16_bf16 v[48:63], v[80:83], v[112:115], v[48:63]
    ds_read_b128 v[72:75], v22 offset:320
    s_waitcnt lgkmcnt(5)
    v_mfma_f32_32x32x16_bf16 v[48:63], v[84:87], v[116:119], v[48:63]
    ds_read_b128 v[76:79], v22 offset:352
    s_waitcnt lgkmcnt(5)
    v_mfma_f32_32x32x16_bf16 v[48:63], v[88:91], v[120:123], v[48:63]
    ds_read_b128 v[80:83], v22 offset:384
    s_waitcnt lgkmcnt(5)
    v_mfma_f32_32x32x16_bf16 v[48:63], v[92:95], v[124:127], v[48:63]
    ds_read_b128 v[84:87], v22 offset:416
    s_waitcnt lgkmcnt(5)
    v_mfma_f32_32x32x16_bf16 v[48:63], v[64:67], v[128:131], v[48:63]
    ds_read_b128 v[88:91], v22 offset:448
    s_waitcnt lgkmcnt(5)
    v_mfma_f32_32x32x16_bf16 v[48:63], v[68:71], v[132:135], v[48:63]
    ds_read_b128 v[92:95], v22 offset:480
    s_waitcnt lgkmcnt(5)
    v_mfma_f32_32x32x16_bf16 v[48:63], v[72:75], v[136:139], v[48:63]
    s_waitcnt lgkmcnt(4)
    v_mfma_f32_32x32x16_bf16 v[48:63], v[76:79], v[140:143], v[48:63]
    s_waitcnt lgkmcnt(3)
    v_mfma_f32_32x32x16_bf16 v[48:63], v[80:83], v[144:147], v[48:63]
    s_waitcnt lgkmcnt(2)
    v_mfma_f32_32x32x16_bf16 v[48:63], v[84:87], v[148:151], v[48:63]
    s_waitcnt lgkmcnt(1)
    v_mfma_f32_32x32x16_bf16 v[48:63], v[88:91], v[152:155], v[48:63]
    s_waitcnt lgkmcnt(0)
    v_mfma_f32_32x32x16_bf16 v[48:63], v[92:95], v[156:159], v[48:63]
    s_waitcnt vmcnt(4)
    s_barrier
    s_setprio 0
    s_add_u32 m0, s66, 121856
    s_add_u32 s69, s27, 16384
    buffer_load_dwordx4 v3, s[36:39], s69 offen nt lds
    s_add_u32 m0, s66, 126016
    s_add_u32 s69, s27, 18432
    buffer_load_dwordx4 v3, s[36:39], s69 offen nt lds
    s_add_u32 m0, s66, 130176
    s_add_u32 s69, s27, 20480
    buffer_load_dwordx4 v3, s[36:39], s69 offen nt lds
    s_add_u32 m0, s66, 134336
    s_add_u32 s69, s27, 22528
    buffer_load_dwordx4 v3, s[36:39], s69 offen nt lds
    s_add_u32 m0, s66, 52224
    s_add_u32 s69, s28, 0
    buffer_load_dwordx4 v3, s[36:39], s69 offen nt lds
    s_add_u32 m0, s66, 56384
    s_add_u32 s69, s28, 2048
    buffer_load_dwordx4 v3, s[36:39], s69 offen nt lds
    s_add_u32 m0, s66, 60544
    s_add_u32 s69, s28, 4096
    buffer_load_dwordx4 v3, s[36:39], s69 offen nt lds
    s_add_u32 m0, s66, 64704
    s_add_u32 s69, s28, 6144
    buffer_load_dwordx4 v3, s[36:39], s69 offen nt lds
    v_max3_f32 v5, v48, v49, v50
    v_max3_f32 v6, v51, v52, v53
    v_max3_f32 v5, v5, v54, v55
    v_max3_f32 v6, v6, v56, v57
    v_max3_f32 v5, v5, v58, v59
    v_max3_f32 v6, v6, v60, v61
    v_max3_f32 v5, v5, v62, v63
    v_max_f32 v5, v5, v6
    v_cmp_gt_f32 vcc, v5, v7
    s_cbranch_vccz NR_100003
    s_call_b64 s[72:73], L_RARE
NR_100003:
    v_fma_f32 v48, v48, s68, -v8
    v_exp_f32 v48, v48
    v_fma_f32 v49, v49, s68, -v8
    v_exp_f32 v49, v49
    v_add_f32 v9, v9, v48
    v_fma_f32 v50, v50, s68, -v8
    v_exp_f32 v50, v50
    v_add_f32 v12, v12, v49
    v_cvt_pk_bf16_f32 v184, v48, v49
    v_fma_f32 v51, v51, s68, -v8
    v_exp_f32 v51, v51
    v_add_f32 v9, v9, v50
    v_fma_f32 v52, v52, s68, -v8
    v_exp_f32 v52, v52
    v_add_f32 v12, v12, v51
    v_cvt_pk_bf16_f32 v185, v50, v51
    v_fma_f32 v53, v53, s68, -v8
    v_exp_f32 v53, v53
    v_add_f32 v9, v9, v52
    v_fma_f32 v54, v54, s68, -v8
    v_exp_f32 v54, v54
    v_add_f32 v12, v12, v53
    v_cvt_pk_bf16_f32 v186, v52, v53
    v_fma_f32 v55, v55, s68, -v8
    v_exp_f32 v55, v55
    v_add_f32 v9, v9, v54
    v_fma_f32 v56, v56, s68, -v8
    v_exp_f32 v56, v56
    v_add_f32 v12, v12, v55
    v_cvt_pk_bf16_f32 v187, v54, v55
    v_fma_f32 v57, v57, s68, -v8
    v_exp_f32 v57, v57
    v_add_f32 v9, v9, v56
    v_fma_f32 v58, v58, s68, -v8
    v_exp_f32 v58, v58
    v_add_f32 v12, v12, v57
    v_cvt_pk_bf16_f32 v188, v56, v57
    v_fma_f32 v59, v59, s68, -v8
    v_exp_f32 v59, v59
    v_add_f32 v9, v9, v58
    v_fma_f32 v60, v60, s68, -v8
    v_exp_f32 v60, v60
    v_add_f32 v12, v12, v59
    v_cvt_pk_bf16_f32 v189, v58, v59
    v_fma_f32 v61, v61, s68, -v8
    v_exp_f32 v61, v61
    v_add_f32 v9, v9, v60
    v_fma_f32 v62, v62, s68, -v8
    v_exp_f32 v62, v62
    v_add_f32 v12, v12, v61
    v_cvt_pk_bf16_f32 v190, v60, v61
    v_fma_f32 v63, v63, s68, -v8
    v_exp_f32 v63, v63
    v_add_f32 v9, v9, v62
    v_add_f32 v12, v12, v63
    v_cvt_pk_bf16_f32 v191, v62, v63
    s_mul_i32 s70, s82, 52224
    s_add_u32 s70, s70, 34816
    v_add_u32 v22, s70, v17
    ds_read_b128 v[64:67], v22
    ds_read_b128 v[68:71], v22 offset:32
    ds_read_b128 v[72:75], v22 offset:64
    ds_read_b128 v[76:79], v22 offset:96
    ds_read_b128 v[80:83], v22 offset:128
    ds_read_b128 v[84:87], v22 offset:160
    s_barrier
    s_setprio 1
    s_waitcnt lgkmcnt(5)
    v_mfma_f32_32x32x16_bf16 v[32:47], v[64:67], v[96:99], 0
    ds_read_b128 v[88:91], v22 offset:192
    s_waitcnt lgkmcnt(5)
    v_mfma_f32_32x32x16_bf16 v[32:47], v[68:71], v[100:103], v[32:47]
    ds_read_b128 v[92:95], v22 offset:224
    s_waitcnt lgkmcnt(5)
    v_mfma_f32_32x32x16_bf16 v[32:47], v[72:75], v[104:107], v[32:47]
    ds_read_b128 v[64:67], v22 offset:256
    s_waitcnt lgkmcnt(5)
    v_mfma_f32_32x32x16_bf16 v[32:47], v[76:79], v[108:111], v[32:47]
    ds_read_b128 v[68:71], v22 offset:288
    s_waitcnt lgkmcnt(5)
    v_mfma_f32_32x32x16_bf16 v[32:47], v[80:83], v[112:115], v[32:47]
    ds_read_b128 v[72:75], v22 offset:320
    s_waitcnt lgkmcnt(5)
    v_mfma_f32_32x32x16_bf16 v[32:47], v[84:87], v[116:119], v[32:47]
    ds_read_b128 v[76:79], v22 offset:352
    s_waitcnt lgkmcnt(5)
    v_mfma_f32_32x32x16_bf16 v[32:47], v[88:91], v[120:123], v[32:47]
    ds_read_b128 v[80:83], v22 offset:384
    s_waitcnt lgkmcnt(5)
    v_mfma_f32_32x32x16_bf16 v[32:47], v[92:95], v[124:127], v[32:47]
    ds_read_b128 v[84:87], v22 offset:416
    s_waitcnt lgkmcnt(5)
    v_mfma_f32_32x32x16_bf16 v[32:47], v[64:67], v[128:131], v[32:47]
    ds_read_b128 v[88:91], v22 offset:448
    s_waitcnt lgkmcnt(5)
    v_mfma_f32_32x32x16_bf16 v[32:47], v[68:71], v[132:135], v[32:47]
    ds_read_b128 v[92:95], v22 offset:480
    s_waitcnt lgkmcnt(5)
    v_mfma_f32_32x32x16_bf16 v[32:47], v[72:75], v[136:139], v[32:47]
    s_waitcnt lgkmcnt(4)
    v_mfma_f32_32x32x16_bf16 v[32:47], v[76:79], v[140:143], v[32:47]
    s_waitcnt lgkmcnt(3)
    v_mfma_f32_32x32x16_bf16 v[32:47], v[80:83], v[144:147], v[32:47]
    s_waitcnt lgkmcnt(2)
    v_mfma_f32_32x32x16_bf16 v[32:47], v[84:87], v[148:151], v[32:47]
    s_waitcnt lgkmcnt(1)
    v_mfma_f32_32x32x16_bf16 v[32:47], v[88:91], v[152:155], v[32:47]
    s_waitcnt lgkmcnt(0)
    v_mfma_f32_32x32x16_bf16 v[32:47], v[92:95], v[156:159], v[32:47]
    s_waitcnt vmcnt(4)
    s_barrier
    s_setprio 0
    s_add_u32 m0, s66, 87040
    s_add_u32 s69, s28, 16384
    buffer_load_dwordx4 v3, s[36:39], s69 offen nt lds
    s_add_u32 m0, s66, 91200
    s_add_u32 s69, s28, 18432
    buffer_load_dwordx4 v3, s[36:39], s69 offen nt lds
    s_add_u32 m0, s66, 95360
    s_add_u32 s69, s28, 20480
    buffer_load_dwordx4 v3, s[36:39], s69 offen nt lds
    s_add_u32 m0, s66, 99520
    s_add_u32 s69, s28, 22528
    buffer_load_dwordx4 v3, s[36:39], s69 offen nt lds
    s_add_u32 m0, s66, 34816
    s_add_u32 s69, s29, 0
    buffer_load_dwordx4 v3, s[36:39], s69 offen nt lds
    s_add_u32 m0, s66, 38976
    s_add_u32 s69, s29, 2048
    buffer_load_dwordx4 v3, s[36:39], s69 offen nt lds
    s_add_u32 m0, s66, 43136
    s_add_u32 s69, s29, 4096
    buffer_load_dwordx4 v3, s[36:39], s69 offen nt lds
    s_add_u32 m0, s66, 47296
    s_add_u32 s69, s29, 6144
    buffer_load_dwordx4 v3, s[36:39], s69 offen nt lds
    v_max3_f32 v5, v32, v33, v34
    v_max3_f32 v6, v35, v36, v37
    v_max3_f32 v5, v5, v38, v39
    v_max3_f32 v6, v6, v40, v41
    v_max3_f32 v5, v5, v42, v43
    v_max3_f32 v6, v6, v44, v45
    v_max3_f32 v5, v5, v46, v47
    v_max_f32 v5, v5, v6
    v_cmp_gt_f32 vcc, v5, v7
    s_cbranch_vccz NR_100004
    s_call_b64 s[72:73], L_RARE
NR_100004:
    v_fma_f32 v32, v32, s68, -v8
    v_exp_f32 v32, v32
    v_fma_f32 v33, v33, s68, -v8
    v_exp_f32 v33, v33
    v_add_f32 v9, v9, v32
    v_fma_f32 v34, v34, s68, -v8
    v_exp_f32 v34, v34
    v_add_f32 v12, v12, v33
    v_cvt_pk_bf16_f32 v192, v32, v33
    v_fma_f32 v35, v35, s68, -v8
    v_exp_f32 v35, v35
    v_add_f32 v9, v9, v34
    v_fma_f32 v36, v36, s68, -v8
    v_exp_f32 v36, v36
    v_add_f32 v12, v12, v35
    v_cvt_pk_bf16_f32 v193, v34, v35
    v_fma_f32 v37, v37, s68, -v8
    v_exp_f32 v37, v37
    v_add_f32 v9, v9, v36
    v_fma_f32 v38, v38, s68, -v8
    v_exp_f32 v38, v38
    v_add_f32 v12, v12, v37
    v_cvt_pk_bf16_f32 v194, v36, v37
    v_fma_f32 v39, v39, s68, -v8
    v_exp_f32 v39, v39
    v_add_f32 v9, v9, v38
    v_fma_f32 v40, v40, s68, -v8
    v_exp_f32 v40, v40
    v_add_f32 v12, v12, v39
    v_cvt_pk_bf16_f32 v195, v38, v39
    v_fma_f32 v41, v41, s68, -v8
    v_exp_f32 v41, v41
    v_add_f32 v9, v9, v40
    v_fma_f32 v42, v42, s68, -v8
    v_exp_f32 v42, v42
    v_add_f32 v12, v12, v41
    v_cvt_pk_bf16_f32 v196, v40, v41
    v_fma_f32 v43, v43, s68, -v8
    v_exp_f32 v43, v43
    v_add_f32 v9, v9, v42
    v_fma_f32 v44, v44, s68, -v8
    v_exp_f32 v44, v44
    v_add_f32 v12, v12, v43
    v_cvt_pk_bf16_f32 v197, v42, v43
    v_fma_f32 v45, v45, s68, -v8
    v_exp_f32 v45, v45
    v_add_f32 v9, v9, v44
    v_fma_f32 v46, v46, s68, -v8
    v_exp_f32 v46, v46
    v_add_f32 v12, v12, v45
    v_cvt_pk_bf16_f32 v198, v44, v45
    v_fma_f32 v47, v47, s68, -v8
    v_exp_f32 v47, v47
    v_add_f32 v9, v9, v46
    v_add_f32 v12, v12, v47
    v_cvt_pk_bf16_f32 v199, v46, v47
    s_mul_i32 s70, s82, 104448
    s_add_u32 s70, s70, 17408
    v_add_u32 v22, s70, v17
    ds_read_b128 v[64:67], v22
    ds_read_b128 v[68:71], v22 offset:32
    ds_read_b128 v[72:75], v22 offset:64
    ds_read_b128 v[76:79], v22 offset:96
    ds_read_b128 v[80:83], v22 offset:128
    ds_read_b128 v[84:87], v22 offset:160
    s_barrier
    s_setprio 1
    s_waitcnt lgkmcnt(5)
    v_mfma_f32_32x32x16_bf16 v[48:63], v[64:67], v[96:99], 0
    ds_read_b128 v[88:91], v22 offset:192
    s_waitcnt lgkmcnt(5)
    v_mfma_f32_32x32x16_bf16 v[48:63], v[68:71], v[100:103], v[48:63]
    ds_read_b128 v[92:95], v22 offset:224
    s_waitcnt lgkmcnt(5)
    v_mfma_f32_32x32x16_bf16 v[48:63], v[72:75], v[104:107], v[48:63]
    ds_read_b128 v[64:67], v22 offset:256
    s_waitcnt lgkmcnt(5)
    v_mfma_f32_32x32x16_bf16 v[48:63], v[76:79], v[108:111], v[48:63]
    ds_read_b128 v[68:71], v22 offset:288
    s_waitcnt lgkmcnt(5)
    v_mfma_f32_32x32x16_bf16 v[48:63], v[80:83], v[112:115], v[48:63]
    ds_read_b128 v[72:75], v22 offset:320
    s_waitcnt lgkmcnt(5)
    v_mfma_f32_32x32x16_bf16 v[48:63], v[84:87], v[116:119], v[48:63]
    ds_read_b128 v[76:79], v22 offset:352
    s_waitcnt lgkmcnt(5)
    v_mfma_f32_32x32x16_bf16 v[48:63], v[88:91], v[120:123], v[48:63]
    ds_read_b128 v[80:83], v22 offset:384
    s_waitcnt lgkmcnt(5)
    v_mfma_f32_32x32x16_bf16 v[48:63], v[92:95], v[124:127], v[48:63]
    ds_read_b128 v[84:87], v22 offset:416
    s_waitcnt lgkmcnt(5)
    v_mfma_f32_32x32x16_bf16 v[48:63], v[64:67], v[128:131], v[48:63]
    ds_read_b128 v[88:91], v22 offset:448
    s_waitcnt lgkmcnt(5)
    v_mfma_f32_32x32x16_bf16 v[48:63], v[68:71], v[132:135], v[48:63]
    ds_read_b128 v[92:95], v22 offset:480
    s_waitcnt lgkmcnt(5)
    v_mfma_f32_32x32x16_bf16 v[48:63], v[72:75], v[136:139], v[48:63]
    s_waitcnt lgkmcnt(4)
    v_mfma_f32_32x32x16_bf16 v[48:63], v[76:79], v[140:143], v[48:63]
    s_waitcnt lgkmcnt(3)
    v_mfma_f32_32x32x16_bf16 v[48:63], v[80:83], v[144:147], v[48:63]
    s_waitcnt lgkmcnt(2)
    v_mfma_f32_32x32x16_bf16 v[48:63], v[84:87], v[148:151], v[48:63]
    s_waitcnt lgkmcnt(1)
    v_mfma_f32_32x32x16_bf16 v[48:63], v[88:91], v[152:155], v[48:63]
    s_waitcnt lgkmcnt(0)
    v_mfma_f32_32x32x16_bf16 v[48:63], v[92:95], v[156:159], v[48:63]
    s_waitcnt vmcnt(4)
    s_barrier
    s_setprio 0
    s_add_u32 m0, s66, 121856
    s_add_u32 s69, s29, 16384
    buffer_load_dwordx4 v3, s[36:39], s69 offen nt lds
    s_add_u32 m0, s66, 126016
    s_add_u32 s69, s29, 18432
    buffer_load_dwordx4 v3, s[36:39], s69 offen nt lds
    s_add_u32 m0, s66, 130176
    s_add_u32 s69, s29, 20480
    buffer_load_dwordx4 v3, s[36:39], s69 offen nt lds
    s_add_u32 m0, s66, 134336
    s_add_u32 s69, s29, 22528
    buffer_load_dwordx4 v3, s[36:39], s69 offen nt lds
    s_add_u32 m0, s65, 17408
    s_add_u32 s69, s22, 0
    buffer_load_dwordx4 v4, s[40:43], s69 offen nt lds
    s_add_u32 m0, s65, 21760
    s_add_u32 s69, s22, 8192
    buffer_load_dwordx4 v4, s[40:43], s69 offen nt lds
    s_add_u32 m0, s65, 26112
    s_add_u32 s69, s23, 0
    buffer_load_dwordx4 v4, s[40:43], s69 offen nt lds
    s_add_u32 m0, s65, 30464
    s_add_u32 s69, s23, 8192
    buffer_load_dwordx4 v4, s[40:43], s69 offen nt lds
    v_max3_f32 v5, v48, v49, v50
    v_max3_f32 v6, v51, v52, v53
    v_max3_f32 v5, v5, v54, v55
    v_max3_f32 v6, v6, v56, v57
    v_max3_f32 v5, v5, v58, v59
    v_max3_f32 v6, v6, v60, v61
    v_max3_f32 v5, v5, v62, v63
    v_max_f32 v5, v5, v6
    v_cmp_gt_f32 vcc, v5, v7
    s_cbranch_vccz NR_100005
    s_call_b64 s[72:73], L_RARE
NR_100005:
    v_fma_f32 v48, v48, s68, -v8
    v_exp_f32 v48, v48
    v_fma_f32 v49, v49, s68, -v8
    v_exp_f32 v49, v49
    v_add_f32 v9, v9, v48
    v_fma_f32 v50, v50, s68, -v8
    v_exp_f32 v50, v50
    v_add_f32 v12, v12, v49
    v_cvt_pk_bf16_f32 v200, v48, v49
    v_fma_f32 v51, v51, s68, -v8
    v_exp_f32 v51, v51
    v_add_f32 v9, v9, v50
    v_fma_f32 v52, v52, s68, -v8
    v_exp_f32 v52, v52
    v_add_f32 v12, v12, v51
    v_cvt_pk_bf16_f32 v201, v50, v51
    v_fma_f32 v53, v53, s68, -v8
    v_exp_f32 v53, v53
    v_add_f32 v9, v9, v52
    v_fma_f32 v54, v54, s68, -v8
    v_exp_f32 v54, v54
    v_add_f32 v12, v12, v53
    v_cvt_pk_bf16_f32 v202, v52, v53
    v_fma_f32 v55, v55, s68, -v8
    v_exp_f32 v55, v55
    v_add_f32 v9, v9, v54
    v_fma_f32 v56, v56, s68, -v8
    v_exp_f32 v56, v56
    v_add_f32 v12, v12, v55
    v_cvt_pk_bf16_f32 v203, v54, v55
    v_fma_f32 v57, v57, s68, -v8
    v_exp_f32 v57, v57
    v_add_f32 v9, v9, v56
    v_fma_f32 v58, v58, s68, -v8
    v_exp_f32 v58, v58
    v_add_f32 v12, v12, v57
    v_cvt_pk_bf16_f32 v204, v56, v57
    v_fma_f32 v59, v59, s68, -v8
    v_exp_f32 v59, v59
    v_add_f32 v9, v9, v58
    v_fma_f32 v60, v60, s68, -v8
    v_exp_f32 v60, v60
    v_add_f32 v12, v12, v59
    v_cvt_pk_bf16_f32 v205, v58, v59
    v_fma_f32 v61, v61, s68, -v8
    v_exp_f32 v61, v61
    v_add_f32 v9, v9, v60
    v_fma_f32 v62, v62, s68, -v8
    v_exp_f32 v62, v62
    v_add_f32 v12, v12, v61
    v_cvt_pk_bf16_f32 v206, v60, v61
    v_fma_f32 v63, v63, s68, -v8
    v_exp_f32 v63, v63
    v_add_f32 v9, v9, v62
    v_add_f32 v12, v12, v63
    v_cvt_pk_bf16_f32 v207, v62, v63
    s_mul_i32 s70, s82, 34816
    s_add_u32 s70, s70, 52224
    v_add_u32 v22, s70, v17
    ds_read_b128 v[64:67], v22
    ds_read_b128 v[68:71], v22 offset:32
    ds_read_b128 v[72:75], v22 offset:64
    ds_read_b128 v[76:79], v22 offset:96
    ds_read_b128 v[80:83], v22 offset:128
    ds_read_b128 v[84:87], v22 offset:160
    s_barrier
    s_setprio 1
    s_waitcnt lgkmcnt(5)
    v_mfma_f32_32x32x16_bf16 v[32:47], v[64:67], v[96:99], 0
    ds_read_b128 v[88:91], v22 offset:192
    s_waitcnt lgkmcnt(5)
    v_mfma_f32_32x32x16_bf16 v[32:47], v[68:71], v[100:103], v[32:47]
    ds_read_b128 v[92:95], v22 offset:224
    s_waitcnt lgkmcnt(5)
    v_mfma_f32_32x32x16_bf16 v[32:47], v[72:75], v[104:107], v[32:47]
    ds_read_b128 v[64:67], v22 offset:256
    s_waitcnt lgkmcnt(5)
    v_mfma_f32_32x32x16_bf16 v[32:47], v[76:79], v[108:111], v[32:47]
    ds_read_b128 v[68:71], v22 offset:288
    s_waitcnt lgkmcnt(5)
    v_mfma_f32_32x32x16_bf16 v[32:47], v[80:83], v[112:115], v[32:47]
    ds_read_b128 v[72:75], v22 offset:320
    s_waitcnt lgkmcnt(5)
    v_mfma_f32_32x32x16_bf16 v[32:47], v[84:87], v[116:119], v[32:47]
    ds_read_b128 v[76:79], v22 offset:352
    s_waitcnt lgkmcnt(5)
    v_mfma_f32_32x32x16_bf16 v[32:47], v[88:91], v[120:123], v[32:47]
    ds_read_b128 v[80:83], v22 offset:384
    s_waitcnt lgkmcnt(5)
    v_mfma_f32_32x32x16_bf16 v[32:47], v[92:95], v[124:127], v[32:47]
    ds_read_b128 v[84:87], v22 offset:416
    s_waitcnt lgkmcnt(5)
    v_mfma_f32_32x32x16_bf16 v[32:47], v[64:67], v[128:131], v[32:47]
    ds_read_b128 v[88:91], v22 offset:448
    s_waitcnt lgkmcnt(5)
    v_mfma_f32_32x32x16_bf16 v[32:47], v[68:71], v[132:135], v[32:47]
    ds_read_b128 v[92:95], v22 offset:480
    s_waitcnt lgkmcnt(5)
    v_mfma_f32_32x32x16_bf16 v[32:47], v[72:75], v[136:139], v[32:47]
    s_waitcnt lgkmcnt(4)
    v_mfma_f32_32x32x16_bf16 v[32:47], v[76:79], v[140:143], v[32:47]
    s_waitcnt lgkmcnt(3)
    v_mfma_f32_32x32x16_bf16 v[32:47], v[80:83], v[144:147], v[32:47]
    s_waitcnt lgkmcnt(2)
    v_mfma_f32_32x32x16_bf16 v[32:47], v[84:87], v[148:151], v[32:47]
    s_waitcnt lgkmcnt(1)
    v_mfma_f32_32x32x16_bf16 v[32:47], v[88:91], v[152:155], v[32:47]
    s_waitcnt lgkmcnt(0)
    v_mfma_f32_32x32x16_bf16 v[32:47], v[92:95], v[156:159], v[32:47]
    s_waitcnt vmcnt(4)
    s_barrier
    s_setprio 0
    s_add_u32 m0, s65, 87040
    s_add_u32 s69, s22, 16384
    buffer_load_dwordx4 v4, s[40:43], s69 offen nt lds
    s_add_u32 m0, s65, 91392
    s_add_u32 s69, s22, 24576
    buffer_load_dwordx4 v4, s[40:43], s69 offen nt lds
    s_add_u32 m0, s65, 95744
    s_add_u32 s69, s23, 16384
    buffer_load_dwordx4 v4, s[40:43], s69 offen nt lds
    s_add_u32 m0, s65, 100096
    s_add_u32 s69, s23, 24576
    buffer_load_dwordx4 v4, s[40:43], s69 offen nt lds
    s_add_u32 m0, s65, 52224
    s_add_u32 s69, s24, 0
    buffer_load_dwordx4 v4, s[40:43], s69 offen nt lds
    s_add_u32 m0, s65, 56576
    s_add_u32 s69, s24, 8192
    buffer_load_dwordx4 v4, s[40:43], s69 offen nt lds
    s_add_u32 m0, s65, 60928
    s_add_u32 s69, s25, 0
    buffer_load_dwordx4 v4, s[40:43], s69 offen nt lds
    s_add_u32 m0, s65, 65280
    s_add_u32 s69, s25, 8192
    buffer_load_dwordx4 v4, s[40:43], s69 offen nt lds
    v_max3_f32 v5, v32, v33, v34
    v_max3_f32 v6, v35, v36, v37
    v_max3_f32 v5, v5, v38, v39
    v_max3_f32 v6, v6, v40, v41
    v_max3_f32 v5, v5, v42, v43
    v_max3_f32 v6, v6, v44, v45
    v_max3_f32 v5, v5, v46, v47
    v_max_f32 v5, v5, v6
    v_cmp_gt_f32 vcc, v5, v7
    s_cbranch_vccz NR_100006
    s_call_b64 s[72:73], L_RARE
NR_100006:
    v_fma_f32 v32, v32, s68, -v8
    v_exp_f32 v32, v32
    v_fma_f32 v33, v33, s68, -v8
    v_exp_f32 v33, v33
    v_add_f32 v9, v9, v32
    v_fma_f32 v34, v34, s68, -v8
    v_exp_f32 v34, v34
    v_add_f32 v12, v12, v33
    v_cvt_pk_bf16_f32 v208, v32, v33
    v_fma_f32 v35, v35, s68, -v8
    v_exp_f32 v35, v35
    v_add_f32 v9, v9, v34
    v_fma_f32 v36, v36, s68, -v8
    v_exp_f32 v36, v36
    v_add_f32 v12, v12, v35
    v_cvt_pk_bf16_f32 v209, v34, v35
    v_fma_f32 v37, v37, s68, -v8
    v_exp_f32 v37, v37
    v_add_f32 v9, v9, v36
    v_fma_f32 v38, v38, s68, -v8
    v_exp_f32 v38, v38
    v_add_f32 v12, v12, v37
    v_cvt_pk_bf16_f32 v210, v36, v37
    v_fma_f32 v39, v39, s68, -v8
    v_exp_f32 v39, v39
    v_add_f32 v9, v9, v38
    v_fma_f32 v40, v40, s68, -v8
    v_exp_f32 v40, v40
    v_add_f32 v12, v12, v39
    v_cvt_pk_bf16_f32 v211, v38, v39
    v_fma_f32 v41, v41, s68, -v8
    v_exp_f32 v41, v41
    v_add_f32 v9, v9, v40
    v_fma_f32 v42, v42, s68, -v8
    v_exp_f32 v42, v42
    v_add_f32 v12, v12, v41
    v_cvt_pk_bf16_f32 v212, v40, v41
    v_fma_f32 v43, v43, s68, -v8
    v_exp_f32 v43, v43
    v_add_f32 v9, v9, v42
    v_fma_f32 v44, v44, s68, -v8
    v_exp_f32 v44, v44
    v_add_f32 v12, v12, v43
    v_cvt_pk_bf16_f32 v213, v42, v43
    v_fma_f32 v45, v45, s68, -v8
    v_exp_f32 v45, v45
    v_add_f32 v9, v9, v44
    v_fma_f32 v46, v46, s68, -v8
    v_exp_f32 v46, v46
    v_add_f32 v12, v12, v45
    v_cvt_pk_bf16_f32 v214, v44, v45
    v_fma_f32 v47, v47, s68, -v8
    v_exp_f32 v47, v47
    v_add_f32 v9, v9, v46
    v_add_f32 v12, v12, v47
    v_cvt_pk_bf16_f32 v215, v46, v47
    s_mul_i32 s70, s82, 87040
    s_add_u32 s70, s70, 34816
    v_add_u32 v22, s70, v17
    ds_read_b128 v[64:67], v22
    ds_read_b128 v[68:71], v22 offset:32
    ds_read_b128 v[72:75], v22 offset:64
    ds_read_b128 v[76:79], v22 offset:96
    ds_read_b128 v[80:83], v22 offset:128
    ds_read_b128 v[84:87], v22 offset:160
    s_barrier
    s_setprio 1
    s_waitcnt lgkmcnt(5)
    v_mfma_f32_32x32x16_bf16 v[48:63], v[64:67], v[96:99], 0
    ds_read_b128 v[88:91], v22 offset:192
    s_waitcnt lgkmcnt(5)
    v_mfma_f32_32x32x16_bf16 v[48:63], v[68:71], v[100:103], v[48:63]
    ds_read_b128 v[92:95], v22 offset:224
    s_waitcnt lgkmcnt(5)
    v_mfma_f32_32x32x16_bf16 v[48:63], v[72:75], v[104:107], v[48:63]
    ds_read_b128 v[64:67], v22 offset:256
    s_waitcnt lgkmcnt(5)
    v_mfma_f32_32x32x16_bf16 v[48:63], v[76:79], v[108:111], v[48:63]
    ds_read_b128 v[68:71], v22 offset:288
    s_waitcnt lgkmcnt(5)
    v_mfma_f32_32x32x16_bf16 v[48:63], v[80:83], v[112:115], v[48:63]
    ds_read_b128 v[72:75], v22 offset:320
    s_waitcnt lgkmcnt(5)
    v_mfma_f32_32x32x16_bf16 v[48:63], v[84:87], v[116:119], v[48:63]
    ds_read_b128 v[76:79], v22 offset:352
    s_waitcnt lgkmcnt(5)
    v_mfma_f32_32x32x16_bf16 v[48:63], v[88:91], v[120:123], v[48:63]
    ds_read_b128 v[80:83], v22 offset:384
    s_waitcnt lgkmcnt(5)
    v_mfma_f32_32x32x16_bf16 v[48:63], v[92:95], v[124:127], v[48:63]
    ds_read_b128 v[84:87], v22 offset:416
    s_waitcnt lgkmcnt(5)
    v_mfma_f32_32x32x16_bf16 v[48:63], v[64:67], v[128:131], v[48:63]
    ds_read_b128 v[88:91], v22 offset:448
    s_waitcnt lgkmcnt(5)
    v_mfma_f32_32x32x16_bf16 v[48:63], v[68:71], v[132:135], v[48:63]
    ds_read_b128 v[92:95], v22 offset:480
    s_waitcnt lgkmcnt(5)
    v_mfma_f32_32x32x16_bf16 v[48:63], v[72:75], v[136:139], v[48:63]
    s_waitcnt lgkmcnt(4)
    v_mfma_f32_32x32x16_bf16 v[48:63], v[76:79], v[140:143], v[48:63]
    s_waitcnt lgkmcnt(3)
    v_mfma_f32_32x32x16_bf16 v[48:63], v[80:83], v[144:147], v[48:63]
    s_waitcnt lgkmcnt(2)
    v_mfma_f32_32x32x16_bf16 v[48:63], v[84:87], v[148:151], v[48:63]
    s_waitcnt lgkmcnt(1)
    v_mfma_f32_32x32x16_bf16 v[48:63], v[88:91], v[152:155], v[48:63]
    s_waitcnt lgkmcnt(0)
    v_mfma_f32_32x32x16_bf16 v[48:63], v[92:95], v[156:159], v[48:63]
    s_waitcnt vmcnt(4)
    s_barrier
    s_setprio 0
    s_add_u32 m0, s65, 121856
    s_add_u32 s69, s24, 16384
    buffer_load_dwordx4 v4, s[40:43], s69 offen nt lds
    s_add_u32 m0, s65, 126208
    s_add_u32 s69, s24, 24576
    buffer_load_dwordx4 v4, s[40:43], s69 offen nt lds
    s_add_u32 m0, s65, 130560
    s_add_u32 s69, s25, 16384
    buffer_load_dwordx4 v4, s[40:43], s69 offen nt lds
    s_add_u32 m0, s65, 134912
    s_add_u32 s69, s25, 24576
    buffer_load_dwordx4 v4, s[40:43], s69 offen nt lds
    s_add_u32 m0, s65, 34816
    s_add_u32 s69, s26, 0
    buffer_load_dwordx4 v4, s[40:43], s69 offen nt lds
    s_add_u32 m0, s65, 39168
    s_add_u32 s69, s26, 8192
    buffer_load_dwordx4 v4, s[40:43], s69 offen nt lds
    s_add_u32 m0, s65, 43520
    s_add_u32 s69, s27, 0
    buffer_load_dwordx4 v4, s[40:43], s69 offen nt lds
    s_add_u32 m0, s65, 47872
    s_add_u32 s69, s27, 8192
    buffer_load_dwordx4 v4, s[40:43], s69 offen nt lds
    v_max3_f32 v5, v48, v49, v50
    v_max3_f32 v6, v51, v52, v53
    v_max3_f32 v5, v5, v54, v55
    v_max3_f32 v6, v6, v56, v57
    v_max3_f32 v5, v5, v58, v59
    v_max3_f32 v6, v6, v60, v61
    v_max3_f32 v5, v5, v62, v63
    v_max_f32 v5, v5, v6
    v_cmp_gt_f32 vcc, v5, v7
    s_cbranch_vccz NR_100007
    s_call_b64 s[72:73], L_RARE
NR_100007:
    v_fma_f32 v48, v48, s68, -v8
    v_exp_f32 v48, v48
    v_fma_f32 v49, v49, s68, -v8
    v_exp_f32 v49, v49
    v_add_f32 v9, v9, v48
    v_fma_f32 v50, v50, s68, -v8
    v_exp_f32 v50, v50
    v_add_f32 v12, v12, v49
    v_cvt_pk_bf16_f32 v216, v48, v49
    v_fma_f32 v51, v51, s68, -v8
    v_exp_f32 v51, v51
    v_add_f32 v9, v9, v50
    v_fma_f32 v52, v52, s68, -v8
    v_exp_f32 v52, v52
    v_add_f32 v12, v12, v51
    v_cvt_pk_bf16_f32 v217, v50, v51
    v_fma_f32 v53, v53, s68, -v8
    v_exp_f32 v53, v53
    v_add_f32 v9, v9, v52
    v_fma_f32 v54, v54, s68, -v8
    v_exp_f32 v54, v54
    v_add_f32 v12, v12, v53
    v_cvt_pk_bf16_f32 v218, v52, v53
    v_fma_f32 v55, v55, s68, -v8
    v_exp_f32 v55, v55
    v_add_f32 v9, v9, v54
    v_fma_f32 v56, v56, s68, -v8
    v_exp_f32 v56, v56
    v_add_f32 v12, v12, v55
    v_cvt_pk_bf16_f32 v219, v54, v55
    v_fma_f32 v57, v57, s68, -v8
    v_exp_f32 v57, v57
    v_add_f32 v9, v9, v56
    v_fma_f32 v58, v58, s68, -v8
    v_exp_f32 v58, v58
    v_add_f32 v12, v12, v57
    v_cvt_pk_bf16_f32 v220, v56, v57
    v_fma_f32 v59, v59, s68, -v8
    v_exp_f32 v59, v59
    v_add_f32 v9, v9, v58
    v_fma_f32 v60, v60, s68, -v8
    v_exp_f32 v60, v60
    v_add_f32 v12, v12, v59
    v_cvt_pk_bf16_f32 v221, v58, v59
    v_fma_f32 v61, v61, s68, -v8
    v_exp_f32 v61, v61
    v_add_f32 v9, v9, v60
    v_fma_f32 v62, v62, s68, -v8
    v_exp_f32 v62, v62
    v_add_f32 v12, v12, v61
    v_cvt_pk_bf16_f32 v222, v60, v61
    v_fma_f32 v63, v63, s68, -v8
    v_exp_f32 v63, v63
    v_add_f32 v9, v9, v62
    v_add_f32 v12, v12, v63
    v_cvt_pk_bf16_f32 v223, v62, v63
    v_add_f32 v9, v9, v12
    v_mov_b32 v6, v9
    s_nop 1
    v_permlane32_swap_b32 v9, v6
    v_add_f32 v9, v9, v6
    v_and_b32 v26, 31, v0
    s_lshl_b32 s70, s64, 8
    v_lshl_add_u32 v29, v26, 3, s70
    v_add_u32 v27, 156672, v29
    ds_write_b64 v27, v[8:9]
    s_mul_i32 s70, s82, 69632
    s_add_u32 s70, s70, 17408
    v_add_u32 v22, s70, v16
    v_add_u32 v23, s70, v30
    ds_read_b64_tr_b16 v[128:129], v22
    ds_read_b64_tr_b16 v[130:131], v22 offset:512
    ds_read_b64_tr_b16 v[132:133], v22 offset:64
    ds_read_b64_tr_b16 v[134:135], v22 offset:576
    ds_read_b64_tr_b16 v[136:137], v23
    ds_read_b64_tr_b16 v[138:139], v23 offset:512
    ds_read_b64_tr_b16 v[140:141], v23 offset:64
    ds_read_b64_tr_b16 v[142:143], v23 offset:576
    ds_read_b64_tr_b16 v[144:145], v22 offset:4352
    ds_read_b64_tr_b16 v[146:147], v22 offset:4864
    ds_read_b64_tr_b16 v[148:149], v22 offset:4416
    ds_read_b64_tr_b16 v[150:151], v22 offset:4928
    s_waitcnt lgkmcnt(12)
    s_barrier
    s_setprio 1
    s_waitcnt lgkmcnt(10)
    v_mfma_f32_32x32x16_bf16 v[96:111], v[128:131], v[160:163], 0
    ds_read_b64_tr_b16 v[152:153], v23 offset:4352
    ds_read_b64_tr_b16 v[154:155], v23 offset:4864
    s_waitcnt lgkmcnt(10)
    v_mfma_f32_32x32x16_bf16 v[48:63], v[132:135], v[160:163], 0
    ds_read_b64_tr_b16 v[156:157], v23 offset:4416
    ds_read_b64_tr_b16 v[158:159], v23 offset:4928
    s_waitcnt lgkmcnt(10)
    v_mfma_f32_32x32x16_bf16 v[64:79], v[136:139], v[160:163], 0
    ds_read_b64_tr_b16 v[128:129], v22 offset:8704
    ds_read_b64_tr_b16 v[130:131], v22 offset:9216
    s_waitcnt lgkmcnt(10)
    v_mfma_f32_32x32x16_bf16 v[80:95], v[140:143], v[160:163], 0
    ds_read_b64_tr_b16 v[132:133], v22 offset:8768
    ds_read_b64_tr_b16 v[134:135], v22 offset:9280
    s_waitcnt lgkmcnt(10)
    v_mfma_f32_32x32x16_bf16 v[96:111], v[144:147], v[164:167], v[96:111]
    ds_read_b64_tr_b16 v[136:137], v23 offset:8704
    ds_read_b64_tr_b16 v[138:139], v23 offset:9216
    s_waitcnt lgkmcnt(10)
    v_mfma_f32_32x32x16_bf16 v[48:63], v[148:151], v[164:167], v[48:63]
    ds_read_b64_tr_b16 v[140:141], v23 offset:8768
    ds_read_b64_tr_b16 v[142:143], v23 offset:9280
    s_waitcnt lgkmcnt(10)
    v_mfma_f32_32x32x16_bf16 v[64:79], v[152:155], v[164:167], v[64:79]
    ds_read_b64_tr_b16 v[144:145], v22 offset:13056
    ds_read_b64_tr_b16 v[146:147], v22 offset:13568
    s_waitcnt lgkmcnt(10)
    v_mfma_f32_32x32x16_bf16 v[80:95], v[156:159], v[164:167], v[80:95]
    ds_read_b64_tr_b16 v[148:149], v22 offset:13120
    ds_read_b64_tr_b16 v[150:151], v22 offset:13632
    s_waitcnt lgkmcnt(10)
    v_mfma_f32_32x32x16_bf16 v[96:111], v[128:131], v[168:171], v[96:111]
    ds_read_b64_tr_b16 v[152:153], v23 offset:13056
    ds_read_b64_tr_b16 v[154:155], v23 offset:13568
    s_waitcnt lgkmcnt(10)
    v_mfma_f32_32x32x16_bf16 v[48:63], v[132:135], v[168:171], v[48:63]
    ds_read_b64_tr_b16 v[156:157], v23 offset:13120
    ds_read_b64_tr_b16 v[158:159], v23 offset:13632
    s_waitcnt lgkmcnt(10)
    v_mfma_f32_32x32x16_bf16 v[64:79], v[136:139], v[168:171], v[64:79]
    s_waitcnt lgkmcnt(8)
    v_mfma_f32_32x32x16_bf16 v[80:95], v[140:143], v[168:171], v[80:95]
    s_waitcnt lgkmcnt(6)
    v_mfma_f32_32x32x16_bf16 v[96:111], v[144:147], v[172:175], v[96:111]
    s_waitcnt lgkmcnt(4)
    v_mfma_f32_32x32x16_bf16 v[48:63], v[148:151], v[172:175], v[48:63]
    s_waitcnt lgkmcnt(2)
    v_mfma_f32_32x32x16_bf16 v[64:79], v[152:155], v[172:175], v[64:79]
    s_waitcnt lgkmcnt(0)
    v_mfma_f32_32x32x16_bf16 v[80:95], v[156:159], v[172:175], v[80:95]
    s_waitcnt vmcnt(4)
    s_barrier
    s_setprio 0
    s_add_u32 m0, s65, 87040
    s_add_u32 s69, s26, 16384
    buffer_load_dwordx4 v4, s[40:43], s69 offen nt lds
    s_add_u32 m0, s65, 91392
    s_add_u32 s69, s26, 24576
    buffer_load_dwordx4 v4, s[40:43], s69 offen nt lds
    s_add_u32 m0, s65, 95744
    s_add_u32 s69, s27, 16384
    buffer_load_dwordx4 v4, s[40:43], s69 offen nt lds
    s_add_u32 m0, s65, 100096
    s_add_u32 s69, s27, 24576
    buffer_load_dwordx4 v4, s[40:43], s69 offen nt lds
    s_add_u32 m0, s65, 17408
    s_add_u32 s69, s28, 0
    buffer_load_dwordx4 v4, s[40:43], s69 offen nt lds
    s_add_u32 m0, s65, 21760
    s_add_u32 s69, s28, 8192
    buffer_load_dwordx4 v4, s[40:43], s69 offen nt lds
    s_add_u32 m0, s65, 26112
    s_add_u32 s69, s29, 0
    buffer_load_dwordx4 v4, s[40:43], s69 offen nt lds
    s_add_u32 m0, s65, 30464
    s_add_u32 s69, s29, 8192
    buffer_load_dwordx4 v4, s[40:43], s69 offen nt lds
    s_mul_i32 s70, s82, 69632
    s_add_u32 s70, s70, 52224
    v_add_u32 v22, s70, v16
    v_add_u32 v23, s70, v30
    ds_read_b64_tr_b16 v[128:129], v22
    ds_read_b64_tr_b16 v[130:131], v22 offset:512
    ds_read_b64_tr_b16 v[132:133], v22 offset:64
    ds_read_b64_tr_b16 v[134:135], v22 offset:576
    ds_read_b64_tr_b16 v[136:137], v23
    ds_read_b64_tr_b16 v[138:139], v23 offset:512
    ds_read_b64_tr_b16 v[140:141], v23 offset:64
    ds_read_b64_tr_b16 v[142:143], v23 offset:576
    ds_read_b64_tr_b16 v[144:145], v22 offset:4352
    ds_read_b64_tr_b16 v[146:147], v22 offset:4864
    ds_read_b64_tr_b16 v[148:149], v22 offset:4416
    ds_read_b64_tr_b16 v[150:151], v22 offset:4928
    s_barrier
    s_setprio 1
    s_waitcnt lgkmcnt(10)
    v_mfma_f32_32x32x16_bf16 v[96:111], v[128:131], v[176:179], v[96:111]
    ds_read_b64_tr_b16 v[152:153], v23 offset:4352
    ds_read_b64_tr_b16 v[154:155], v23 offset:4864
    s_waitcnt lgkmcnt(10)
    v_mfma_f32_32x32x16_bf16 v[48:63], v[132:135], v[176:179], v[48:63]
    ds_read_b64_tr_b16 v[156:157], v23 offset:4416
    ds_read_b64_tr_b16 v[158:159], v23 offset:4928
    s_waitcnt lgkmcnt(10)
    v_mfma_f32_32x32x16_bf16 v[64:79], v[136:139], v[176:179], v[64:79]
    ds_read_b64_tr_b16 v[128:129], v22 offset:8704
    ds_read_b64_tr_b16 v[130:131], v22 offset:9216
    s_waitcnt lgkmcnt(10)
    v_mfma_f32_32x32x16_bf16 v[80:95], v[140:143], v[176:179], v[80:95]
    ds_read_b64_tr_b16 v[132:133], v22 offset:8768
    ds_read_b64_tr_b16 v[134:135], v22 offset:9280
    s_waitcnt lgkmcnt(10)
    v_mfma_f32_32x32x16_bf16 v[96:111], v[144:147], v[180:183], v[96:111]
    ds_read_b64_tr_b16 v[136:137], v23 offset:8704
    ds_read_b64_tr_b16 v[138:139], v23 offset:9216
    s_waitcnt lgkmcnt(10)
    v_mfma_f32_32x32x16_bf16 v[48:63], v[148:151], v[180:183], v[48:63]
    ds_read_b64_tr_b16 v[140:141], v23 offset:8768
    ds_read_b64_tr_b16 v[142:143], v23 offset:9280
    s_waitcnt lgkmcnt(10)
    v_mfma_f32_32x32x16_bf16 v[64:79], v[152:155], v[180:183], v[64:79]
    ds_read_b64_tr_b16 v[144:145], v22 offset:13056
    ds_read_b64_tr_b16 v[146:147], v22 offset:13568
    s_waitcnt lgkmcnt(10)
    v_mfma_f32_32x32x16_bf16 v[80:95], v[156:159], v[180:183], v[80:95]
    ds_read_b64_tr_b16 v[148:149], v22 offset:13120
    ds_read_b64_tr_b16 v[150:151], v22 offset:13632
    s_waitcnt lgkmcnt(10)
    v_mfma_f32_32x32x16_bf16 v[96:111], v[128:131], v[184:187], v[96:111]
    ds_read_b64_tr_b16 v[152:153], v23 offset:13056
    ds_read_b64_tr_b16 v[154:155], v23 offset:13568
    s_waitcnt lgkmcnt(10)
    v_mfma_f32_32x32x16_bf16 v[48:63], v[132:135], v[184:187], v[48:63]
    ds_read_b64_tr_b16 v[156:157], v23 offset:13120
    ds_read_b64_tr_b16 v[158:159], v23 offset:13632
    s_waitcnt lgkmcnt(10)
    v_mfma_f32_32x32x16_bf16 v[64:79], v[136:139], v[184:187], v[64:79]
    s_waitcnt lgkmcnt(8)
    v_mfma_f32_32x32x16_bf16 v[80:95], v[140:143], v[184:187], v[80:95]
    s_waitcnt lgkmcnt(6)
    v_mfma_f32_32x32x16_bf16 v[96:111], v[144:147], v[188:191], v[96:111]
    s_waitcnt lgkmcnt(4)
    v_mfma_f32_32x32x16_bf16 v[48:63], v[148:151], v[188:191], v[48:63]
    s_waitcnt lgkmcnt(2)
    v_mfma_f32_32x32x16_bf16 v[64:79], v[152:155], v[188:191], v[64:79]
    s_waitcnt lgkmcnt(0)
    v_mfma_f32_32x32x16_bf16 v[80:95], v[156:159], v[188:191], v[80:95]
    s_waitcnt vmcnt(4)
    s_barrier
    s_setprio 0
    s_add_u32 m0, s65, 52224
    s_add_u32 s69, s28, 16384
    buffer_load_dwordx4 v4, s[40:43], s69 offen nt lds
    s_add_u32 m0, s65, 56576
    s_add_u32 s69, s28, 24576
    buffer_load_dwordx4 v4, s[40:43], s69 offen nt lds
    s_add_u32 m0, s65, 60928
    s_add_u32 s69, s29, 16384
    buffer_load_dwordx4 v4, s[40:43], s69 offen nt lds
    s_add_u32 m0, s65, 65280
    s_add_u32 s69, s29, 24576
    buffer_load_dwordx4 v4, s[40:43], s69 offen nt lds
    v_xor_b32 v5, 1024, v29
    v_add_u32 v5, 156672, v5
    ds_read_b64 v[232:233], v5
    v_xor_b32 v5, 512, v29
    v_add_u32 v5, 156672, v5
    ds_read_b64 v[234:235], v5
    v_xor_b32 v5, 1536, v29
    v_add_u32 v5, 156672, v5
    ds_read_b64 v[236:237], v5
    s_waitcnt lgkmcnt(0)
    v_max3_f32 v238, v232, v234, v236
    v_max_f32 v238, v238, v8
    v_sub_f32 v8, v8, v238
    v_exp_f32 v8, v8
    v_sub_f32 v232, v232, v238
    v_exp_f32 v232, v232
    v_sub_f32 v234, v234, v238
    v_exp_f32 v234, v234
    v_sub_f32 v236, v236, v238
    v_exp_f32 v236, v236
    v_mul_f32 v9, v9, v8
    v_fmac_f32 v9, v232, v233
    v_fmac_f32 v9, v234, v235
    v_fmac_f32 v9, v236, v237
    v_rcp_f32 v9, v9
    s_nop 0
    v_mul_f32 v13, v8, v9
    v_mul_f32 v24, v232, v9
    v_mul_f32 v25, v234, v9
    v_mul_f32 v12, v236, v9
    s_mul_i32 s70, s82, 52224
    s_add_u32 s70, s70, 34816
    v_add_u32 v22, s70, v16
    v_add_u32 v23, s70, v30
    ds_read_b64_tr_b16 v[128:129], v22
    ds_read_b64_tr_b16 v[130:131], v22 offset:512
    ds_read_b64_tr_b16 v[132:133], v22 offset:64
    ds_read_b64_tr_b16 v[134:135], v22 offset:576
    ds_read_b64_tr_b16 v[136:137], v23
    ds_read_b64_tr_b16 v[138:139], v23 offset:512
    ds_read_b64_tr_b16 v[140:141], v23 offset:64
    ds_read_b64_tr_b16 v[142:143], v23 offset:576
    ds_read_b64_tr_b16 v[144:145], v22 offset:4352
    ds_read_b64_tr_b16 v[146:147], v22 offset:4864
    ds_read_b64_tr_b16 v[148:149], v22 offset:4416
    ds_read_b64_tr_b16 v[150:151], v22 offset:4928
    s_barrier
    s_setprio 1
    s_waitcnt lgkmcnt(10)
    v_mfma_f32_32x32x16_bf16 v[96:111], v[128:131], v[192:195], v[96:111]
    ds_read_b64_tr_b16 v[152:153], v23 offset:4352
    ds_read_b64_tr_b16 v[154:155], v23 offset:4864
    s_waitcnt lgkmcnt(10)
    v_mfma_f32_32x32x16_bf16 v[48:63], v[132:135], v[192:195], v[48:63]
    ds_read_b64_tr_b16 v[156:157], v23 offset:4416
    ds_read_b64_tr_b16 v[158:159], v23 offset:4928
    s_waitcnt lgkmcnt(10)
    v_mfma_f32_32x32x16_bf16 v[64:79], v[136:139], v[192:195], v[64:79]
    ds_read_b64_tr_b16 v[128:129], v22 offset:8704
    ds_read_b64_tr_b16 v[130:131], v22 offset:9216
    s_waitcnt lgkmcnt(10)
    v_mfma_f32_32x32x16_bf16 v[80:95], v[140:143], v[192:195], v[80:95]
    ds_read_b64_tr_b16 v[132:133], v22 offset:8768
    ds_read_b64_tr_b16 v[134:135], v22 offset:9280
    s_waitcnt lgkmcnt(10)
    v_mfma_f32_32x32x16_bf16 v[96:111], v[144:147], v[196:199], v[96:111]
    ds_read_b64_tr_b16 v[136:137], v23 offset:8704
    ds_read_b64_tr_b16 v[138:139], v23 offset:9216
    s_waitcnt lgkmcnt(10)
    v_mfma_f32_32x32x16_bf16 v[48:63], v[148:151], v[196:199], v[48:63]
    ds_read_b64_tr_b16 v[140:141], v23 offset:8768
    ds_read_b64_tr_b16 v[142:143], v23 offset:9280
    s_waitcnt lgkmcnt(10)
    v_mfma_f32_32x32x16_bf16 v[64:79], v[152:155], v[196:199], v[64:79]
    ds_read_b64_tr_b16 v[144:145], v22 offset:13056
    ds_read_b64_tr_b16 v[146:147], v22 offset:13568
    s_waitcnt lgkmcnt(10)
    v_mfma_f32_32x32x16_bf16 v[80:95], v[156:159], v[196:199], v[80:95]
    ds_read_b64_tr_b16 v[148:149], v22 offset:13120
    ds_read_b64_tr_b16 v[150:151], v22 offset:13632
    s_waitcnt lgkmcnt(10)
    v_mfma_f32_32x32x16_bf16 v[96:111], v[128:131], v[200:203], v[96:111]
    ds_read_b64_tr_b16 v[152:153], v23 offset:13056
    ds_read_b64_tr_b16 v[154:155], v23 offset:13568
    s_waitcnt lgkmcnt(10)
    v_mfma_f32_32x32x16_bf16 v[48:63], v[132:135], v[200:203], v[48:63]
    ds_read_b64_tr_b16 v[156:157], v23 offset:13120
    ds_read_b64_tr_b16 v[158:159], v23 offset:13632
    s_waitcnt lgkmcnt(10)
    v_mfma_f32_32x32x16_bf16 v[64:79], v[136:139], v[200:203], v[64:79]
    s_waitcnt lgkmcnt(8)
    v_mfma_f32_32x32x16_bf16 v[80:95], v[140:143], v[200:203], v[80:95]
    s_waitcnt lgkmcnt(6)
    v_mfma_f32_32x32x16_bf16 v[96:111], v[144:147], v[204:207], v[96:111]
    s_waitcnt lgkmcnt(4)
    v_mfma_f32_32x32x16_bf16 v[48:63], v[148:151], v[204:207], v[48:63]
    s_waitcnt lgkmcnt(2)
    v_mfma_f32_32x32x16_bf16 v[64:79], v[152:155], v[204:207], v[64:79]
    s_waitcnt lgkmcnt(0)
    v_mfma_f32_32x32x16_bf16 v[80:95], v[156:159], v[204:207], v[80:95]
    s_waitcnt vmcnt(0)
    s_barrier
    s_setprio 0
    s_add_u32 m0, s65, 34816
    s_add_u32 s69, s22, 256
    buffer_load_dwordx4 v4, s[40:43], s69 offen nt lds
    s_add_u32 m0, s65, 39168
    s_add_u32 s69, s22, 8448
    buffer_load_dwordx4 v4, s[40:43], s69 offen nt lds
    s_add_u32 m0, s65, 43520
    s_add_u32 s69, s23, 256
    buffer_load_dwordx4 v4, s[40:43], s69 offen nt lds
    s_add_u32 m0, s65, 47872
    s_add_u32 s69, s23, 8448
    buffer_load_dwordx4 v4, s[40:43], s69 offen nt lds
    s_add_u32 m0, s65, 87040
    s_add_u32 s69, s22, 16640
    buffer_load_dwordx4 v4, s[40:43], s69 offen nt lds
    s_add_u32 m0, s65, 91392
    s_add_u32 s69, s22, 24832
    buffer_load_dwordx4 v4, s[40:43], s69 offen nt lds
    s_add_u32 m0, s65, 95744
    s_add_u32 s69, s23, 16640
    buffer_load_dwordx4 v4, s[40:43], s69 offen nt lds
    s_add_u32 m0, s65, 100096
    s_add_u32 s69, s23, 24832
    buffer_load_dwordx4 v4, s[40:43], s69 offen nt lds
    s_mul_i32 s70, s82, 34816
    s_add_u32 s70, s70, 17408
    v_add_u32 v22, s70, v16
    v_add_u32 v23, s70, v30
    ds_read_b64_tr_b16 v[128:129], v22
    ds_read_b64_tr_b16 v[130:131], v22 offset:512
    ds_read_b64_tr_b16 v[132:133], v22 offset:64
    ds_read_b64_tr_b16 v[134:135], v22 offset:576
    ds_read_b64_tr_b16 v[136:137], v23
    ds_read_b64_tr_b16 v[138:139], v23 offset:512
    ds_read_b64_tr_b16 v[140:141], v23 offset:64
    ds_read_b64_tr_b16 v[142:143], v23 offset:576
    ds_read_b64_tr_b16 v[144:145], v22 offset:4352
    ds_read_b64_tr_b16 v[146:147], v22 offset:4864
    ds_read_b64_tr_b16 v[148:149], v22 offset:4416
    ds_read_b64_tr_b16 v[150:151], v22 offset:4928
    s_barrier
    s_setprio 1
    s_waitcnt lgkmcnt(10)
    v_mfma_f32_32x32x16_bf16 v[96:111], v[128:131], v[208:211], v[96:111]
    ds_read_b64_tr_b16 v[152:153], v23 offset:4352
    ds_read_b64_tr_b16 v[154:155], v23 offset:4864
    s_waitcnt lgkmcnt(10)
    v_mfma_f32_32x32x16_bf16 v[48:63], v[132:135], v[208:211], v[48:63]
    ds_read_b64_tr_b16 v[156:157], v23 offset:4416
    ds_read_b64_tr_b16 v[158:159], v23 offset:4928
    s_waitcnt lgkmcnt(10)
    v_mfma_f32_32x32x16_bf16 v[64:79], v[136:139], v[208:211], v[64:79]
    ds_read_b64_tr_b16 v[128:129], v22 offset:8704
    ds_read_b64_tr_b16 v[130:131], v22 offset:9216
    s_waitcnt lgkmcnt(10)
    v_mfma_f32_32x32x16_bf16 v[80:95], v[140:143], v[208:211], v[80:95]
    ds_read_b64_tr_b16 v[132:133], v22 offset:8768
    ds_read_b64_tr_b16 v[134:135], v22 offset:9280
    s_waitcnt lgkmcnt(10)
    v_mfma_f32_32x32x16_bf16 v[96:111], v[144:147], v[212:215], v[96:111]
    ds_read_b64_tr_b16 v[136:137], v23 offset:8704
    ds_read_b64_tr_b16 v[138:139], v23 offset:9216
    s_waitcnt lgkmcnt(10)
    v_mfma_f32_32x32x16_bf16 v[48:63], v[148:151], v[212:215], v[48:63]
    ds_read_b64_tr_b16 v[140:141], v23 offset:8768
    ds_read_b64_tr_b16 v[142:143], v23 offset:9280
    s_waitcnt lgkmcnt(10)
    v_mfma_f32_32x32x16_bf16 v[64:79], v[152:155], v[212:215], v[64:79]
    ds_read_b64_tr_b16 v[144:145], v22 offset:13056
    ds_read_b64_tr_b16 v[146:147], v22 offset:13568
    s_waitcnt lgkmcnt(10)
    v_mfma_f32_32x32x16_bf16 v[80:95], v[156:159], v[212:215], v[80:95]
    ds_read_b64_tr_b16 v[148:149], v22 offset:13120
    ds_read_b64_tr_b16 v[150:151], v22 offset:13632
    s_waitcnt lgkmcnt(10)
    v_mfma_f32_32x32x16_bf16 v[96:111], v[128:131], v[216:219], v[96:111]
    ds_read_b64_tr_b16 v[152:153], v23 offset:13056
    ds_read_b64_tr_b16 v[154:155], v23 offset:13568
    s_waitcnt lgkmcnt(10)
    v_mfma_f32_32x32x16_bf16 v[48:63], v[132:135], v[216:219], v[48:63]
    ds_read_b64_tr_b16 v[156:157], v23 offset:13120
    ds_read_b64_tr_b16 v[158:159], v23 offset:13632
    s_waitcnt lgkmcnt(10)
    v_mfma_f32_32x32x16_bf16 v[64:79], v[136:139], v[216:219], v[64:79]
    s_waitcnt lgkmcnt(8)
    v_mfma_f32_32x32x16_bf16 v[80:95], v[140:143], v[216:219], v[80:95]
    s_waitcnt lgkmcnt(6)
    v_mfma_f32_32x32x16_bf16 v[96:111], v[144:147], v[220:223], v[96:111]
    s_waitcnt lgkmcnt(4)
    v_mfma_f32_32x32x16_bf16 v[48:63], v[148:151], v[220:223], v[48:63]
    s_waitcnt lgkmcnt(2)
    v_mfma_f32_32x32x16_bf16 v[64:79], v[152:155], v[220:223], v[64:79]
    s_waitcnt lgkmcnt(0)
    v_mfma_f32_32x32x16_bf16 v[80:95], v[156:159], v[220:223], v[80:95]
    s_barrier
    s_setprio 0
    s_xor_b32 s70, s64, 4
    s_mul_i32 s70, s70, 6144
    s_add_u32 s70, s70, 104448
    v_add_u32 v6, s70, v18
    s_nop 1
    v_cvt_pk_bf16_f32 v48, v48, v49
    v_cvt_pk_bf16_f32 v49, v50, v51
    v_cvt_pk_bf16_f32 v50, v52, v53
    v_cvt_pk_bf16_f32 v51, v54, v55
    ds_write_b128 v6, v[48:51]
    v_cvt_pk_bf16_f32 v52, v56, v57
    v_cvt_pk_bf16_f32 v53, v58, v59
    v_cvt_pk_bf16_f32 v54, v60, v61
    v_cvt_pk_bf16_f32 v55, v62, v63
    ds_write_b128 v6, v[52:55] offset:1024
    s_xor_b32 s70, s64, 2
    s_mul_i32 s70, s70, 6144
    s_add_u32 s70, s70, 106496
    v_add_u32 v6, s70, v18
    v_cvt_pk_bf16_f32 v64, v64, v65
    v_cvt_pk_bf16_f32 v65, v66, v67
    v_cvt_pk_bf16_f32 v66, v68, v69
    v_cvt_pk_bf16_f32 v67, v70, v71
    ds_write_b128 v6, v[64:67]
    v_cvt_pk_bf16_f32 v68, v72, v73
    v_cvt_pk_bf16_f32 v69, v74, v75
    v_cvt_pk_bf16_f32 v70, v76, v77
    v_cvt_pk_bf16_f32 v71, v78, v79
    ds_write_b128 v6, v[68:71] offset:1024
    s_xor_b32 s70, s64, 6
    s_mul_i32 s70, s70, 6144
    s_add_u32 s70, s70, 108544
    v_add_u32 v6, s70, v18
    v_cvt_pk_bf16_f32 v80, v80, v81
    v_cvt_pk_bf16_f32 v81, v82, v83
    v_cvt_pk_bf16_f32 v82, v84, v85
    v_cvt_pk_bf16_f32 v83, v86, v87
    ds_write_b128 v6, v[80:83]
    v_cvt_pk_bf16_f32 v84, v88, v89
    v_cvt_pk_bf16_f32 v85, v90, v91
    v_cvt_pk_bf16_f32 v86, v92, v93
    v_cvt_pk_bf16_f32 v87, v94, v95
    ds_write_b128 v6, v[84:87] offset:1024
    s_waitcnt vmcnt(0) lgkmcnt(0)
    s_barrier
    s_setprio 1
    s_mul_i32 s70, s82, 52224
    s_add_u32 s70, s70, 34816
    v_add_u32 v22, s70, v16
    v_add_u32 v23, s70, v30
    ds_read_b64_tr_b16 v[128:129], v22
    ds_read_b64_tr_b16 v[130:131], v22 offset:512
    ds_read_b64_tr_b16 v[132:133], v22 offset:64
    ds_read_b64_tr_b16 v[134:135], v22 offset:576
    ds_read_b64_tr_b16 v[136:137], v23
    ds_read_b64_tr_b16 v[138:139], v23 offset:512
    ds_read_b64_tr_b16 v[140:141], v23 offset:64
    ds_read_b64_tr_b16 v[142:143], v23 offset:576
    ds_read_b64_tr_b16 v[144:145], v22 offset:4352
    ds_read_b64_tr_b16 v[146:147], v22 offset:4864
    ds_read_b64_tr_b16 v[148:149], v22 offset:4416
    ds_read_b64_tr_b16 v[150:151], v22 offset:4928
    s_waitcnt lgkmcnt(10)
    v_mfma_f32_32x32x16_bf16 v[32:47], v[128:131], v[160:163], 0
    ds_read_b64_tr_b16 v[152:153], v23 offset:4352
    ds_read_b64_tr_b16 v[154:155], v23 offset:4864
    s_waitcnt lgkmcnt(10)
    v_mfma_f32_32x32x16_bf16 v[48:63], v[132:135], v[160:163], 0
    ds_read_b64_tr_b16 v[156:157], v23 offset:4416
    ds_read_b64_tr_b16 v[158:159], v23 offset:4928
    s_waitcnt lgkmcnt(10)
    v_mfma_f32_32x32x16_bf16 v[64:79], v[136:139], v[160:163], 0
    ds_read_b64_tr_b16 v[128:129], v22 offset:8704
    ds_read_b64_tr_b16 v[130:131], v22 offset:9216
    s_waitcnt lgkmcnt(10)
    v_mfma_f32_32x32x16_bf16 v[80:95], v[140:143], v[160:163], 0
    ds_read_b64_tr_b16 v[132:133], v22 offset:8768
    ds_read_b64_tr_b16 v[134:135], v22 offset:9280
    s_waitcnt lgkmcnt(10)
    v_mfma_f32_32x32x16_bf16 v[32:47], v[144:147], v[164:167], v[32:47]
    ds_read_b64_tr_b16 v[136:137], v23 offset:8704
    ds_read_b64_tr_b16 v[138:139], v23 offset:9216
    s_waitcnt lgkmcnt(10)
    v_mfma_f32_32x32x16_bf16 v[48:63], v[148:151], v[164:167], v[48:63]
    ds_read_b64_tr_b16 v[140:141], v23 offset:8768
    ds_read_b64_tr_b16 v[142:143], v23 offset:9280
    s_waitcnt lgkmcnt(10)
    v_mfma_f32_32x32x16_bf16 v[64:79], v[152:155], v[164:167], v[64:79]
    ds_read_b64_tr_b16 v[144:145], v22 offset:13056
    ds_read_b64_tr_b16 v[146:147], v22 offset:13568
    s_waitcnt lgkmcnt(10)
    v_mfma_f32_32x32x16_bf16 v[80:95], v[156:159], v[164:167], v[80:95]
    ds_read_b64_tr_b16 v[148:149], v22 offset:13120
    ds_read_b64_tr_b16 v[150:151], v22 offset:13632
    s_waitcnt lgkmcnt(10)
    v_mfma_f32_32x32x16_bf16 v[32:47], v[128:131], v[168:171], v[32:47]
    ds_read_b64_tr_b16 v[152:153], v23 offset:13056
    ds_read_b64_tr_b16 v[154:155], v23 offset:13568
    s_waitcnt lgkmcnt(10)
    v_mfma_f32_32x32x16_bf16 v[48:63], v[132:135], v[168:171], v[48:63]
    ds_read_b64_tr_b16 v[156:157], v23 offset:13120
    ds_read_b64_tr_b16 v[158:159], v23 offset:13632
    s_waitcnt lgkmcnt(10)
    v_mfma_f32_32x32x16_bf16 v[64:79], v[136:139], v[168:171], v[64:79]
    s_waitcnt lgkmcnt(8)
    v_mfma_f32_32x32x16_bf16 v[80:95], v[140:143], v[168:171], v[80:95]
    s_waitcnt lgkmcnt(6)
    v_mfma_f32_32x32x16_bf16 v[32:47], v[144:147], v[172:175], v[32:47]
    s_waitcnt lgkmcnt(4)
    v_mfma_f32_32x32x16_bf16 v[48:63], v[148:151], v[172:175], v[48:63]
    s_waitcnt lgkmcnt(2)
    v_mfma_f32_32x32x16_bf16 v[64:79], v[152:155], v[172:175], v[64:79]
    s_waitcnt lgkmcnt(0)
    v_mfma_f32_32x32x16_bf16 v[80:95], v[156:159], v[172:175], v[80:95]
    s_add_u32 m0, s65, 0
    s_add_u32 s69, s24, 256
    buffer_load_dwordx4 v4, s[40:43], s69 offen nt lds
    s_add_u32 m0, s65, 4352
    s_add_u32 s69, s24, 8448
    buffer_load_dwordx4 v4, s[40:43], s69 offen nt lds
    s_add_u32 m0, s65, 8704
    s_add_u32 s69, s25, 256
    buffer_load_dwordx4 v4, s[40:43], s69 offen nt lds
    s_add_u32 m0, s65, 13056
    s_add_u32 s69, s25, 8448
    buffer_load_dwordx4 v4, s[40:43], s69 offen nt lds
    s_add_u32 m0, s65, 69632
    s_add_u32 s69, s24, 16640
    buffer_load_dwordx4 v4, s[40:43], s69 offen nt lds
    s_add_u32 m0, s65, 73984
    s_add_u32 s69, s24, 24832
    buffer_load_dwordx4 v4, s[40:43], s69 offen nt lds
    s_add_u32 m0, s65, 78336
    s_add_u32 s69, s25, 16640
    buffer_load_dwordx4 v4, s[40:43], s69 offen nt lds
    s_add_u32 m0, s65, 82688
    s_add_u32 s69, s25, 24832
    buffer_load_dwordx4 v4, s[40:43], s69 offen nt lds
    s_barrier
    s_setprio 0
    ds_read_b128 v[232:235], v31
    ds_read_b128 v[240:243], v31 offset:2048
    ds_read_b128 v[248:251], v31 offset:4096
    ds_read_b128 v[236:239], v31 offset:1024
    ds_read_b128 v[244:247], v31 offset:3072
    ds_read_b128 v[252:255], v31 offset:5120
    v_mul_f32 v96, v13, v96
    v_mul_f32 v97, v13, v97
    v_mul_f32 v98, v13, v98
    v_mul_f32 v99, v13, v99
    v_mul_f32 v100, v13, v100
    v_mul_f32 v101, v13, v101
    v_mul_f32 v102, v13, v102
    v_mul_f32 v103, v13, v103
    v_mul_f32 v104, v13, v104
    v_mul_f32 v105, v13, v105
    v_mul_f32 v106, v13, v106
    v_mul_f32 v107, v13, v107
    v_mul_f32 v108, v13, v108
    v_mul_f32 v109, v13, v109
    v_mul_f32 v110, v13, v110
    v_mul_f32 v111, v13, v111
    s_waitcnt lgkmcnt(3)
    v_lshlrev_b32 v5, 16, v232
    v_and_b32 v6, 4294901760, v232
    v_fmac_f32 v96, v5, v24
    v_fmac_f32 v97, v6, v24
    v_lshlrev_b32 v5, 16, v240
    v_and_b32 v6, 4294901760, v240
    v_fmac_f32 v96, v5, v25
    v_fmac_f32 v97, v6, v25
    v_lshlrev_b32 v5, 16, v248
    v_and_b32 v6, 4294901760, v248
    v_fmac_f32 v96, v5, v12
    v_fmac_f32 v97, v6, v12
    v_cvt_pk_bf16_f32 v224, v96, v97
    v_lshlrev_b32 v5, 16, v233
    v_and_b32 v6, 4294901760, v233
    v_fmac_f32 v98, v5, v24
    v_fmac_f32 v99, v6, v24
    v_lshlrev_b32 v5, 16, v241
    v_and_b32 v6, 4294901760, v241
    v_fmac_f32 v98, v5, v25
    v_fmac_f32 v99, v6, v25
    v_lshlrev_b32 v5, 16, v249
    v_and_b32 v6, 4294901760, v249
    v_fmac_f32 v98, v5, v12
    v_fmac_f32 v99, v6, v12
    v_cvt_pk_bf16_f32 v225, v98, v99
    v_lshlrev_b32 v5, 16, v234
    v_and_b32 v6, 4294901760, v234
    v_fmac_f32 v100, v5, v24
    v_fmac_f32 v101, v6, v24
    v_lshlrev_b32 v5, 16, v242
    v_and_b32 v6, 4294901760, v242
    v_fmac_f32 v100, v5, v25
    v_fmac_f32 v101, v6, v25
    v_lshlrev_b32 v5, 16, v250
    v_and_b32 v6, 4294901760, v250
    v_fmac_f32 v100, v5, v12
    v_fmac_f32 v101, v6, v12
    v_cvt_pk_bf16_f32 v226, v100, v101
    v_lshlrev_b32 v5, 16, v235
    v_and_b32 v6, 4294901760, v235
    v_fmac_f32 v102, v5, v24
    v_fmac_f32 v103, v6, v24
    v_lshlrev_b32 v5, 16, v243
    v_and_b32 v6, 4294901760, v243
    v_fmac_f32 v102, v5, v25
    v_fmac_f32 v103, v6, v25
    v_lshlrev_b32 v5, 16, v251
    v_and_b32 v6, 4294901760, v251
    v_fmac_f32 v102, v5, v12
    v_fmac_f32 v103, v6, v12
    v_cvt_pk_bf16_f32 v227, v102, v103
    s_waitcnt lgkmcnt(0)
    v_lshlrev_b32 v5, 16, v236
    v_and_b32 v6, 4294901760, v236
    v_fmac_f32 v104, v5, v24
    v_fmac_f32 v105, v6, v24
    v_lshlrev_b32 v5, 16, v244
    v_and_b32 v6, 4294901760, v244
    v_fmac_f32 v104, v5, v25
    v_fmac_f32 v105, v6, v25
    v_lshlrev_b32 v5, 16, v252
    v_and_b32 v6, 4294901760, v252
    v_fmac_f32 v104, v5, v12
    v_fmac_f32 v105, v6, v12
    v_cvt_pk_bf16_f32 v228, v104, v105
    v_lshlrev_b32 v5, 16, v237
    v_and_b32 v6, 4294901760, v237
    v_fmac_f32 v106, v5, v24
    v_fmac_f32 v107, v6, v24
    v_lshlrev_b32 v5, 16, v245
    v_and_b32 v6, 4294901760, v245
    v_fmac_f32 v106, v5, v25
    v_fmac_f32 v107, v6, v25
    v_lshlrev_b32 v5, 16, v253
    v_and_b32 v6, 4294901760, v253
    v_fmac_f32 v106, v5, v12
    v_fmac_f32 v107, v6, v12
    v_cvt_pk_bf16_f32 v229, v106, v107
    v_lshlrev_b32 v5, 16, v238
    v_and_b32 v6, 4294901760, v238
    v_fmac_f32 v108, v5, v24
    v_fmac_f32 v109, v6, v24
    v_lshlrev_b32 v5, 16, v246
    v_and_b32 v6, 4294901760, v246
    v_fmac_f32 v108, v5, v25
    v_fmac_f32 v109, v6, v25
    v_lshlrev_b32 v5, 16, v254
    v_and_b32 v6, 4294901760, v254
    v_fmac_f32 v108, v5, v12
    v_fmac_f32 v109, v6, v12
    v_cvt_pk_bf16_f32 v230, v108, v109
    v_lshlrev_b32 v5, 16, v239
    v_and_b32 v6, 4294901760, v239
    v_fmac_f32 v110, v5, v24
    v_fmac_f32 v111, v6, v24
    v_lshlrev_b32 v5, 16, v247
    v_and_b32 v6, 4294901760, v247
    v_fmac_f32 v110, v5, v25
    v_fmac_f32 v111, v6, v25
    v_lshlrev_b32 v5, 16, v255
    v_and_b32 v6, 4294901760, v255
    v_fmac_f32 v110, v5, v12
    v_fmac_f32 v111, v6, v12
    v_cvt_pk_bf16_f32 v231, v110, v111
    ds_write_b128 v31, v[224:227]
    ds_write_b128 v31, v[228:231] offset:1024
    s_waitcnt vmcnt(0) lgkmcnt(0)
    s_barrier
    s_setprio 1
    s_mul_i32 s70, s82, 69632
    s_add_u32 s70, s70, 0
    v_add_u32 v22, s70, v16
    v_add_u32 v23, s70, v30
    ds_read_b64_tr_b16 v[128:129], v22
    ds_read_b64_tr_b16 v[130:131], v22 offset:512
    ds_read_b64_tr_b16 v[132:133], v22 offset:64
    ds_read_b64_tr_b16 v[134:135], v22 offset:576
    ds_read_b64_tr_b16 v[136:137], v23
    ds_read_b64_tr_b16 v[138:139], v23 offset:512
    ds_read_b64_tr_b16 v[140:141], v23 offset:64
    ds_read_b64_tr_b16 v[142:143], v23 offset:576
    ds_read_b64_tr_b16 v[144:145], v22 offset:4352
    ds_read_b64_tr_b16 v[146:147], v22 offset:4864
    ds_read_b64_tr_b16 v[148:149], v22 offset:4416
    ds_read_b64_tr_b16 v[150:151], v22 offset:4928
    s_waitcnt lgkmcnt(10)
    v_mfma_f32_32x32x16_bf16 v[32:47], v[128:131], v[176:179], v[32:47]
    ds_read_b64_tr_b16 v[152:153], v23 offset:4352
    ds_read_b64_tr_b16 v[154:155], v23 offset:4864
    s_waitcnt lgkmcnt(10)
    v_mfma_f32_32x32x16_bf16 v[48:63], v[132:135], v[176:179], v[48:63]
    ds_read_b64_tr_b16 v[156:157], v23 offset:4416
    ds_read_b64_tr_b16 v[158:159], v23 offset:4928
    s_waitcnt lgkmcnt(10)
    v_mfma_f32_32x32x16_bf16 v[64:79], v[136:139], v[176:179], v[64:79]
    ds_read_b64_tr_b16 v[128:129], v22 offset:8704
    ds_read_b64_tr_b16 v[130:131], v22 offset:9216
    s_waitcnt lgkmcnt(10)
    v_mfma_f32_32x32x16_bf16 v[80:95], v[140:143], v[176:179], v[80:95]
    ds_read_b64_tr_b16 v[132:133], v22 offset:8768
    ds_read_b64_tr_b16 v[134:135], v22 offset:9280
    s_waitcnt lgkmcnt(10)
    v_mfma_f32_32x32x16_bf16 v[32:47], v[144:147], v[180:183], v[32:47]
    ds_read_b64_tr_b16 v[136:137], v23 offset:8704
    ds_read_b64_tr_b16 v[138:139], v23 offset:9216
    s_waitcnt lgkmcnt(10)
    v_mfma_f32_32x32x16_bf16 v[48:63], v[148:151], v[180:183], v[48:63]
    ds_read_b64_tr_b16 v[140:141], v23 offset:8768
    ds_read_b64_tr_b16 v[142:143], v23 offset:9280
    s_waitcnt lgkmcnt(10)
    v_mfma_f32_32x32x16_bf16 v[64:79], v[152:155], v[180:183], v[64:79]
    ds_read_b64_tr_b16 v[144:145], v22 offset:13056
    ds_read_b64_tr_b16 v[146:147], v22 offset:13568
    s_waitcnt lgkmcnt(10)
    v_mfma_f32_32x32x16_bf16 v[80:95], v[156:159], v[180:183], v[80:95]
    ds_read_b64_tr_b16 v[148:149], v22 offset:13120
    ds_read_b64_tr_b16 v[150:151], v22 offset:13632
    s_waitcnt lgkmcnt(10)
    v_mfma_f32_32x32x16_bf16 v[32:47], v[128:131], v[184:187], v[32:47]
    ds_read_b64_tr_b16 v[152:153], v23 offset:13056
    ds_read_b64_tr_b16 v[154:155], v23 offset:13568
    s_waitcnt lgkmcnt(10)
    v_mfma_f32_32x32x16_bf16 v[48:63], v[132:135], v[184:187], v[48:63]
    ds_read_b64_tr_b16 v[156:157], v23 offset:13120
    ds_read_b64_tr_b16 v[158:159], v23 offset:13632
    s_waitcnt lgkmcnt(10)
    v_mfma_f32_32x32x16_bf16 v[64:79], v[136:139], v[184:187], v[64:79]
    s_waitcnt lgkmcnt(8)
    v_mfma_f32_32x32x16_bf16 v[80:95], v[140:143], v[184:187], v[80:95]
    s_waitcnt lgkmcnt(6)
    v_mfma_f32_32x32x16_bf16 v[32:47], v[144:147], v[188:191], v[32:47]
    s_waitcnt lgkmcnt(4)
    v_mfma_f32_32x32x16_bf16 v[48:63], v[148:151], v[188:191], v[48:63]
    s_waitcnt lgkmcnt(2)
    v_mfma_f32_32x32x16_bf16 v[64:79], v[152:155], v[188:191], v[64:79]
    s_waitcnt lgkmcnt(0)
    v_mfma_f32_32x32x16_bf16 v[80:95], v[156:159], v[188:191], v[80:95]
    s_add_u32 m0, s65, 17408
    s_add_u32 s69, s26, 256
    buffer_load_dwordx4 v4, s[40:43], s69 offen nt lds
    s_add_u32 m0, s65, 21760
    s_add_u32 s69, s26, 8448
    buffer_load_dwordx4 v4, s[40:43], s69 offen nt lds
    s_add_u32 m0, s65, 26112
    s_add_u32 s69, s27, 256
    buffer_load_dwordx4 v4, s[40:43], s69 offen nt lds
    s_add_u32 m0, s65, 30464
    s_add_u32 s69, s27, 8448
    buffer_load_dwordx4 v4, s[40:43], s69 offen nt lds
    s_add_u32 m0, s65, 52224
    s_add_u32 s69, s26, 16640
    buffer_load_dwordx4 v4, s[40:43], s69 offen nt lds
    s_add_u32 m0, s65, 56576
    s_add_u32 s69, s26, 24832
    buffer_load_dwordx4 v4, s[40:43], s69 offen nt lds
    s_add_u32 m0, s65, 60928
    s_add_u32 s69, s27, 16640
    buffer_load_dwordx4 v4, s[40:43], s69 offen nt lds
    s_add_u32 m0, s65, 65280
    s_add_u32 s69, s27, 24832
    buffer_load_dwordx4 v4, s[40:43], s69 offen nt lds
    s_barrier
    s_setprio 0
    ds_read_b128 v[96:99], v19
    ds_read_b128 v[100:103], v19 offset:1024
    ds_read_b128 v[104:107], v19 offset:24576
    ds_read_b128 v[108:111], v19 offset:25600
    ds_read_b128 v[112:115], v19 offset:12288
    ds_read_b128 v[116:119], v19 offset:13312
    ds_read_b128 v[120:123], v19 offset:36864
    ds_read_b128 v[124:127], v19 offset:37888
    s_waitcnt vmcnt(0) lgkmcnt(0)
    s_barrier
    s_setprio 1
    s_mul_i32 s70, s82, 34816
    s_add_u32 s70, s70, 17408
    v_add_u32 v22, s70, v16
    v_add_u32 v23, s70, v30
    ds_read_b64_tr_b16 v[128:129], v22
    ds_read_b64_tr_b16 v[130:131], v22 offset:512
    ds_read_b64_tr_b16 v[132:133], v22 offset:64
    ds_read_b64_tr_b16 v[134:135], v22 offset:576
    ds_read_b64_tr_b16 v[136:137], v23
    ds_read_b64_tr_b16 v[138:139], v23 offset:512
    ds_read_b64_tr_b16 v[140:141], v23 offset:64
    ds_read_b64_tr_b16 v[142:143], v23 offset:576
    ds_read_b64_tr_b16 v[144:145], v22 offset:4352
    ds_read_b64_tr_b16 v[146:147], v22 offset:4864
    ds_read_b64_tr_b16 v[148:149], v22 offset:4416
    ds_read_b64_tr_b16 v[150:151], v22 offset:4928
    s_waitcnt lgkmcnt(10)
    v_mfma_f32_32x32x16_bf16 v[32:47], v[128:131], v[192:195], v[32:47]
    ds_read_b64_tr_b16 v[152:153], v23 offset:4352
    ds_read_b64_tr_b16 v[154:155], v23 offset:4864
    s_waitcnt lgkmcnt(10)
    v_mfma_f32_32x32x16_bf16 v[48:63], v[132:135], v[192:195], v[48:63]
    ds_read_b64_tr_b16 v[156:157], v23 offset:4416
    ds_read_b64_tr_b16 v[158:159], v23 offset:4928
    s_waitcnt lgkmcnt(10)
    v_mfma_f32_32x32x16_bf16 v[64:79], v[136:139], v[192:195], v[64:79]
    ds_read_b64_tr_b16 v[128:129], v22 offset:8704
    ds_read_b64_tr_b16 v[130:131], v22 offset:9216
    s_waitcnt lgkmcnt(10)
    v_mfma_f32_32x32x16_bf16 v[80:95], v[140:143], v[192:195], v[80:95]
    ds_read_b64_tr_b16 v[132:133], v22 offset:8768
    ds_read_b64_tr_b16 v[134:135], v22 offset:9280
    s_waitcnt lgkmcnt(10)
    v_mfma_f32_32x32x16_bf16 v[32:47], v[144:147], v[196:199], v[32:47]
    ds_read_b64_tr_b16 v[136:137], v23 offset:8704
    ds_read_b64_tr_b16 v[138:139], v23 offset:9216
    s_waitcnt lgkmcnt(10)
    v_mfma_f32_32x32x16_bf16 v[48:63], v[148:151], v[196:199], v[48:63]
    ds_read_b64_tr_b16 v[140:141], v23 offset:8768
    ds_read_b64_tr_b16 v[142:143], v23 offset:9280
    s_waitcnt lgkmcnt(10)
    v_mfma_f32_32x32x16_bf16 v[64:79], v[152:155], v[196:199], v[64:79]
    ds_read_b64_tr_b16 v[144:145], v22 offset:13056
    ds_read_b64_tr_b16 v[146:147], v22 offset:13568
    s_waitcnt lgkmcnt(10)
    v_mfma_f32_32x32x16_bf16 v[80:95], v[156:159], v[196:199], v[80:95]
    ds_read_b64_tr_b16 v[148:149], v22 offset:13120
    ds_read_b64_tr_b16 v[150:151], v22 offset:13632
    s_waitcnt lgkmcnt(10)
    v_mfma_f32_32x32x16_bf16 v[32:47], v[128:131], v[200:203], v[32:47]
    ds_read_b64_tr_b16 v[152:153], v23 offset:13056
    ds_read_b64_tr_b16 v[154:155], v23 offset:13568
    s_waitcnt lgkmcnt(10)
    v_mfma_f32_32x32x16_bf16 v[48:63], v[132:135], v[200:203], v[48:63]
    ds_read_b64_tr_b16 v[156:157], v23 offset:13120
    ds_read_b64_tr_b16 v[158:159], v23 offset:13632
    s_waitcnt lgkmcnt(10)
    v_mfma_f32_32x32x16_bf16 v[64:79], v[136:139], v[200:203], v[64:79]
    s_waitcnt lgkmcnt(8)
    v_mfma_f32_32x32x16_bf16 v[80:95], v[140:143], v[200:203], v[80:95]
    s_waitcnt lgkmcnt(6)
    v_mfma_f32_32x32x16_bf16 v[32:47], v[144:147], v[204:207], v[32:47]
    s_waitcnt lgkmcnt(4)
    v_mfma_f32_32x32x16_bf16 v[48:63], v[148:151], v[204:207], v[48:63]
    s_waitcnt lgkmcnt(2)
    v_mfma_f32_32x32x16_bf16 v[64:79], v[152:155], v[204:207], v[64:79]
    s_waitcnt lgkmcnt(0)
    v_mfma_f32_32x32x16_bf16 v[80:95], v[156:159], v[204:207], v[80:95]
    s_add_u32 m0, s65, 34816
    s_add_u32 s69, s28, 256
    buffer_load_dwordx4 v4, s[40:43], s69 offen nt lds
    s_add_u32 m0, s65, 39168
    s_add_u32 s69, s28, 8448
    buffer_load_dwordx4 v4, s[40:43], s69 offen nt lds
    s_add_u32 m0, s65, 43520
    s_add_u32 s69, s29, 256
    buffer_load_dwordx4 v4, s[40:43], s69 offen nt lds
    s_add_u32 m0, s65, 47872
    s_add_u32 s69, s29, 8448
    buffer_load_dwordx4 v4, s[40:43], s69 offen nt lds
    s_add_u32 m0, s65, 87040
    s_add_u32 s69, s28, 16640
    buffer_load_dwordx4 v4, s[40:43], s69 offen nt lds
    s_add_u32 m0, s65, 91392
    s_add_u32 s69, s28, 24832
    buffer_load_dwordx4 v4, s[40:43], s69 offen nt lds
    s_add_u32 m0, s65, 95744
    s_add_u32 s69, s29, 16640
    buffer_load_dwordx4 v4, s[40:43], s69 offen nt lds
    s_add_u32 m0, s65, 100096
    s_add_u32 s69, s29, 24832
    buffer_load_dwordx4 v4, s[40:43], s69 offen nt lds
    s_barrier
    s_setprio 0
    s_add_u32 m0, s65, 104448
    s_mov_b32 s69, 0
    buffer_load_dwordx4 v1, s[48:51], s69 offen lds
    s_add_u32 m0, s65, 108800
    s_mov_b32 s69, 28672
    buffer_load_dwordx4 v1, s[48:51], s69 offen lds
    s_add_u32 m0, s65, 113152
    s_mov_b32 s69, 57344
    buffer_load_dwordx4 v1, s[48:51], s69 offen lds
    s_add_u32 m0, s65, 117504
    s_mov_b32 s69, 86016
    buffer_load_dwordx4 v1, s[48:51], s69 offen lds
    s_add_u32 m0, s65, 121856
    s_mov_b32 s69, 128
    buffer_load_dwordx4 v1, s[48:51], s69 offen lds
    s_add_u32 m0, s65, 126208
    s_mov_b32 s69, 28800
    buffer_load_dwordx4 v1, s[48:51], s69 offen lds
    s_add_u32 m0, s65, 130560
    s_mov_b32 s69, 57472
    buffer_load_dwordx4 v1, s[48:51], s69 offen lds
    s_add_u32 m0, s65, 134912
    s_mov_b32 s69, 86144
    buffer_load_dwordx4 v1, s[48:51], s69 offen lds
    s_waitcnt vmcnt(8)
    s_barrier
    s_setprio 1
    s_mul_i32 s70, s82, 52224
    s_add_u32 s70, s70, 34816
    v_add_u32 v22, s70, v16
    v_add_u32 v23, s70, v30
    ds_read_b64_tr_b16 v[128:129], v22
    ds_read_b64_tr_b16 v[130:131], v22 offset:512
    ds_read_b64_tr_b16 v[132:133], v22 offset:64
    ds_read_b64_tr_b16 v[134:135], v22 offset:576
    ds_read_b64_tr_b16 v[136:137], v23
    ds_read_b64_tr_b16 v[138:139], v23 offset:512
    ds_read_b64_tr_b16 v[140:141], v23 offset:64
    ds_read_b64_tr_b16 v[142:143], v23 offset:576
    ds_read_b64_tr_b16 v[144:145], v22 offset:4352
    ds_read_b64_tr_b16 v[146:147], v22 offset:4864
    ds_read_b64_tr_b16 v[148:149], v22 offset:4416
    ds_read_b64_tr_b16 v[150:151], v22 offset:4928
    s_waitcnt lgkmcnt(10)
    v_mfma_f32_32x32x16_bf16 v[32:47], v[128:131], v[208:211], v[32:47]
    ds_read_b64_tr_b16 v[152:153], v23 offset:4352
    ds_read_b64_tr_b16 v[154:155], v23 offset:4864
    s_waitcnt lgkmcnt(10)
    v_mfma_f32_32x32x16_bf16 v[48:63], v[132:135], v[208:211], v[48:63]
    ds_read_b64_tr_b16 v[156:157], v23 offset:4416
    ds_read_b64_tr_b16 v[158:159], v23 offset:4928
    s_waitcnt lgkmcnt(10)
    v_mfma_f32_32x32x16_bf16 v[64:79], v[136:139], v[208:211], v[64:79]
    ds_read_b64_tr_b16 v[128:129], v22 offset:8704
    ds_read_b64_tr_b16 v[130:131], v22 offset:9216
    s_waitcnt lgkmcnt(10)
    v_mfma_f32_32x32x16_bf16 v[80:95], v[140:143], v[208:211], v[80:95]
    ds_read_b64_tr_b16 v[132:133], v22 offset:8768
    ds_read_b64_tr_b16 v[134:135], v22 offset:9280
    s_waitcnt lgkmcnt(10)
    v_mfma_f32_32x32x16_bf16 v[32:47], v[144:147], v[212:215], v[32:47]
    ds_read_b64_tr_b16 v[136:137], v23 offset:8704
    ds_read_b64_tr_b16 v[138:139], v23 offset:9216
    s_waitcnt lgkmcnt(10)
    v_mfma_f32_32x32x16_bf16 v[48:63], v[148:151], v[212:215], v[48:63]
    ds_read_b64_tr_b16 v[140:141], v23 offset:8768
    ds_read_b64_tr_b16 v[142:143], v23 offset:9280
    s_waitcnt lgkmcnt(10)
    v_mfma_f32_32x32x16_bf16 v[64:79], v[152:155], v[212:215], v[64:79]
    ds_read_b64_tr_b16 v[144:145], v22 offset:13056
    ds_read_b64_tr_b16 v[146:147], v22 offset:13568
    s_waitcnt lgkmcnt(10)
    v_mfma_f32_32x32x16_bf16 v[80:95], v[156:159], v[212:215], v[80:95]
    ds_read_b64_tr_b16 v[148:149], v22 offset:13120
    ds_read_b64_tr_b16 v[150:151], v22 offset:13632
    s_waitcnt lgkmcnt(10)
    v_mfma_f32_32x32x16_bf16 v[32:47], v[128:131], v[216:219], v[32:47]
    ds_read_b64_tr_b16 v[152:153], v23 offset:13056
    ds_read_b64_tr_b16 v[154:155], v23 offset:13568
    s_waitcnt lgkmcnt(10)
    v_mfma_f32_32x32x16_bf16 v[48:63], v[132:135], v[216:219], v[48:63]
    ds_read_b64_tr_b16 v[156:157], v23 offset:13120
    ds_read_b64_tr_b16 v[158:159], v23 offset:13632
    s_waitcnt lgkmcnt(10)
    v_mfma_f32_32x32x16_bf16 v[64:79], v[136:139], v[216:219], v[64:79]
    s_waitcnt lgkmcnt(8)
    v_mfma_f32_32x32x16_bf16 v[80:95], v[140:143], v[216:219], v[80:95]
    s_waitcnt lgkmcnt(6)
    v_mfma_f32_32x32x16_bf16 v[32:47], v[144:147], v[220:223], v[32:47]
    s_waitcnt lgkmcnt(4)
    v_mfma_f32_32x32x16_bf16 v[48:63], v[148:151], v[220:223], v[48:63]
    s_waitcnt lgkmcnt(2)
    v_mfma_f32_32x32x16_bf16 v[64:79], v[152:155], v[220:223], v[64:79]
    s_waitcnt lgkmcnt(0)
    v_mfma_f32_32x32x16_bf16 v[80:95], v[156:159], v[220:223], v[80:95]
    s_add_u32 m0, s65, 0
    s_mov_b32 s69, 256
    buffer_load_dwordx4 v1, s[48:51], s69 offen lds
    s_add_u32 m0, s65, 4352
    s_mov_b32 s69, 28928
    buffer_load_dwordx4 v1, s[48:51], s69 offen lds
    s_add_u32 m0, s65, 8704
    s_mov_b32 s69, 57600
    buffer_load_dwordx4 v1, s[48:51], s69 offen lds
    s_add_u32 m0, s65, 13056
    s_mov_b32 s69, 86272
    buffer_load_dwordx4 v1, s[48:51], s69 offen lds
    s_add_u32 m0, s65, 69632
    s_mov_b32 s69, 384
    buffer_load_dwordx4 v1, s[48:51], s69 offen lds
    s_add_u32 m0, s65, 73984
    s_mov_b32 s69, 29056
    buffer_load_dwordx4 v1, s[48:51], s69 offen lds
    s_add_u32 m0, s65, 78336
    s_mov_b32 s69, 57728
    buffer_load_dwordx4 v1, s[48:51], s69 offen lds
    s_add_u32 m0, s65, 82688
    s_mov_b32 s69, 86400
    buffer_load_dwordx4 v1, s[48:51], s69 offen lds
    s_waitcnt vmcnt(12)
    s_barrier
    s_setprio 0
    v_add_u32 v23, 104448, v15
    ds_read_b64_tr_b16 v[128:129], v23
    ds_read_b64_tr_b16 v[130:131], v23 offset:256
    ds_read_b64_tr_b16 v[132:133], v23 offset:512
    ds_read_b64_tr_b16 v[134:135], v23 offset:768
    ds_read_b64_tr_b16 v[136:137], v23 offset:4352
    ds_read_b64_tr_b16 v[138:139], v23 offset:4608
    ds_read_b64_tr_b16 v[140:141], v23 offset:4864
    ds_read_b64_tr_b16 v[142:143], v23 offset:5120
    ds_read_b64_tr_b16 v[144:145], v23 offset:8704
    ds_read_b64_tr_b16 v[146:147], v23 offset:8960
    ds_read_b64_tr_b16 v[148:149], v23 offset:9216
    ds_read_b64_tr_b16 v[150:151], v23 offset:9472
    ds_read_b64_tr_b16 v[152:153], v23 offset:13056
    ds_read_b64_tr_b16 v[154:155], v23 offset:13312
    ds_read_b64_tr_b16 v[156:157], v23 offset:13568
    ds_read_b64_tr_b16 v[158:159], v23 offset:13824
    s_add_u32 m0, s65, 34816
    s_mov_b32 s69, 114688
    buffer_load_dwordx4 v1, s[48:51], s69 offen lds
    s_add_u32 m0, s65, 39168
    s_mov_b32 s69, 143360
    buffer_load_dwordx4 v1, s[48:51], s69 offen lds
    s_add_u32 m0, s65, 43520
    s_mov_b32 s69, 172032
    buffer_load_dwordx4 v1, s[48:51], s69 offen lds
    s_add_u32 m0, s65, 47872
    s_mov_b32 s69, 200704
    buffer_load_dwordx4 v1, s[48:51], s69 offen lds
    s_waitcnt vmcnt(12) lgkmcnt(0)
    s_barrier
    s_setprio 1
    v_add_u32 v23, 121856, v15
    v_mfma_f32_32x32x16_bf16 v[192:207], v[128:131], v[96:99], 0
    ds_read_b64_tr_b16 v[128:129], v23
    ds_read_b64_tr_b16 v[130:131], v23 offset:256
    v_mfma_f32_32x32x16_bf16 v[192:207], v[132:135], v[100:103], v[192:207]
    ds_read_b64_tr_b16 v[132:133], v23 offset:512
    ds_read_b64_tr_b16 v[134:135], v23 offset:768
    v_mfma_f32_32x32x16_bf16 v[192:207], v[136:139], v[104:107], v[192:207]
    ds_read_b64_tr_b16 v[136:137], v23 offset:4352
    ds_read_b64_tr_b16 v[138:139], v23 offset:4608
    v_mfma_f32_32x32x16_bf16 v[192:207], v[140:143], v[108:111], v[192:207]
    ds_read_b64_tr_b16 v[140:141], v23 offset:4864
    ds_read_b64_tr_b16 v[142:143], v23 offset:5120
    v_mfma_f32_32x32x16_bf16 v[192:207], v[144:147], v[112:115], v[192:207]
    ds_read_b64_tr_b16 v[144:145], v23 offset:8704
    ds_read_b64_tr_b16 v[146:147], v23 offset:8960
    v_mfma_f32_32x32x16_bf16 v[192:207], v[148:151], v[116:119], v[192:207]
    ds_read_b64_tr_b16 v[148:149], v23 offset:9216
    ds_read_b64_tr_b16 v[150:151], v23 offset:9472
    v_mfma_f32_32x32x16_bf16 v[192:207], v[152:155], v[120:123], v[192:207]
    ds_read_b64_tr_b16 v[152:153], v23 offset:13056
    ds_read_b64_tr_b16 v[154:155], v23 offset:13312
    v_mfma_f32_32x32x16_bf16 v[192:207], v[156:159], v[124:127], v[192:207]
    ds_read_b64_tr_b16 v[156:157], v23 offset:13568
    ds_read_b64_tr_b16 v[158:159], v23 offset:13824
    s_barrier
    s_setprio 0
    s_waitcnt vmcnt(8) lgkmcnt(0)
    s_barrier
    s_setprio 1
    v_add_u32 v23, 0, v15
    v_mfma_f32_32x32x16_bf16 v[208:223], v[128:131], v[96:99], 0
    ds_read_b64_tr_b16 v[128:129], v23
    ds_read_b64_tr_b16 v[130:131], v23 offset:256
    v_mfma_f32_32x32x16_bf16 v[208:223], v[132:135], v[100:103], v[208:223]
    ds_read_b64_tr_b16 v[132:133], v23 offset:512
    ds_read_b64_tr_b16 v[134:135], v23 offset:768
    v_mfma_f32_32x32x16_bf16 v[208:223], v[136:139], v[104:107], v[208:223]
    ds_read_b64_tr_b16 v[136:137], v23 offset:4352
    ds_read_b64_tr_b16 v[138:139], v23 offset:4608
    v_mfma_f32_32x32x16_bf16 v[208:223], v[140:143], v[108:111], v[208:223]
    ds_read_b64_tr_b16 v[140:141], v23 offset:4864
    ds_read_b64_tr_b16 v[142:143], v23 offset:5120
    v_mfma_f32_32x32x16_bf16 v[208:223], v[144:147], v[112:115], v[208:223]
    ds_read_b64_tr_b16 v[144:145], v23 offset:8704
    ds_read_b64_tr_b16 v[146:147], v23 offset:8960
    v_mfma_f32_32x32x16_bf16 v[208:223], v[148:151], v[116:119], v[208:223]
    ds_read_b64_tr_b16 v[148:149], v23 offset:9216
    ds_read_b64_tr_b16 v[150:151], v23 offset:9472
    v_mfma_f32_32x32x16_bf16 v[208:223], v[152:155], v[120:123], v[208:223]
    ds_read_b64_tr_b16 v[152:153], v23 offset:13056
    ds_read_b64_tr_b16 v[154:155], v23 offset:13312
    v_mfma_f32_32x32x16_bf16 v[208:223], v[156:159], v[124:127], v[208:223]
    ds_read_b64_tr_b16 v[156:157], v23 offset:13568
    ds_read_b64_tr_b16 v[158:159], v23 offset:13824
    s_barrier
    s_setprio 0
    s_add_u32 m0, s65, 87040
    s_mov_b32 s69, 114816
    buffer_load_dwordx4 v1, s[48:51], s69 offen lds
    s_add_u32 m0, s65, 91392
    s_mov_b32 s69, 143488
    buffer_load_dwordx4 v1, s[48:51], s69 offen lds
    s_add_u32 m0, s65, 95744
    s_mov_b32 s69, 172160
    buffer_load_dwordx4 v1, s[48:51], s69 offen lds
    s_add_u32 m0, s65, 100096
    s_mov_b32 s69, 200832
    buffer_load_dwordx4 v1, s[48:51], s69 offen lds
    s_xor_b32 s70, s64, 4
    s_mul_i32 s70, s70, 6144
    s_add_u32 s70, s70, 104448
    v_add_u32 v6, s70, v18
    v_cvt_pk_bf16_f32 v48, v48, v49
    v_cvt_pk_bf16_f32 v49, v50, v51
    v_cvt_pk_bf16_f32 v50, v52, v53
    v_cvt_pk_bf16_f32 v51, v54, v55
    ds_write_b128 v6, v[48:51]
    v_cvt_pk_bf16_f32 v52, v56, v57
    v_cvt_pk_bf16_f32 v53, v58, v59
    v_cvt_pk_bf16_f32 v54, v60, v61
    v_cvt_pk_bf16_f32 v55, v62, v63
    ds_write_b128 v6, v[52:55] offset:1024
    s_xor_b32 s70, s64, 2
    s_mul_i32 s70, s70, 6144
    s_add_u32 s70, s70, 106496
    v_add_u32 v6, s70, v18
    v_cvt_pk_bf16_f32 v64, v64, v65
    v_cvt_pk_bf16_f32 v65, v66, v67
    v_cvt_pk_bf16_f32 v66, v68, v69
    v_cvt_pk_bf16_f32 v67, v70, v71
    ds_write_b128 v6, v[64:67]
    v_cvt_pk_bf16_f32 v68, v72, v73
    v_cvt_pk_bf16_f32 v69, v74, v75
    v_cvt_pk_bf16_f32 v70, v76, v77
    v_cvt_pk_bf16_f32 v71, v78, v79
    ds_write_b128 v6, v[68:71] offset:1024
    s_xor_b32 s70, s64, 6
    s_mul_i32 s70, s70, 6144
    s_add_u32 s70, s70, 108544
    v_add_u32 v6, s70, v18
    v_cvt_pk_bf16_f32 v80, v80, v81
    v_cvt_pk_bf16_f32 v81, v82, v83
    v_cvt_pk_bf16_f32 v82, v84, v85
    v_cvt_pk_bf16_f32 v83, v86, v87
    ds_write_b128 v6, v[80:83]
    v_cvt_pk_bf16_f32 v84, v88, v89
    v_cvt_pk_bf16_f32 v85, v90, v91
    v_cvt_pk_bf16_f32 v86, v92, v93
    v_cvt_pk_bf16_f32 v87, v94, v95
    ds_write_b128 v6, v[84:87] offset:1024
    s_waitcnt vmcnt(8) lgkmcnt(0)
    s_barrier
    s_setprio 1
    v_add_u32 v23, 69632, v15
    v_mfma_f32_32x32x16_bf16 v[48:63], v[128:131], v[96:99], 0
    ds_read_b64_tr_b16 v[128:129], v23
    ds_read_b64_tr_b16 v[130:131], v23 offset:256
    v_mfma_f32_32x32x16_bf16 v[48:63], v[132:135], v[100:103], v[48:63]
    ds_read_b64_tr_b16 v[132:133], v23 offset:512
    ds_read_b64_tr_b16 v[134:135], v23 offset:768
    v_mfma_f32_32x32x16_bf16 v[48:63], v[136:139], v[104:107], v[48:63]
    ds_read_b64_tr_b16 v[136:137], v23 offset:4352
    ds_read_b64_tr_b16 v[138:139], v23 offset:4608
    v_mfma_f32_32x32x16_bf16 v[48:63], v[140:143], v[108:111], v[48:63]
    ds_read_b64_tr_b16 v[140:141], v23 offset:4864
    ds_read_b64_tr_b16 v[142:143], v23 offset:5120
    v_mfma_f32_32x32x16_bf16 v[48:63], v[144:147], v[112:115], v[48:63]
    ds_read_b64_tr_b16 v[144:145], v23 offset:8704
    ds_read_b64_tr_b16 v[146:147], v23 offset:8960
    v_mfma_f32_32x32x16_bf16 v[48:63], v[148:151], v[116:119], v[48:63]
    ds_read_b64_tr_b16 v[148:149], v23 offset:9216
    ds_read_b64_tr_b16 v[150:151], v23 offset:9472
    v_mfma_f32_32x32x16_bf16 v[48:63], v[152:155], v[120:123], v[48:63]
    ds_read_b64_tr_b16 v[152:153], v23 offset:13056
    ds_read_b64_tr_b16 v[154:155], v23 offset:13312
    v_mfma_f32_32x32x16_bf16 v[48:63], v[156:159], v[124:127], v[48:63]
    ds_read_b64_tr_b16 v[156:157], v23 offset:13568
    ds_read_b64_tr_b16 v[158:159], v23 offset:13824
    s_barrier
    s_setprio 0
    s_add_u32 m0, s65, 17408
    s_mov_b32 s69, 114944
    buffer_load_dwordx4 v1, s[48:51], s69 offen lds
    s_add_u32 m0, s65, 21760
    s_mov_b32 s69, 143616
    buffer_load_dwordx4 v1, s[48:51], s69 offen lds
    s_add_u32 m0, s65, 26112
    s_mov_b32 s69, 172288
    buffer_load_dwordx4 v1, s[48:51], s69 offen lds
    s_add_u32 m0, s65, 30464
    s_mov_b32 s69, 200960
    buffer_load_dwordx4 v1, s[48:51], s69 offen lds
    ds_read_b128 v[232:235], v31
    ds_read_b128 v[240:243], v31 offset:2048
    ds_read_b128 v[248:251], v31 offset:4096
    ds_read_b128 v[236:239], v31 offset:1024
    ds_read_b128 v[244:247], v31 offset:3072
    ds_read_b128 v[252:255], v31 offset:5120
    v_mul_f32 v32, v13, v32
    v_mul_f32 v33, v13, v33
    v_mul_f32 v34, v13, v34
    v_mul_f32 v35, v13, v35
    v_mul_f32 v36, v13, v36
    v_mul_f32 v37, v13, v37
    v_mul_f32 v38, v13, v38
    v_mul_f32 v39, v13, v39
    v_mul_f32 v40, v13, v40
    v_mul_f32 v41, v13, v41
    v_mul_f32 v42, v13, v42
    v_mul_f32 v43, v13, v43
    v_mul_f32 v44, v13, v44
    v_mul_f32 v45, v13, v45
    v_mul_f32 v46, v13, v46
    v_mul_f32 v47, v13, v47
    s_waitcnt lgkmcnt(3)
    v_lshlrev_b32 v5, 16, v232
    v_and_b32 v6, 4294901760, v232
    v_fmac_f32 v32, v5, v24
    v_fmac_f32 v33, v6, v24
    v_lshlrev_b32 v5, 16, v240
    v_and_b32 v6, 4294901760, v240
    v_fmac_f32 v32, v5, v25
    v_fmac_f32 v33, v6, v25
    v_lshlrev_b32 v5, 16, v248
    v_and_b32 v6, 4294901760, v248
    v_fmac_f32 v32, v5, v12
    v_fmac_f32 v33, v6, v12
    v_cvt_pk_bf16_f32 v224, v32, v33
    v_lshlrev_b32 v5, 16, v233
    v_and_b32 v6, 4294901760, v233
    v_fmac_f32 v34, v5, v24
    v_fmac_f32 v35, v6, v24
    v_lshlrev_b32 v5, 16, v241
    v_and_b32 v6, 4294901760, v241
    v_fmac_f32 v34, v5, v25
    v_fmac_f32 v35, v6, v25
    v_lshlrev_b32 v5, 16, v249
    v_and_b32 v6, 4294901760, v249
    v_fmac_f32 v34, v5, v12
    v_fmac_f32 v35, v6, v12
    v_cvt_pk_bf16_f32 v225, v34, v35
    v_lshlrev_b32 v5, 16, v234
    v_and_b32 v6, 4294901760, v234
    v_fmac_f32 v36, v5, v24
    v_fmac_f32 v37, v6, v24
    v_lshlrev_b32 v5, 16, v242
    v_and_b32 v6, 4294901760, v242
    v_fmac_f32 v36, v5, v25
    v_fmac_f32 v37, v6, v25
    v_lshlrev_b32 v5, 16, v250
    v_and_b32 v6, 4294901760, v250
    v_fmac_f32 v36, v5, v12
    v_fmac_f32 v37, v6, v12
    v_cvt_pk_bf16_f32 v226, v36, v37
    v_lshlrev_b32 v5, 16, v235
    v_and_b32 v6, 4294901760, v235
    v_fmac_f32 v38, v5, v24
    v_fmac_f32 v39, v6, v24
    v_lshlrev_b32 v5, 16, v243
    v_and_b32 v6, 4294901760, v243
    v_fmac_f32 v38, v5, v25
    v_fmac_f32 v39, v6, v25
    v_lshlrev_b32 v5, 16, v251
    v_and_b32 v6, 4294901760, v251
    v_fmac_f32 v38, v5, v12
    v_fmac_f32 v39, v6, v12
    v_cvt_pk_bf16_f32 v227, v38, v39
    s_waitcnt lgkmcnt(0)
    v_lshlrev_b32 v5, 16, v236
    v_and_b32 v6, 4294901760, v236
    v_fmac_f32 v40, v5, v24
    v_fmac_f32 v41, v6, v24
    v_lshlrev_b32 v5, 16, v244
    v_and_b32 v6, 4294901760, v244
    v_fmac_f32 v40, v5, v25
    v_fmac_f32 v41, v6, v25
    v_lshlrev_b32 v5, 16, v252
    v_and_b32 v6, 4294901760, v252
    v_fmac_f32 v40, v5, v12
    v_fmac_f32 v41, v6, v12
    v_cvt_pk_bf16_f32 v228, v40, v41
    v_lshlrev_b32 v5, 16, v237
    v_and_b32 v6, 4294901760, v237
    v_fmac_f32 v42, v5, v24
    v_fmac_f32 v43, v6, v24
    v_lshlrev_b32 v5, 16, v245
    v_and_b32 v6, 4294901760, v245
    v_fmac_f32 v42, v5, v25
    v_fmac_f32 v43, v6, v25
    v_lshlrev_b32 v5, 16, v253
    v_and_b32 v6, 4294901760, v253
    v_fmac_f32 v42, v5, v12
    v_fmac_f32 v43, v6, v12
    v_cvt_pk_bf16_f32 v229, v42, v43
    v_lshlrev_b32 v5, 16, v238
    v_and_b32 v6, 4294901760, v238
    v_fmac_f32 v44, v5, v24
    v_fmac_f32 v45, v6, v24
    v_lshlrev_b32 v5, 16, v246
    v_and_b32 v6, 4294901760, v246
    v_fmac_f32 v44, v5, v25
    v_fmac_f32 v45, v6, v25
    v_lshlrev_b32 v5, 16, v254
    v_and_b32 v6, 4294901760, v254
    v_fmac_f32 v44, v5, v12
    v_fmac_f32 v45, v6, v12
    v_cvt_pk_bf16_f32 v230, v44, v45
    v_lshlrev_b32 v5, 16, v239
    v_and_b32 v6, 4294901760, v239
    v_fmac_f32 v46, v5, v24
    v_fmac_f32 v47, v6, v24
    v_lshlrev_b32 v5, 16, v247
    v_and_b32 v6, 4294901760, v247
    v_fmac_f32 v46, v5, v25
    v_fmac_f32 v47, v6, v25
    v_lshlrev_b32 v5, 16, v255
    v_and_b32 v6, 4294901760, v255
    v_fmac_f32 v46, v5, v12
    v_fmac_f32 v47, v6, v12
    v_cvt_pk_bf16_f32 v231, v46, v47
    ds_write_b128 v31, v[224:227]
    ds_write_b128 v31, v[228:231] offset:1024
    s_waitcnt vmcnt(8) lgkmcnt(0)
    s_barrier
    s_setprio 1
    v_add_u32 v23, 34816, v15
    v_mfma_f32_32x32x16_bf16 v[64:79], v[128:131], v[96:99], 0
    ds_read_b64_tr_b16 v[128:129], v23
    ds_read_b64_tr_b16 v[130:131], v23 offset:256
    v_mfma_f32_32x32x16_bf16 v[64:79], v[132:135], v[100:103], v[64:79]
    ds_read_b64_tr_b16 v[132:133], v23 offset:512
    ds_read_b64_tr_b16 v[134:135], v23 offset:768
    v_mfma_f32_32x32x16_bf16 v[64:79], v[136:139], v[104:107], v[64:79]
    ds_read_b64_tr_b16 v[136:137], v23 offset:4352
    ds_read_b64_tr_b16 v[138:139], v23 offset:4608
    v_mfma_f32_32x32x16_bf16 v[64:79], v[140:143], v[108:111], v[64:79]
    ds_read_b64_tr_b16 v[140:141], v23 offset:4864
    ds_read_b64_tr_b16 v[142:143], v23 offset:5120
    v_mfma_f32_32x32x16_bf16 v[64:79], v[144:147], v[112:115], v[64:79]
    ds_read_b64_tr_b16 v[144:145], v23 offset:8704
    ds_read_b64_tr_b16 v[146:147], v23 offset:8960
    v_mfma_f32_32x32x16_bf16 v[64:79], v[148:151], v[116:119], v[64:79]
    ds_read_b64_tr_b16 v[148:149], v23 offset:9216
    ds_read_b64_tr_b16 v[150:151], v23 offset:9472
    v_mfma_f32_32x32x16_bf16 v[64:79], v[152:155], v[120:123], v[64:79]
    ds_read_b64_tr_b16 v[152:153], v23 offset:13056
    ds_read_b64_tr_b16 v[154:155], v23 offset:13312
    v_mfma_f32_32x32x16_bf16 v[64:79], v[156:159], v[124:127], v[64:79]
    ds_read_b64_tr_b16 v[156:157], v23 offset:13568
    ds_read_b64_tr_b16 v[158:159], v23 offset:13824
    s_barrier
    s_setprio 0
    ds_read_b128 v[160:163], v19
    ds_read_b128 v[164:167], v19 offset:1024
    ds_read_b128 v[168:171], v19 offset:24576
    ds_read_b128 v[172:175], v19 offset:25600
    ds_read_b128 v[176:179], v19 offset:12288
    ds_read_b128 v[180:183], v19 offset:13312
    ds_read_b128 v[184:187], v19 offset:36864
    ds_read_b128 v[188:191], v19 offset:37888
    s_add_u32 m0, s65, 52224
    s_mov_b32 s69, 115072
    buffer_load_dwordx4 v1, s[48:51], s69 offen lds
    s_add_u32 m0, s65, 56576
    s_mov_b32 s69, 143744
    buffer_load_dwordx4 v1, s[48:51], s69 offen lds
    s_add_u32 m0, s65, 60928
    s_mov_b32 s69, 172416
    buffer_load_dwordx4 v1, s[48:51], s69 offen lds
    s_add_u32 m0, s65, 65280
    s_mov_b32 s69, 201088
    buffer_load_dwordx4 v1, s[48:51], s69 offen lds
    s_waitcnt vmcnt(8) lgkmcnt(0)
    s_barrier
    s_setprio 1
    v_add_u32 v23, 87040, v15
    v_mfma_f32_32x32x16_bf16 v[192:207], v[128:131], v[160:163], v[192:207]
    ds_read_b64_tr_b16 v[128:129], v23
    ds_read_b64_tr_b16 v[130:131], v23 offset:256
    v_mfma_f32_32x32x16_bf16 v[192:207], v[132:135], v[164:167], v[192:207]
    ds_read_b64_tr_b16 v[132:133], v23 offset:512
    ds_read_b64_tr_b16 v[134:135], v23 offset:768
    v_mfma_f32_32x32x16_bf16 v[192:207], v[136:139], v[168:171], v[192:207]
    ds_read_b64_tr_b16 v[136:137], v23 offset:4352
    ds_read_b64_tr_b16 v[138:139], v23 offset:4608
    v_mfma_f32_32x32x16_bf16 v[192:207], v[140:143], v[172:175], v[192:207]
    ds_read_b64_tr_b16 v[140:141], v23 offset:4864
    ds_read_b64_tr_b16 v[142:143], v23 offset:5120
    v_mfma_f32_32x32x16_bf16 v[192:207], v[144:147], v[176:179], v[192:207]
    ds_read_b64_tr_b16 v[144:145], v23 offset:8704
    ds_read_b64_tr_b16 v[146:147], v23 offset:8960
    v_mfma_f32_32x32x16_bf16 v[192:207], v[148:151], v[180:183], v[192:207]
    ds_read_b64_tr_b16 v[148:149], v23 offset:9216
    ds_read_b64_tr_b16 v[150:151], v23 offset:9472
    v_mfma_f32_32x32x16_bf16 v[192:207], v[152:155], v[184:187], v[192:207]
    ds_read_b64_tr_b16 v[152:153], v23 offset:13056
    ds_read_b64_tr_b16 v[154:155], v23 offset:13312
    v_mfma_f32_32x32x16_bf16 v[192:207], v[156:159], v[188:191], v[192:207]
    ds_read_b64_tr_b16 v[156:157], v23 offset:13568
    ds_read_b64_tr_b16 v[158:159], v23 offset:13824
    s_barrier
    s_setprio 0
    s_mov_b32 s69, 0
    s_nop 6
    v_cvt_pk_bf16_f32 v232, v192, v193
    v_cvt_pk_bf16_f32 v233, v194, v195
    v_cvt_pk_bf16_f32 v234, v196, v197
    v_cvt_pk_bf16_f32 v235, v198, v199
    buffer_store_dwordx4 v[232:235], v21, s[52:55], s69 offen sc1
    v_cvt_pk_bf16_f32 v236, v200, v201
    v_cvt_pk_bf16_f32 v237, v202, v203
    v_cvt_pk_bf16_f32 v238, v204, v205
    v_cvt_pk_bf16_f32 v239, v206, v207
    buffer_store_dwordx4 v[236:239], v21, s[52:55], s69 offen offset:1024 sc1
    s_waitcnt vmcnt(6) lgkmcnt(0)
    s_barrier
    s_setprio 1
    v_add_u32 v23, 17408, v15
    v_mfma_f32_32x32x16_bf16 v[208:223], v[128:131], v[160:163], v[208:223]
    ds_read_b64_tr_b16 v[128:129], v23
    ds_read_b64_tr_b16 v[130:131], v23 offset:256
    v_mfma_f32_32x32x16_bf16 v[208:223], v[132:135], v[164:167], v[208:223]
    ds_read_b64_tr_b16 v[132:133], v23 offset:512
    ds_read_b64_tr_b16 v[134:135], v23 offset:768
    v_mfma_f32_32x32x16_bf16 v[208:223], v[136:139], v[168:171], v[208:223]
    ds_read_b64_tr_b16 v[136:137], v23 offset:4352
    ds_read_b64_tr_b16 v[138:139], v23 offset:4608
    v_mfma_f32_32x32x16_bf16 v[208:223], v[140:143], v[172:175], v[208:223]
    ds_read_b64_tr_b16 v[140:141], v23 offset:4864
    ds_read_b64_tr_b16 v[142:143], v23 offset:5120
    v_mfma_f32_32x32x16_bf16 v[208:223], v[144:147], v[176:179], v[208:223]
    ds_read_b64_tr_b16 v[144:145], v23 offset:8704
    ds_read_b64_tr_b16 v[146:147], v23 offset:8960
    v_mfma_f32_32x32x16_bf16 v[208:223], v[148:151], v[180:183], v[208:223]
    ds_read_b64_tr_b16 v[148:149], v23 offset:9216
    ds_read_b64_tr_b16 v[150:151], v23 offset:9472
    v_mfma_f32_32x32x16_bf16 v[208:223], v[152:155], v[184:187], v[208:223]
    ds_read_b64_tr_b16 v[152:153], v23 offset:13056
    ds_read_b64_tr_b16 v[154:155], v23 offset:13312
    v_mfma_f32_32x32x16_bf16 v[208:223], v[156:159], v[188:191], v[208:223]
    ds_read_b64_tr_b16 v[156:157], v23 offset:13568
    ds_read_b64_tr_b16 v[158:159], v23 offset:13824
    s_barrier
    s_setprio 0
    s_mov_b32 s69, 8192
    s_nop 6
    v_cvt_pk_bf16_f32 v224, v208, v209
    v_cvt_pk_bf16_f32 v225, v210, v211
    v_cvt_pk_bf16_f32 v226, v212, v213
    v_cvt_pk_bf16_f32 v227, v214, v215
    buffer_store_dwordx4 v[224:227], v21, s[52:55], s69 offen sc1
    v_cvt_pk_bf16_f32 v228, v216, v217
    v_cvt_pk_bf16_f32 v229, v218, v219
    v_cvt_pk_bf16_f32 v230, v220, v221
    v_cvt_pk_bf16_f32 v231, v222, v223
    buffer_store_dwordx4 v[228:231], v21, s[52:55], s69 offen offset:1024 sc1
    s_waitcnt vmcnt(4) lgkmcnt(0)
    s_barrier
    s_setprio 1
    v_add_u32 v23, 52224, v15
    v_mfma_f32_32x32x16_bf16 v[48:63], v[128:131], v[160:163], v[48:63]
    ds_read_b64_tr_b16 v[128:129], v23
    ds_read_b64_tr_b16 v[130:131], v23 offset:256
    v_mfma_f32_32x32x16_bf16 v[48:63], v[132:135], v[164:167], v[48:63]
    ds_read_b64_tr_b16 v[132:133], v23 offset:512
    ds_read_b64_tr_b16 v[134:135], v23 offset:768
    v_mfma_f32_32x32x16_bf16 v[48:63], v[136:139], v[168:171], v[48:63]
    ds_read_b64_tr_b16 v[136:137], v23 offset:4352
    ds_read_b64_tr_b16 v[138:139], v23 offset:4608
    v_mfma_f32_32x32x16_bf16 v[48:63], v[140:143], v[172:175], v[48:63]
    ds_read_b64_tr_b16 v[140:141], v23 offset:4864
    ds_read_b64_tr_b16 v[142:143], v23 offset:5120
    v_mfma_f32_32x32x16_bf16 v[48:63], v[144:147], v[176:179], v[48:63]
    ds_read_b64_tr_b16 v[144:145], v23 offset:8704
    ds_read_b64_tr_b16 v[146:147], v23 offset:8960
    v_mfma_f32_32x32x16_bf16 v[48:63], v[148:151], v[180:183], v[48:63]
    ds_read_b64_tr_b16 v[148:149], v23 offset:9216
    ds_read_b64_tr_b16 v[150:151], v23 offset:9472
    v_mfma_f32_32x32x16_bf16 v[48:63], v[152:155], v[184:187], v[48:63]
    ds_read_b64_tr_b16 v[152:153], v23 offset:13056
    ds_read_b64_tr_b16 v[154:155], v23 offset:13312
    v_mfma_f32_32x32x16_bf16 v[48:63], v[156:159], v[188:191], v[48:63]
    ds_read_b64_tr_b16 v[156:157], v23 offset:13568
    ds_read_b64_tr_b16 v[158:159], v23 offset:13824
    s_barrier
    s_setprio 1
    s_mov_b32 s69, 16384
    s_nop 6
    v_cvt_pk_bf16_f32 v232, v48, v49
    v_cvt_pk_bf16_f32 v233, v50, v51
    v_cvt_pk_bf16_f32 v234, v52, v53
    v_cvt_pk_bf16_f32 v235, v54, v55
    buffer_store_dwordx4 v[232:235], v21, s[52:55], s69 offen sc1
    v_cvt_pk_bf16_f32 v236, v56, v57
    v_cvt_pk_bf16_f32 v237, v58, v59
    v_cvt_pk_bf16_f32 v238, v60, v61
    v_cvt_pk_bf16_f32 v239, v62, v63
    buffer_store_dwordx4 v[236:239], v21, s[52:55], s69 offen offset:1024 sc1
    s_waitcnt lgkmcnt(0)
    v_mfma_f32_32x32x16_bf16 v[64:79], v[128:131], v[160:163], v[64:79]
    v_mfma_f32_32x32x16_bf16 v[64:79], v[132:135], v[164:167], v[64:79]
    v_mfma_f32_32x32x16_bf16 v[64:79], v[136:139], v[168:171], v[64:79]
    v_mfma_f32_32x32x16_bf16 v[64:79], v[140:143], v[172:175], v[64:79]
    v_mfma_f32_32x32x16_bf16 v[64:79], v[144:147], v[176:179], v[64:79]
    v_mfma_f32_32x32x16_bf16 v[64:79], v[148:151], v[180:183], v[64:79]
    v_mfma_f32_32x32x16_bf16 v[64:79], v[152:155], v[184:187], v[64:79]
    v_mfma_f32_32x32x16_bf16 v[64:79], v[156:159], v[188:191], v[64:79]
    s_mov_b32 s69, 24576
    s_nop 10
    v_cvt_pk_bf16_f32 v224, v64, v65
    v_cvt_pk_bf16_f32 v225, v66, v67
    v_cvt_pk_bf16_f32 v226, v68, v69
    v_cvt_pk_bf16_f32 v227, v70, v71
    buffer_store_dwordx4 v[224:227], v21, s[52:55], s69 offen sc1
    v_cvt_pk_bf16_f32 v228, v72, v73
    v_cvt_pk_bf16_f32 v229, v74, v75
    v_cvt_pk_bf16_f32 v230, v76, v77
    v_cvt_pk_bf16_f32 v231, v78, v79
    buffer_store_dwordx4 v[228:231], v21, s[52:55], s69 offen offset:1024 sc1
    s_branch L_TAIL
L_RARE:
    s_nop 3
    v_mov_b32 v6, v5
    s_nop 1
    v_permlane32_swap_b32 v5, v6
    v_max_f32 v5, v5, v6
    v_mul_f32 v5, s68, v5
    v_ceil_f32 v5, v5
    v_max_f32 v5, v5, v8
    v_sub_f32 v6, v5, v8
    v_mov_b32 v8, v5
    v_add_f32 v5, 1090519040, v8
    v_mul_f32 v7, 1093759512, v5
    v_min_f32 v6, 1132396544, v6
    v_cvt_i32_f32 v6, v6
    v_sub_u32 v5, 0, v6
    v_ldexp_f32 v9, v9, v5
    v_ldexp_f32 v12, v12, v5
    v_mul_u32_u24 v6, 8388736, v6
    v_pk_sub_u16 v160, v160, v6 clamp
    v_pk_sub_u16 v161, v161, v6 clamp
    v_pk_sub_u16 v162, v162, v6 clamp
    v_pk_sub_u16 v163, v163, v6 clamp
    v_pk_sub_u16 v164, v164, v6 clamp
    v_pk_sub_u16 v165, v165, v6 clamp
    v_pk_sub_u16 v166, v166, v6 clamp
    v_pk_sub_u16 v167, v167, v6 clamp
    v_pk_sub_u16 v168, v168, v6 clamp
    v_pk_sub_u16 v169, v169, v6 clamp
    v_pk_sub_u16 v170, v170, v6 clamp
    v_pk_sub_u16 v171, v171, v6 clamp
    v_pk_sub_u16 v172, v172, v6 clamp
    v_pk_sub_u16 v173, v173, v6 clamp
    v_pk_sub_u16 v174, v174, v6 clamp
    v_pk_sub_u16 v175, v175, v6 clamp
    v_pk_sub_u16 v176, v176, v6 clamp
    v_pk_sub_u16 v177, v177, v6 clamp
    v_pk_sub_u16 v178, v178, v6 clamp
    v_pk_sub_u16 v179, v179, v6 clamp
    v_pk_sub_u16 v180, v180, v6 clamp
    v_pk_sub_u16 v181, v181, v6 clamp
    v_pk_sub_u16 v182, v182, v6 clamp
    v_pk_sub_u16 v183, v183, v6 clamp
    v_pk_sub_u16 v184, v184, v6 clamp
    v_pk_sub_u16 v185, v185, v6 clamp
    v_pk_sub_u16 v186, v186, v6 clamp
    v_pk_sub_u16 v187, v187, v6 clamp
    v_pk_sub_u16 v188, v188, v6 clamp
    v_pk_sub_u16 v189, v189, v6 clamp
    v_pk_sub_u16 v190, v190, v6 clamp
    v_pk_sub_u16 v191, v191, v6 clamp
    v_pk_sub_u16 v192, v192, v6 clamp
    v_pk_sub_u16 v193, v193, v6 clamp
    v_pk_sub_u16 v194, v194, v6 clamp
    v_pk_sub_u16 v195, v195, v6 clamp
    v_pk_sub_u16 v196, v196, v6 clamp
    v_pk_sub_u16 v197, v197, v6 clamp
    v_pk_sub_u16 v198, v198, v6 clamp
    v_pk_sub_u16 v199, v199, v6 clamp
    v_pk_sub_u16 v200, v200, v6 clamp
    v_pk_sub_u16 v201, v201, v6 clamp
    v_pk_sub_u16 v202, v202, v6 clamp
    v_pk_sub_u16 v203, v203, v6 clamp
    v_pk_sub_u16 v204, v204, v6 clamp
    v_pk_sub_u16 v205, v205, v6 clamp
    v_pk_sub_u16 v206, v206, v6 clamp
    v_pk_sub_u16 v207, v207, v6 clamp
    v_pk_sub_u16 v208, v208, v6 clamp
    v_pk_sub_u16 v209, v209, v6 clamp
    v_pk_sub_u16 v210, v210, v6 clamp
    v_pk_sub_u16 v211, v211, v6 clamp
    v_pk_sub_u16 v212, v212, v6 clamp
    v_pk_sub_u16 v213, v213, v6 clamp
    v_pk_sub_u16 v214, v214, v6 clamp
    v_pk_sub_u16 v215, v215, v6 clamp
    v_pk_sub_u16 v216, v216, v6 clamp
    v_pk_sub_u16 v217, v217, v6 clamp
    v_pk_sub_u16 v218, v218, v6 clamp
    v_pk_sub_u16 v219, v219, v6 clamp
    v_pk_sub_u16 v220, v220, v6 clamp
    v_pk_sub_u16 v221, v221, v6 clamp
    v_pk_sub_u16 v222, v222, v6 clamp
    v_pk_sub_u16 v223, v223, v6 clamp
    s_nop 1
    s_setpc_b64 s[72:73]
L_MAIN_1:
    s_nop 1
    s_waitcnt vmcnt(8)
    s_barrier
    s_setprio 0
    v_add_u32 v22, 69632, v14
    ds_read_b128 v[128:131], v20
    ds_read_b128 v[132:135], v20 offset:32
    ds_read_b128 v[136:139], v20 offset:64
    ds_read_b128 v[140:143], v20 offset:96
    ds_read_b64_tr_b16 v[96:97], v22
    ds_read_b64_tr_b16 v[98:99], v22 offset:4352
    ds_read_b64_tr_b16 v[100:101], v22 offset:64
    ds_read_b64_tr_b16 v[102:103], v22 offset:4416
    ds_read_b64_tr_b16 v[104:105], v22 offset:256
    ds_read_b64_tr_b16 v[106:107], v22 offset:4608
    ds_read_b64_tr_b16 v[108:109], v22 offset:320
    ds_read_b64_tr_b16 v[110:111], v22 offset:4672
    ds_read_b64_tr_b16 v[112:113], v22 offset:512
    ds_read_b64_tr_b16 v[114:115], v22 offset:4864
    ds_read_b64_tr_b16 v[116:117], v22 offset:576
    ds_read_b64_tr_b16 v[118:119], v22 offset:4928
    ds_read_b64_tr_b16 v[120:121], v22 offset:768
    ds_read_b64_tr_b16 v[122:123], v22 offset:5120
    ds_read_b64_tr_b16 v[124:125], v22 offset:832
    ds_read_b64_tr_b16 v[126:127], v22 offset:5184
    v_add_co_u32 v10, vcc, 1, v10
    s_nop 1
    v_addc_co_u32 v11, vcc, 0, v11, vcc
    ds_read_b128 v[144:147], v20 offset:128
    ds_read_b128 v[148:151], v20 offset:160
    ds_read_b128 v[152:155], v20 offset:192
    ds_read_b128 v[156:159], v20 offset:224
    ds_read_b128 v[160:163], v20 offset:256
    ds_read_b128 v[164:167], v20 offset:288
    ds_read_b128 v[168:171], v20 offset:320
    s_waitcnt vmcnt(4) lgkmcnt(7)
    s_barrier
    s_setprio 1
    v_add_u32 v22, 104448, v14
    v_mfma_f32_32x32x16_bf16 v[32:47], v[96:99], v[128:131], 0
    ds_read_b64_tr_b16 v[96:97], v22
    ds_read_b64_tr_b16 v[98:99], v22 offset:4352
    v_mfma_f32_32x32x16_bf16 v[48:63], v[100:103], v[128:131], 0
    ds_read_b64_tr_b16 v[100:101], v22 offset:64
    ds_read_b64_tr_b16 v[102:103], v22 offset:4416
    v_mfma_f32_32x32x16_bf16 v[32:47], v[104:107], v[132:135], v[32:47]
    ds_read_b64_tr_b16 v[104:105], v22 offset:256
    ds_read_b64_tr_b16 v[106:107], v22 offset:4608
    v_mfma_f32_32x32x16_bf16 v[48:63], v[108:111], v[132:135], v[48:63]
    ds_read_b64_tr_b16 v[108:109], v22 offset:320
    ds_read_b64_tr_b16 v[110:111], v22 offset:4672
    v_mfma_f32_32x32x16_bf16 v[32:47], v[112:115], v[136:139], v[32:47]
    ds_read_b64_tr_b16 v[112:113], v22 offset:512
    ds_read_b64_tr_b16 v[114:115], v22 offset:4864
    v_mfma_f32_32x32x16_bf16 v[48:63], v[116:119], v[136:139], v[48:63]
    ds_read_b64_tr_b16 v[116:117], v22 offset:576
    ds_read_b64_tr_b16 v[118:119], v22 offset:4928
    v_mfma_f32_32x32x16_bf16 v[32:47], v[120:123], v[140:143], v[32:47]
    ds_read_b64_tr_b16 v[120:121], v22 offset:768
    ds_read_b64_tr_b16 v[122:123], v22 offset:5120
    v_mfma_f32_32x32x16_bf16 v[48:63], v[124:127], v[140:143], v[48:63]
    ds_read_b64_tr_b16 v[124:125], v22 offset:832
    ds_read_b64_tr_b16 v[126:127], v22 offset:5184
    s_barrier
    s_setprio 0
    s_add_u32 m0, s65, 87040
    s_add_u32 s69, s30, 0
    buffer_load_dwordx4 v2, s[44:47], s69 offen lds
    s_add_u32 m0, s65, 91392
    s_add_u32 s69, s30, 32768
    buffer_load_dwordx4 v2, s[44:47], s69 offen lds
    s_add_u32 m0, s65, 95744
    s_add_u32 s69, s30, 65536
    buffer_load_dwordx4 v2, s[44:47], s69 offen lds
    s_add_u32 m0, s65, 100096
    s_add_u32 s69, s30, 98304
    buffer_load_dwordx4 v2, s[44:47], s69 offen lds
    s_add_u32 s30, s30, 524288
    s_cmp_eq_u32 s30, 3670016
    s_cselect_b32 s30, 0, s30
    ds_read_b128 v[172:175], v20 offset:352
    ds_read_b128 v[176:179], v20 offset:384
    ds_read_b128 v[180:183], v20 offset:416
    ds_read_b128 v[184:187], v20 offset:448
    ds_read_b128 v[188:191], v20 offset:480
    ds_read_b128 v[192:195], v20 offset:512
    ds_read_b128 v[196:199], v20 offset:544
    s_waitcnt vmcnt(4) lgkmcnt(7)
    s_barrier
    s_setprio 1
    v_add_u32 v22, 139264, v14
    v_mfma_f32_32x32x16_bf16 v[32:47], v[96:99], v[144:147], v[32:47]
    ds_read_b64_tr_b16 v[96:97], v22
    ds_read_b64_tr_b16 v[98:99], v22 offset:4352
    v_mfma_f32_32x32x16_bf16 v[48:63], v[100:103], v[144:147], v[48:63]
    ds_read_b64_tr_b16 v[100:101], v22 offset:64
    ds_read_b64_tr_b16 v[102:103], v22 offset:4416
    v_mfma_f32_32x32x16_bf16 v[32:47], v[104:107], v[148:151], v[32:47]
    ds_read_b64_tr_b16 v[104:105], v22 offset:256
    ds_read_b64_tr_b16 v[106:107], v22 offset:4608
    v_mfma_f32_32x32x16_bf16 v[48:63], v[108:111], v[148:151], v[48:63]
    ds_read_b64_tr_b16 v[108:109], v22 offset:320
    ds_read_b64_tr_b16 v[110:111], v22 offset:4672
    v_mfma_f32_32x32x16_bf16 v[32:47], v[112:115], v[152:155], v[32:47]
    ds_read_b64_tr_b16 v[112:113], v22 offset:512
    ds_read_b64_tr_b16 v[114:115], v22 offset:4864
    v_mfma_f32_32x32x16_bf16 v[48:63], v[116:119], v[152:155], v[48:63]
    ds_read_b64_tr_b16 v[116:117], v22 offset:576
    ds_read_b64_tr_b16 v[118:119], v22 offset:4928
    v_mfma_f32_32x32x16_bf16 v[32:47], v[120:123], v[156:159], v[32:47]
    ds_read_b64_tr_b16 v[120:121], v22 offset:768
    ds_read_b64_tr_b16 v[122:123], v22 offset:5120
    v_mfma_f32_32x32x16_bf16 v[48:63], v[124:127], v[156:159], v[48:63]
    ds_read_b64_tr_b16 v[124:125], v22 offset:832
    ds_read_b64_tr_b16 v[126:127], v22 offset:5184
    s_barrier
    s_setprio 0
    s_add_u32 m0, s65, 121856
    s_add_u32 s69, s30, 0
    buffer_load_dwordx4 v2, s[44:47], s69 offen lds
    s_add_u32 m0, s65, 126208
    s_add_u32 s69, s30, 32768
    buffer_load_dwordx4 v2, s[44:47], s69 offen lds
    s_add_u32 m0, s65, 130560
    s_add_u32 s69, s30, 65536
    buffer_load_dwordx4 v2, s[44:47], s69 offen lds
    s_add_u32 m0, s65, 134912
    s_add_u32 s69, s30, 98304
    buffer_load_dwordx4 v2, s[44:47], s69 offen lds
    s_add_u32 s30, s30, 524288
    s_cmp_eq_u32 s30, 3670016
    s_cselect_b32 s30, 0, s30
    ds_read_b128 v[200:203], v20 offset:576
    ds_read_b128 v[204:207], v20 offset:608
    ds_read_b128 v[208:211], v20 offset:640
    ds_read_b128 v[212:215], v20 offset:672
    ds_read_b128 v[216:219], v20 offset:704
    ds_read_b128 v[220:223], v20 offset:736
    ds_read_b128 v[224:227], v20 offset:768
    s_waitcnt vmcnt(4) lgkmcnt(7)
    s_barrier
    s_setprio 1
    v_add_u32 v22, 87040, v14
    v_mfma_f32_32x32x16_bf16 v[32:47], v[96:99], v[160:163], v[32:47]
    ds_read_b64_tr_b16 v[96:97], v22
    ds_read_b64_tr_b16 v[98:99], v22 offset:4352
    v_mfma_f32_32x32x16_bf16 v[48:63], v[100:103], v[160:163], v[48:63]
    ds_read_b64_tr_b16 v[100:101], v22 offset:64
    ds_read_b64_tr_b16 v[102:103], v22 offset:4416
    v_mfma_f32_32x32x16_bf16 v[32:47], v[104:107], v[164:167], v[32:47]
    ds_read_b64_tr_b16 v[104:105], v22 offset:256
    ds_read_b64_tr_b16 v[106:107], v22 offset:4608
    v_mfma_f32_32x32x16_bf16 v[48:63], v[108:111], v[164:167], v[48:63]
    ds_read_b64_tr_b16 v[108:109], v22 offset:320
    ds_read_b64_tr_b16 v[110:111], v22 offset:4672
    v_mfma_f32_32x32x16_bf16 v[32:47], v[112:115], v[168:171], v[32:47]
    ds_read_b64_tr_b16 v[112:113], v22 offset:512
    ds_read_b64_tr_b16 v[114:115], v22 offset:4864
    v_mfma_f32_32x32x16_bf16 v[48:63], v[116:119], v[168:171], v[48:63]
    ds_read_b64_tr_b16 v[116:117], v22 offset:576
    ds_read_b64_tr_b16 v[118:119], v22 offset:4928
    v_mfma_f32_32x32x16_bf16 v[32:47], v[120:123], v[172:175], v[32:47]
    ds_read_b64_tr_b16 v[120:121], v22 offset:768
    ds_read_b64_tr_b16 v[122:123], v22 offset:5120
    v_mfma_f32_32x32x16_bf16 v[48:63], v[124:127], v[172:175], v[48:63]
    ds_read_b64_tr_b16 v[124:125], v22 offset:832
    ds_read_b64_tr_b16 v[126:127], v22 offset:5184
    s_barrier
    s_setprio 0
    s_add_u32 m0, s65, 69632
    s_add_u32 s69, s30, 0
    buffer_load_dwordx4 v2, s[44:47], s69 offen lds
    s_add_u32 m0, s65, 73984
    s_add_u32 s69, s30, 32768
    buffer_load_dwordx4 v2, s[44:47], s69 offen lds
    s_add_u32 m0, s65, 78336
    s_add_u32 s69, s30, 65536
    buffer_load_dwordx4 v2, s[44:47], s69 offen lds
    s_add_u32 m0, s65, 82688
    s_add_u32 s69, s30, 98304
    buffer_load_dwordx4 v2, s[44:47], s69 offen lds
    s_add_u32 s30, s30, 524288
    s_cmp_eq_u32 s30, 3670016
    s_cselect_b32 s30, 0, s30
    ds_read_b128 v[228:231], v20 offset:800
    ds_read_b128 v[232:235], v20 offset:832
    ds_read_b128 v[236:239], v20 offset:864
    s_waitcnt vmcnt(4) lgkmcnt(0)
    s_barrier
    s_setprio 1
    v_add_u32 v22, 121856, v14
    v_mfma_f32_32x32x16_bf16 v[32:47], v[96:99], v[176:179], v[32:47]
    ds_read_b64_tr_b16 v[96:97], v22
    ds_read_b64_tr_b16 v[98:99], v22 offset:4352
    v_mfma_f32_32x32x16_bf16 v[48:63], v[100:103], v[176:179], v[48:63]
    ds_read_b64_tr_b16 v[100:101], v22 offset:64
    ds_read_b64_tr_b16 v[102:103], v22 offset:4416
    v_mfma_f32_32x32x16_bf16 v[32:47], v[104:107], v[180:183], v[32:47]
    ds_read_b64_tr_b16 v[104:105], v22 offset:256
    ds_read_b64_tr_b16 v[106:107], v22 offset:4608
    v_mfma_f32_32x32x16_bf16 v[48:63], v[108:111], v[180:183], v[48:63]
    ds_read_b64_tr_b16 v[108:109], v22 offset:320
    ds_read_b64_tr_b16 v[110:111], v22 offset:4672
    v_mfma_f32_32x32x16_bf16 v[32:47], v[112:115], v[184:187], v[32:47]
    ds_read_b64_tr_b16 v[112:113], v22 offset:512
    ds_read_b64_tr_b16 v[114:115], v22 offset:4864
    v_mfma_f32_32x32x16_bf16 v[48:63], v[116:119], v[184:187], v[48:63]
    ds_read_b64_tr_b16 v[116:117], v22 offset:576
    ds_read_b64_tr_b16 v[118:119], v22 offset:4928
    v_mfma_f32_32x32x16_bf16 v[32:47], v[120:123], v[188:191], v[32:47]
    ds_read_b64_tr_b16 v[120:121], v22 offset:768
    ds_read_b64_tr_b16 v[122:123], v22 offset:5120
    v_mfma_f32_32x32x16_bf16 v[48:63], v[124:127], v[188:191], v[48:63]
    ds_read_b64_tr_b16 v[124:125], v22 offset:832
    ds_read_b64_tr_b16 v[126:127], v22 offset:5184
    s_barrier
    s_setprio 0
    s_add_u32 m0, s65, 34816
    s_add_u32 s69, s30, 0
    buffer_load_dwordx4 v2, s[44:47], s69 offen lds
    s_add_u32 m0, s65, 39168
    s_add_u32 s69, s30, 32768
    buffer_load_dwordx4 v2, s[44:47], s69 offen lds
    s_add_u32 m0, s65, 43520
    s_add_u32 s69, s30, 65536
    buffer_load_dwordx4 v2, s[44:47], s69 offen lds
    s_add_u32 m0, s65, 47872
    s_add_u32 s69, s30, 98304
    buffer_load_dwordx4 v2, s[44:47], s69 offen lds
    s_add_u32 s30, s30, 524288
    s_cmp_eq_u32 s30, 3670016
    s_cselect_b32 s30, 0, s30
    s_add_u32 m0, s66, 104448
    s_add_u32 s69, s22, 0
    buffer_load_dwordx4 v3, s[36:39], s69 offen nt lds
    s_add_u32 m0, s66, 108608
    s_add_u32 s69, s22, 2048
    buffer_load_dwordx4 v3, s[36:39], s69 offen nt lds
    s_add_u32 m0, s66, 112768
    s_add_u32 s69, s22, 4096
    buffer_load_dwordx4 v3, s[36:39], s69 offen nt lds
    s_add_u32 m0, s66, 116928
    s_add_u32 s69, s22, 6144
    buffer_load_dwordx4 v3, s[36:39], s69 offen nt lds
    s_waitcnt vmcnt(8) lgkmcnt(0)
    s_barrier
    s_setprio 1
    v_add_u32 v22, 69632, v14
    v_mfma_f32_32x32x16_bf16 v[32:47], v[96:99], v[192:195], v[32:47]
    ds_read_b64_tr_b16 v[96:97], v22
    ds_read_b64_tr_b16 v[98:99], v22 offset:4352
    v_mfma_f32_32x32x16_bf16 v[48:63], v[100:103], v[192:195], v[48:63]
    ds_read_b64_tr_b16 v[100:101], v22 offset:64
    ds_read_b64_tr_b16 v[102:103], v22 offset:4416
    v_mfma_f32_32x32x16_bf16 v[32:47], v[104:107], v[196:199], v[32:47]
    ds_read_b64_tr_b16 v[104:105], v22 offset:256
    ds_read_b64_tr_b16 v[106:107], v22 offset:4608
    v_mfma_f32_32x32x16_bf16 v[48:63], v[108:111], v[196:199], v[48:63]
    ds_read_b64_tr_b16 v[108:109], v22 offset:320
    ds_read_b64_tr_b16 v[110:111], v22 offset:4672
    v_mfma_f32_32x32x16_bf16 v[32:47], v[112:115], v[200:203], v[32:47]
    ds_read_b64_tr_b16 v[112:113], v22 offset:512
    ds_read_b64_tr_b16 v[114:115], v22 offset:4864
    v_mfma_f32_32x32x16_bf16 v[48:63], v[116:119], v[200:203], v[48:63]
    ds_read_b64_tr_b16 v[116:117], v22 offset:576
    ds_read_b64_tr_b16 v[118:119], v22 offset:4928
    v_mfma_f32_32x32x16_bf16 v[32:47], v[120:123], v[204:207], v[32:47]
    ds_read_b64_tr_b16 v[120:121], v22 offset:768
    ds_read_b64_tr_b16 v[122:123], v22 offset:5120
    v_mfma_f32_32x32x16_bf16 v[48:63], v[124:127], v[204:207], v[48:63]
    ds_read_b64_tr_b16 v[124:125], v22 offset:832
    ds_read_b64_tr_b16 v[126:127], v22 offset:5184
    s_barrier
    s_setprio 0
    s_add_u32 m0, s66, 139264
    s_add_u32 s69, s22, 16384
    buffer_load_dwordx4 v3, s[36:39], s69 offen nt lds
    s_add_u32 m0, s66, 143424
    s_add_u32 s69, s22, 18432
    buffer_load_dwordx4 v3, s[36:39], s69 offen nt lds
    s_add_u32 m0, s66, 147584
    s_add_u32 s69, s22, 20480
    buffer_load_dwordx4 v3, s[36:39], s69 offen nt lds
    s_add_u32 m0, s66, 151744
    s_add_u32 s69, s22, 22528
    buffer_load_dwordx4 v3, s[36:39], s69 offen nt lds
    s_waitcnt vmcnt(8) lgkmcnt(0)
    s_barrier
    s_setprio 1
    v_add_u32 v22, 34816, v14
    v_mfma_f32_32x32x16_bf16 v[32:47], v[96:99], v[208:211], v[32:47]
    ds_read_b64_tr_b16 v[96:97], v22
    ds_read_b64_tr_b16 v[98:99], v22 offset:4352
    v_mfma_f32_32x32x16_bf16 v[48:63], v[100:103], v[208:211], v[48:63]
    ds_read_b64_tr_b16 v[100:101], v22 offset:64
    ds_read_b64_tr_b16 v[102:103], v22 offset:4416
    v_mfma_f32_32x32x16_bf16 v[32:47], v[104:107], v[212:215], v[32:47]
    ds_read_b64_tr_b16 v[104:105], v22 offset:256
    ds_read_b64_tr_b16 v[106:107], v22 offset:4608
    v_mfma_f32_32x32x16_bf16 v[48:63], v[108:111], v[212:215], v[48:63]
    ds_read_b64_tr_b16 v[108:109], v22 offset:320
    ds_read_b64_tr_b16 v[110:111], v22 offset:4672
    v_mfma_f32_32x32x16_bf16 v[32:47], v[112:115], v[216:219], v[32:47]
    ds_read_b64_tr_b16 v[112:113], v22 offset:512
    ds_read_b64_tr_b16 v[114:115], v22 offset:4864
    v_mfma_f32_32x32x16_bf16 v[48:63], v[116:119], v[216:219], v[48:63]
    ds_read_b64_tr_b16 v[116:117], v22 offset:576
    ds_read_b64_tr_b16 v[118:119], v22 offset:4928
    v_mfma_f32_32x32x16_bf16 v[32:47], v[120:123], v[220:223], v[32:47]
    ds_read_b64_tr_b16 v[120:121], v22 offset:768
    ds_read_b64_tr_b16 v[122:123], v22 offset:5120
    v_mfma_f32_32x32x16_bf16 v[48:63], v[124:127], v[220:223], v[48:63]
    ds_read_b64_tr_b16 v[124:125], v22 offset:832
    ds_read_b64_tr_b16 v[126:127], v22 offset:5184
    s_barrier
    s_setprio 0
    s_add_u32 m0, s66, 69632
    s_add_u32 s69, s23, 0
    buffer_load_dwordx4 v3, s[36:39], s69 offen nt lds
    s_add_u32 m0, s66, 73792
    s_add_u32 s69, s23, 2048
    buffer_load_dwordx4 v3, s[36:39], s69 offen nt lds
    s_add_u32 m0, s66, 77952
    s_add_u32 s69, s23, 4096
    buffer_load_dwordx4 v3, s[36:39], s69 offen nt lds
    s_add_u32 m0, s66, 82112
    s_add_u32 s69, s23, 6144
    buffer_load_dwordx4 v3, s[36:39], s69 offen nt lds
    s_waitcnt lgkmcnt(0)
    s_barrier
    s_setprio 1
    v_mfma_f32_32x32x16_bf16 v[32:47], v[96:99], v[224:227], v[32:47]
    v_mfma_f32_32x32x16_bf16 v[48:63], v[100:103], v[224:227], v[48:63]
    v_mfma_f32_32x32x16_bf16 v[32:47], v[104:107], v[228:231], v[32:47]
    v_mfma_f32_32x32x16_bf16 v[48:63], v[108:111], v[228:231], v[48:63]
    v_mfma_f32_32x32x16_bf16 v[32:47], v[112:115], v[232:235], v[32:47]
    v_mfma_f32_32x32x16_bf16 v[48:63], v[116:119], v[232:235], v[48:63]
    v_mfma_f32_32x32x16_bf16 v[32:47], v[120:123], v[236:239], v[32:47]
    v_mfma_f32_32x32x16_bf16 v[48:63], v[124:127], v[236:239], v[48:63]
    s_barrier
    s_setprio 0
    s_mul_i32 s70, s81, 17408
    s_add_u32 s70, s70, 0
    v_add_u32 v25, s70, v18
    s_lshl_b32 s71, s82, 12
    s_add_u32 s70, s70, s71
    v_add_u32 v24, s70, v18
    s_nop 2
    v_cvt_pk_bf16_f32 v64, v32, v33
    v_cvt_pk_bf16_f32 v65, v34, v35
    v_cvt_pk_bf16_f32 v66, v36, v37
    v_cvt_pk_bf16_f32 v67, v38, v39
    ds_write_b128 v24, v[64:67] offset:8192
    v_cvt_pk_bf16_f32 v68, v40, v41
    v_cvt_pk_bf16_f32 v69, v42, v43
    v_cvt_pk_bf16_f32 v70, v44, v45
    v_cvt_pk_bf16_f32 v71, v46, v47
    ds_write_b128 v24, v[68:71] offset:9216
    v_cvt_pk_bf16_f32 v72, v48, v49
    v_cvt_pk_bf16_f32 v73, v50, v51
    v_cvt_pk_bf16_f32 v74, v52, v53
    v_cvt_pk_bf16_f32 v75, v54, v55
    ds_write_b128 v24, v[72:75] offset:10240
    v_cvt_pk_bf16_f32 v76, v56, v57
    v_cvt_pk_bf16_f32 v77, v58, v59
    v_cvt_pk_bf16_f32 v78, v60, v61
    v_cvt_pk_bf16_f32 v79, v62, v63
    ds_write_b128 v24, v[76:79] offset:11264
    s_waitcnt lgkmcnt(0)
    s_barrier
    s_setprio 0
    s_barrier
    s_setprio 0
    ds_read_b128 v[96:99], v25
    ds_read_b128 v[100:103], v25 offset:1024
    ds_read_b128 v[104:107], v25 offset:2048
    ds_read_b128 v[108:111], v25 offset:3072
    ds_read_b128 v[112:115], v25 offset:4096
    ds_read_b128 v[116:119], v25 offset:5120
    ds_read_b128 v[120:123], v25 offset:6144
    ds_read_b128 v[124:127], v25 offset:7168
    ds_read_b128 v[128:131], v25 offset:8192
    ds_read_b128 v[132:135], v25 offset:9216
    ds_read_b128 v[136:139], v25 offset:10240
    ds_read_b128 v[140:143], v25 offset:11264
    ds_read_b128 v[144:147], v25 offset:12288
    ds_read_b128 v[148:151], v25 offset:13312
    ds_read_b128 v[152:155], v25 offset:14336
    ds_read_b128 v[156:159], v25 offset:15360
    s_waitcnt vmcnt(4) lgkmcnt(0)
    s_barrier
    s_setprio 0
    s_add_u32 m0, s66, 0
    s_add_u32 s69, s23, 16384
    buffer_load_dwordx4 v3, s[36:39], s69 offen nt lds
    s_add_u32 m0, s66, 4160
    s_add_u32 s69, s23, 18432
    buffer_load_dwordx4 v3, s[36:39], s69 offen nt lds
    s_add_u32 m0, s66, 8320
    s_add_u32 s69, s23, 20480
    buffer_load_dwordx4 v3, s[36:39], s69 offen nt lds
    s_add_u32 m0, s66, 12480
    s_add_u32 s69, s23, 22528
    buffer_load_dwordx4 v3, s[36:39], s69 offen nt lds
    s_mul_i32 s70, s82, 34816
    s_add_u32 s70, s70, 104448
    v_add_u32 v22, s70, v17
    ds_read_b128 v[64:67], v22
    ds_read_b128 v[68:71], v22 offset:32
    ds_read_b128 v[72:75], v22 offset:64
    ds_read_b128 v[76:79], v22 offset:96
    ds_read_b128 v[80:83], v22 offset:128
    ds_read_b128 v[84:87], v22 offset:160
    s_barrier
    s_setprio 1
    s_waitcnt lgkmcnt(5)
    v_mfma_f32_32x32x16_bf16 v[32:47], v[64:67], v[96:99], 0
    ds_read_b128 v[88:91], v22 offset:192
    s_waitcnt lgkmcnt(5)
    v_mfma_f32_32x32x16_bf16 v[32:47], v[68:71], v[100:103], v[32:47]
    ds_read_b128 v[92:95], v22 offset:224
    s_waitcnt lgkmcnt(5)
    v_mfma_f32_32x32x16_bf16 v[32:47], v[72:75], v[104:107], v[32:47]
    ds_read_b128 v[64:67], v22 offset:256
    s_waitcnt lgkmcnt(5)
    v_mfma_f32_32x32x16_bf16 v[32:47], v[76:79], v[108:111], v[32:47]
    ds_read_b128 v[68:71], v22 offset:288
    s_waitcnt lgkmcnt(5)
    v_mfma_f32_32x32x16_bf16 v[32:47], v[80:83], v[112:115], v[32:47]
    ds_read_b128 v[72:75], v22 offset:320
    s_waitcnt lgkmcnt(5)
    v_mfma_f32_32x32x16_bf16 v[32:47], v[84:87], v[116:119], v[32:47]
    ds_read_b128 v[76:79], v22 offset:352
    s_waitcnt lgkmcnt(5)
    v_mfma_f32_32x32x16_bf16 v[32:47], v[88:91], v[120:123], v[32:47]
    ds_read_b128 v[80:83], v22 offset:384
    s_waitcnt lgkmcnt(5)
    v_mfma_f32_32x32x16_bf16 v[32:47], v[92:95], v[124:127], v[32:47]
    ds_read_b128 v[84:87], v22 offset:416
    s_waitcnt lgkmcnt(5)
    v_mfma_f32_32x32x16_bf16 v[32:47], v[64:67], v[128:131], v[32:47]
    ds_read_b128 v[88:91], v22 offset:448
    s_waitcnt lgkmcnt(5)
    v_mfma_f32_32x32x16_bf16 v[32:47], v[68:71], v[132:135], v[32:47]
    ds_read_b128 v[92:95], v22 offset:480
    s_waitcnt lgkmcnt(5)
    v_mfma_f32_32x32x16_bf16 v[32:47], v[72:75], v[136:139], v[32:47]
    s_waitcnt lgkmcnt(4)
    v_mfma_f32_32x32x16_bf16 v[32:47], v[76:79], v[140:143], v[32:47]
    s_waitcnt lgkmcnt(3)
    v_mfma_f32_32x32x16_bf16 v[32:47], v[80:83], v[144:147], v[32:47]
    s_waitcnt lgkmcnt(2)
    v_mfma_f32_32x32x16_bf16 v[32:47], v[84:87], v[148:151], v[32:47]
    s_waitcnt lgkmcnt(1)
    v_mfma_f32_32x32x16_bf16 v[32:47], v[88:91], v[152:155], v[32:47]
    s_waitcnt lgkmcnt(0)
    v_mfma_f32_32x32x16_bf16 v[32:47], v[92:95], v[156:159], v[32:47]
    s_waitcnt vmcnt(0)
    s_barrier
    s_setprio 0
    s_add_u32 m0, s66, 139264
    s_add_u32 s69, s24, 0
    buffer_load_dwordx4 v3, s[36:39], s69 offen nt lds
    s_add_u32 m0, s66, 143424
    s_add_u32 s69, s24, 2048
    buffer_load_dwordx4 v3, s[36:39], s69 offen nt lds
    s_add_u32 m0, s66, 147584
    s_add_u32 s69, s24, 4096
    buffer_load_dwordx4 v3, s[36:39], s69 offen nt lds
    s_add_u32 m0, s66, 151744
    s_add_u32 s69, s24, 6144
    buffer_load_dwordx4 v3, s[36:39], s69 offen nt lds
    s_add_u32 m0, s66, 104448
    s_add_u32 s69, s24, 16384
    buffer_load_dwordx4 v3, s[36:39], s69 offen nt lds
    s_add_u32 m0, s66, 108608
    s_add_u32 s69, s24, 18432
    buffer_load_dwordx4 v3, s[36:39], s69 offen nt lds
    s_add_u32 m0, s66, 112768
    s_add_u32 s69, s24, 20480
    buffer_load_dwordx4 v3, s[36:39], s69 offen nt lds
    s_add_u32 m0, s66, 116928
    s_add_u32 s69, s24, 22528
    buffer_load_dwordx4 v3, s[36:39], s69 offen nt lds
    v_max3_f32 v5, v32, v33, v34
    v_max3_f32 v6, v35, v36, v37
    v_max3_f32 v5, v5, v38, v39
    v_max3_f32 v6, v6, v40, v41
    v_max3_f32 v5, v5, v42, v43
    v_max3_f32 v6, v6, v44, v45
    v_max3_f32 v5, v5, v46, v47
    v_max_f32 v5, v5, v6
    v_mov_b32 v6, v5
    s_nop 1
    v_permlane32_swap_b32 v5, v6
    v_max_f32 v5, v5, v6
    v_mul_f32 v5, s68, v5
    v_ceil_f32 v8, v5
    v_add_f32 v5, 1090519040, v8
    v_mul_f32 v7, 1093759512, v5
    v_mov_b32 v9, 0
    v_mov_b32 v12, 0
    v_fma_f32 v32, v32, s68, -v8
    v_exp_f32 v32, v32
    v_fma_f32 v33, v33, s68, -v8
    v_exp_f32 v33, v33
    v_add_f32 v9, v9, v32
    v_fma_f32 v34, v34, s68, -v8
    v_exp_f32 v34, v34
    v_add_f32 v12, v12, v33
    v_cvt_pk_bf16_f32 v160, v32, v33
    v_fma_f32 v35, v35, s68, -v8
    v_exp_f32 v35, v35
    v_add_f32 v9, v9, v34
    v_fma_f32 v36, v36, s68, -v8
    v_exp_f32 v36, v36
    v_add_f32 v12, v12, v35
    v_cvt_pk_bf16_f32 v161, v34, v35
    v_fma_f32 v37, v37, s68, -v8
    v_exp_f32 v37, v37
    v_add_f32 v9, v9, v36
    v_fma_f32 v38, v38, s68, -v8
    v_exp_f32 v38, v38
    v_add_f32 v12, v12, v37
    v_cvt_pk_bf16_f32 v162, v36, v37
    v_fma_f32 v39, v39, s68, -v8
    v_exp_f32 v39, v39
    v_add_f32 v9, v9, v38
    v_fma_f32 v40, v40, s68, -v8
    v_exp_f32 v40, v40
    v_add_f32 v12, v12, v39
    v_cvt_pk_bf16_f32 v163, v38, v39
    v_fma_f32 v41, v41, s68, -v8
    v_exp_f32 v41, v41
    v_add_f32 v9, v9, v40
    v_fma_f32 v42, v42, s68, -v8
    v_exp_f32 v42, v42
    v_add_f32 v12, v12, v41
    v_cvt_pk_bf16_f32 v164, v40, v41
    v_fma_f32 v43, v43, s68, -v8
    v_exp_f32 v43, v43
    v_add_f32 v9, v9, v42
    v_fma_f32 v44, v44, s68, -v8
    v_exp_f32 v44, v44
    v_add_f32 v12, v12, v43
    v_cvt_pk_bf16_f32 v165, v42, v43
    v_fma_f32 v45, v45, s68, -v8
    v_exp_f32 v45, v45
    v_add_f32 v9, v9, v44
    v_fma_f32 v46, v46, s68, -v8
    v_exp_f32 v46, v46
    v_add_f32 v12, v12, v45
    v_cvt_pk_bf16_f32 v166, v44, v45
    v_fma_f32 v47, v47, s68, -v8
    v_exp_f32 v47, v47
    v_add_f32 v9, v9, v46
    v_add_f32 v12, v12, v47
    v_cvt_pk_bf16_f32 v167, v46, v47
    s_mul_i32 s70, s82, -69632
    s_add_u32 s70, s70, 69632
    v_add_u32 v22, s70, v17
    ds_read_b128 v[64:67], v22
    ds_read_b128 v[68:71], v22 offset:32
    ds_read_b128 v[72:75], v22 offset:64
    ds_read_b128 v[76:79], v22 offset:96
    ds_read_b128 v[80:83], v22 offset:128
    ds_read_b128 v[84:87], v22 offset:160
    s_barrier
    s_setprio 1
    s_waitcnt lgkmcnt(5)
    v_mfma_f32_32x32x16_bf16 v[48:63], v[64:67], v[96:99], 0
    ds_read_b128 v[88:91], v22 offset:192
    s_waitcnt lgkmcnt(5)
    v_mfma_f32_32x32x16_bf16 v[48:63], v[68:71], v[100:103], v[48:63]
    ds_read_b128 v[92:95], v22 offset:224
    s_waitcnt lgkmcnt(5)
    v_mfma_f32_32x32x16_bf16 v[48:63], v[72:75], v[104:107], v[48:63]
    ds_read_b128 v[64:67], v22 offset:256
    s_waitcnt lgkmcnt(5)
    v_mfma_f32_32x32x16_bf16 v[48:63], v[76:79], v[108:111], v[48:63]
    ds_read_b128 v[68:71], v22 offset:288
    s_waitcnt lgkmcnt(5)
    v_mfma_f32_32x32x16_bf16 v[48:63], v[80:83], v[112:115], v[48:63]
    ds_read_b128 v[72:75], v22 offset:320
    s_waitcnt lgkmcnt(5)
    v_mfma_f32_32x32x16_bf16 v[48:63], v[84:87], v[116:119], v[48:63]
    ds_read_b128 v[76:79], v22 offset:352
    s_waitcnt lgkmcnt(5)
    v_mfma_f32_32x32x16_bf16 v[48:63], v[88:91], v[120:123], v[48:63]
    ds_read_b128 v[80:83], v22 offset:384
    s_waitcnt lgkmcnt(5)
    v_mfma_f32_32x32x16_bf16 v[48:63], v[92:95], v[124:127], v[48:63]
    ds_read_b128 v[84:87], v22 offset:416
    s_waitcnt lgkmcnt(5)
    v_mfma_f32_32x32x16_bf16 v[48:63], v[64:67], v[128:131], v[48:63]
    ds_read_b128 v[88:91], v22 offset:448
    s_waitcnt lgkmcnt(5)
    v_mfma_f32_32x32x16_bf16 v[48:63], v[68:71], v[132:135], v[48:63]
    ds_read_b128 v[92:95], v22 offset:480
    s_waitcnt lgkmcnt(5)
    v_mfma_f32_32x32x16_bf16 v[48:63], v[72:75], v[136:139], v[48:63]
    s_waitcnt lgkmcnt(4)
    v_mfma_f32_32x32x16_bf16 v[48:63], v[76:79], v[140:143], v[48:63]
    s_waitcnt lgkmcnt(3)
    v_mfma_f32_32x32x16_bf16 v[48:63], v[80:83], v[144:147], v[48:63]
    s_waitcnt lgkmcnt(2)
    v_mfma_f32_32x32x16_bf16 v[48:63], v[84:87], v[148:151], v[48:63]
    s_waitcnt lgkmcnt(1)
    v_mfma_f32_32x32x16_bf16 v[48:63], v[88:91], v[152:155], v[48:63]
    s_waitcnt lgkmcnt(0)
    v_mfma_f32_32x32x16_bf16 v[48:63], v[92:95], v[156:159], v[48:63]
    s_waitcnt vmcnt(0)
    s_barrier
    s_setprio 0
    s_add_u32 m0, s66, 69632
    s_add_u32 s69, s25, 0
    buffer_load_dwordx4 v3, s[36:39], s69 offen nt lds
    s_add_u32 m0, s66, 73792
    s_add_u32 s69, s25, 2048
    buffer_load_dwordx4 v3, s[36:39], s69 offen nt lds
    s_add_u32 m0, s66, 77952
    s_add_u32 s69, s25, 4096
    buffer_load_dwordx4 v3, s[36:39], s69 offen nt lds
    s_add_u32 m0, s66, 82112
    s_add_u32 s69, s25, 6144
    buffer_load_dwordx4 v3, s[36:39], s69 offen nt lds
    s_add_u32 m0, s66, 0
    s_add_u32 s69, s25, 16384
    buffer_load_dwordx4 v3, s[36:39], s69 offen nt lds
    s_add_u32 m0, s66, 4160
    s_add_u32 s69, s25, 18432
    buffer_load_dwordx4 v3, s[36:39], s69 offen nt lds
    s_add_u32 m0, s66, 8320
    s_add_u32 s69, s25, 20480
    buffer_load_dwordx4 v3, s[36:39], s69 offen nt lds
    s_add_u32 m0, s66, 12480
    s_add_u32 s69, s25, 22528
    buffer_load_dwordx4 v3, s[36:39], s69 offen nt lds
    v_max3_f32 v5, v48, v49, v50
    v_max3_f32 v6, v51, v52, v53
    v_max3_f32 v5, v5, v54, v55
    v_max3_f32 v6, v6, v56, v57
    v_max3_f32 v5, v5, v58, v59
    v_max3_f32 v6, v6, v60, v61
    v_max3_f32 v5, v5, v62, v63
    v_max_f32 v5, v5, v6
    v_cmp_gt_f32 vcc, v5, v7
    s_cbranch_vccz NR_200001
    s_call_b64 s[72:73], L_RARE
NR_200001:
    v_fma_f32 v48, v48, s68, -v8
    v_exp_f32 v48, v48
    v_fma_f32 v49, v49, s68, -v8
    v_exp_f32 v49, v49
    v_add_f32 v9, v9, v48
    v_fma_f32 v50, v50, s68, -v8
    v_exp_f32 v50, v50
    v_add_f32 v12, v12, v49
    v_cvt_pk_bf16_f32 v168, v48, v49
    v_fma_f32 v51, v51, s68, -v8
    v_exp_f32 v51, v51
    v_add_f32 v9, v9, v50
    v_fma_f32 v52, v52, s68, -v8
    v_exp_f32 v52, v52
    v_add_f32 v12, v12, v51
    v_cvt_pk_bf16_f32 v169, v50, v51
    v_fma_f32 v53, v53, s68, -v8
    v_exp_f32 v53, v53
    v_add_f32 v9, v9, v52
    v_fma_f32 v54, v54, s68, -v8
    v_exp_f32 v54, v54
    v_add_f32 v12, v12, v53
    v_cvt_pk_bf16_f32 v170, v52, v53
    v_fma_f32 v55, v55, s68, -v8
    v_exp_f32 v55, v55
    v_add_f32 v9, v9, v54
    v_fma_f32 v56, v56, s68, -v8
    v_exp_f32 v56, v56
    v_add_f32 v12, v12, v55
    v_cvt_pk_bf16_f32 v171, v54, v55
    v_fma_f32 v57, v57, s68, -v8
    v_exp_f32 v57, v57
    v_add_f32 v9, v9, v56
    v_fma_f32 v58, v58, s68, -v8
    v_exp_f32 v58, v58
    v_add_f32 v12, v12, v57
    v_cvt_pk_bf16_f32 v172, v56, v57
    v_fma_f32 v59, v59, s68, -v8
    v_exp_f32 v59, v59
    v_add_f32 v9, v9, v58
    v_fma_f32 v60, v60, s68, -v8
    v_exp_f32 v60, v60
    v_add_f32 v12, v12, v59
    v_cvt_pk_bf16_f32 v173, v58, v59
    v_fma_f32 v61, v61, s68, -v8
    v_exp_f32 v61, v61
    v_add_f32 v9, v9, v60
    v_fma_f32 v62, v62, s68, -v8
    v_exp_f32 v62, v62
    v_add_f32 v12, v12, v61
    v_cvt_pk_bf16_f32 v174, v60, v61
    v_fma_f32 v63, v63, s68, -v8
    v_exp_f32 v63, v63
    v_add_f32 v9, v9, v62
    v_add_f32 v12, v12, v63
    v_cvt_pk_bf16_f32 v175, v62, v63
    s_mul_i32 s70, s82, -34816
    s_add_u32 s70, s70, 139264
    v_add_u32 v22, s70, v17
    ds_read_b128 v[64:67], v22
    ds_read_b128 v[68:71], v22 offset:32
    ds_read_b128 v[72:75], v22 offset:64
    ds_read_b128 v[76:79], v22 offset:96
    ds_read_b128 v[80:83], v22 offset:128
    ds_read_b128 v[84:87], v22 offset:160
    s_barrier
    s_setprio 1
    s_waitcnt lgkmcnt(5)
    v_mfma_f32_32x32x16_bf16 v[32:47], v[64:67], v[96:99], 0
    ds_read_b128 v[88:91], v22 offset:192
    s_waitcnt lgkmcnt(5)
    v_mfma_f32_32x32x16_bf16 v[32:47], v[68:71], v[100:103], v[32:47]
    ds_read_b128 v[92:95], v22 offset:224
    s_waitcnt lgkmcnt(5)
    v_mfma_f32_32x32x16_bf16 v[32:47], v[72:75], v[104:107], v[32:47]
    ds_read_b128 v[64:67], v22 offset:256
    s_waitcnt lgkmcnt(5)
    v_mfma_f32_32x32x16_bf16 v[32:47], v[76:79], v[108:111], v[32:47]
    ds_read_b128 v[68:71], v22 offset:288
    s_waitcnt lgkmcnt(5)
    v_mfma_f32_32x32x16_bf16 v[32:47], v[80:83], v[112:115], v[32:47]
    ds_read_b128 v[72:75], v22 offset:320
    s_waitcnt lgkmcnt(5)
    v_mfma_f32_32x32x16_bf16 v[32:47], v[84:87], v[116:119], v[32:47]
    ds_read_b128 v[76:79], v22 offset:352
    s_waitcnt lgkmcnt(5)
    v_mfma_f32_32x32x16_bf16 v[32:47], v[88:91], v[120:123], v[32:47]
    ds_read_b128 v[80:83], v22 offset:384
    s_waitcnt lgkmcnt(5)
    v_mfma_f32_32x32x16_bf16 v[32:47], v[92:95], v[124:127], v[32:47]
    ds_read_b128 v[84:87], v22 offset:416
    s_waitcnt lgkmcnt(5)
    v_mfma_f32_32x32x16_bf16 v[32:47], v[64:67], v[128:131], v[32:47]
    ds_read_b128 v[88:91], v22 offset:448
    s_waitcnt lgkmcnt(5)
    v_mfma_f32_32x32x16_bf16 v[32:47], v[68:71], v[132:135], v[32:47]
    ds_read_b128 v[92:95], v22 offset:480
    s_waitcnt lgkmcnt(5)
    v_mfma_f32_32x32x16_bf16 v[32:47], v[72:75], v[136:139], v[32:47]
    s_waitcnt lgkmcnt(4)
    v_mfma_f32_32x32x16_bf16 v[32:47], v[76:79], v[140:143], v[32:47]
    s_waitcnt lgkmcnt(3)
    v_mfma_f32_32x32x16_bf16 v[32:47], v[80:83], v[144:147], v[32:47]
    s_waitcnt lgkmcnt(2)
    v_mfma_f32_32x32x16_bf16 v[32:47], v[84:87], v[148:151], v[32:47]
    s_waitcnt lgkmcnt(1)
    v_mfma_f32_32x32x16_bf16 v[32:47], v[88:91], v[152:155], v[32:47]
    s_waitcnt lgkmcnt(0)
    v_mfma_f32_32x32x16_bf16 v[32:47], v[92:95], v[156:159], v[32:47]
    s_waitcnt vmcnt(0)
    s_barrier
    s_setprio 0
    s_add_u32 m0, s66, 139264
    s_add_u32 s69, s26, 0
    buffer_load_dwordx4 v3, s[36:39], s69 offen nt lds
    s_add_u32 m0, s66, 143424
    s_add_u32 s69, s26, 2048
    buffer_load_dwordx4 v3, s[36:39], s69 offen nt lds
    s_add_u32 m0, s66, 147584
    s_add_u32 s69, s26, 4096
    buffer_load_dwordx4 v3, s[36:39], s69 offen nt lds
    s_add_u32 m0, s66, 151744
    s_add_u32 s69, s26, 6144
    buffer_load_dwordx4 v3, s[36:39], s69 offen nt lds
    s_add_u32 m0, s66, 104448
    s_add_u32 s69, s26, 16384
    buffer_load_dwordx4 v3, s[36:39], s69 offen nt lds
    s_add_u32 m0, s66, 108608
    s_add_u32 s69, s26, 18432
    buffer_load_dwordx4 v3, s[36:39], s69 offen nt lds
    s_add_u32 m0, s66, 112768
    s_add_u32 s69, s26, 20480
    buffer_load_dwordx4 v3, s[36:39], s69 offen nt lds
    s_add_u32 m0, s66, 116928
    s_add_u32 s69, s26, 22528
    buffer_load_dwordx4 v3, s[36:39], s69 offen nt lds
    v_max3_f32 v5, v32, v33, v34
    v_max3_f32 v6, v35, v36, v37
    v_max3_f32 v5, v5, v38, v39
    v_max3_f32 v6, v6, v40, v41
    v_max3_f32 v5, v5, v42, v43
    v_max3_f32 v6, v6, v44, v45
    v_max3_f32 v5, v5, v46, v47
    v_max_f32 v5, v5, v6
    v_cmp_gt_f32 vcc, v5, v7
    s_cbranch_vccz NR_200002
    s_call_b64 s[72:73], L_RARE
NR_200002:
    v_fma_f32 v32, v32, s68, -v8
    v_exp_f32 v32, v32
    v_fma_f32 v33, v33, s68, -v8
    v_exp_f32 v33, v33
    v_add_f32 v9, v9, v32
    v_fma_f32 v34, v34, s68, -v8
    v_exp_f32 v34, v34
    v_add_f32 v12, v12, v33
    v_cvt_pk_bf16_f32 v176, v32, v33
    v_fma_f32 v35, v35, s68, -v8
    v_exp_f32 v35, v35
    v_add_f32 v9, v9, v34
    v_fma_f32 v36, v36, s68, -v8
    v_exp_f32 v36, v36
    v_add_f32 v12, v12, v35
    v_cvt_pk_bf16_f32 v177, v34, v35
    v_fma_f32 v37, v37, s68, -v8
    v_exp_f32 v37, v37
    v_add_f32 v9, v9, v36
    v_fma_f32 v38, v38, s68, -v8
    v_exp_f32 v38, v38
    v_add_f32 v12, v12, v37
    v_cvt_pk_bf16_f32 v178, v36, v37
    v_fma_f32 v39, v39, s68, -v8
    v_exp_f32 v39, v39
    v_add_f32 v9, v9, v38
    v_fma_f32 v40, v40, s68, -v8
    v_exp_f32 v40, v40
    v_add_f32 v12, v12, v39
    v_cvt_pk_bf16_f32 v179, v38, v39
    v_fma_f32 v41, v41, s68, -v8
    v_exp_f32 v41, v41
    v_add_f32 v9, v9, v40
    v_fma_f32 v42, v42, s68, -v8
    v_exp_f32 v42, v42
    v_add_f32 v12, v12, v41
    v_cvt_pk_bf16_f32 v180, v40, v41
    v_fma_f32 v43, v43, s68, -v8
    v_exp_f32 v43, v43
    v_add_f32 v9, v9, v42
    v_fma_f32 v44, v44, s68, -v8
    v_exp_f32 v44, v44
    v_add_f32 v12, v12, v43
    v_cvt_pk_bf16_f32 v181, v42, v43
    v_fma_f32 v45, v45, s68, -v8
    v_exp_f32 v45, v45
    v_add_f32 v9, v9, v44
    v_fma_f32 v46, v46, s68, -v8
    v_exp_f32 v46, v46
    v_add_f32 v12, v12, v45
    v_cvt_pk_bf16_f32 v182, v44, v45
    v_fma_f32 v47, v47, s68, -v8
    v_exp_f32 v47, v47
    v_add_f32 v9, v9, v46
    v_add_f32 v12, v12, v47
    v_cvt_pk_bf16_f32 v183, v46, v47
    s_mul_i32 s70, s82, -69632
    s_add_u32 s70, s70, 69632
    v_add_u32 v22, s70, v17
    ds_read_b128 v[64:67], v22
    ds_read_b128 v[68:71], v22 offset:32
    ds_read_b128 v[72:75], v22 offset:64
    ds_read_b128 v[76:79], v22 offset:96
    ds_read_b128 v[80:83], v22 offset:128
    ds_read_b128 v[84:87], v22 offset:160
    s_barrier
    s_setprio 1
    s_waitcnt lgkmcnt(5)
    v_mfma_f32_32x32x16_bf16 v[48:63], v[64:67], v[96:99], 0
    ds_read_b128 v[88:91], v22 offset:192
    s_waitcnt lgkmcnt(5)
    v_mfma_f32_32x32x16_bf16 v[48:63], v[68:71], v[100:103], v[48:63]
    ds_read_b128 v[92:95], v22 offset:224
    s_waitcnt lgkmcnt(5)
    v_mfma_f32_32x32x16_bf16 v[48:63], v[72:75], v[104:107], v[48:63]
    ds_read_b128 v[64:67], v22 offset:256
    s_waitcnt lgkmcnt(5)
    v_mfma_f32_32x32x16_bf16 v[48:63], v[76:79], v[108:111], v[48:63]
    ds_read_b128 v[68:71], v22 offset:288
    s_waitcnt lgkmcnt(5)
    v_mfma_f32_32x32x16_bf16 v[48:63], v[80:83], v[112:115], v[48:63]
    ds_read_b128 v[72:75], v22 offset:320
    s_waitcnt lgkmcnt(5)
    v_mfma_f32_32x32x16_bf16 v[48:63], v[84:87], v[116:119], v[48:63]
    ds_read_b128 v[76:79], v22 offset:352
    s_waitcnt lgkmcnt(5)
    v_mfma_f32_32x32x16_bf16 v[48:63], v[88:91], v[120:123], v[48:63]
    ds_read_b128 v[80:83], v22 offset:384
    s_waitcnt lgkmcnt(5)
    v_mfma_f32_32x32x16_bf16 v[48:63], v[92:95], v[124:127], v[48:63]
    ds_read_b128 v[84:87], v22 offset:416
    s_waitcnt lgkmcnt(5)
    v_mfma_f32_32x32x16_bf16 v[48:63], v[64:67], v[128:131], v[48:63]
    ds_read_b128 v[88:91], v22 offset:448
    s_waitcnt lgkmcnt(5)
    v_mfma_f32_32x32x16_bf16 v[48:63], v[68:71], v[132:135], v[48:63]
    ds_read_b128 v[92:95], v22 offset:480
    s_waitcnt lgkmcnt(5)
    v_mfma_f32_32x32x16_bf16 v[48:63], v[72:75], v[136:139], v[48:63]
    s_waitcnt lgkmcnt(4)
    v_mfma_f32_32x32x16_bf16 v[48:63], v[76:79], v[140:143], v[48:63]
    s_waitcnt lgkmcnt(3)
    v_mfma_f32_32x32x16_bf16 v[48:63], v[80:83], v[144:147], v[48:63]
    s_waitcnt lgkmcnt(2)
    v_mfma_f32_32x32x16_bf16 v[48:63], v[84:87], v[148:151], v[48:63]
    s_waitcnt lgkmcnt(1)
    v_mfma_f32_32x32x16_bf16 v[48:63], v[88:91], v[152:155], v[48:63]
    s_waitcnt lgkmcnt(0)
    v_mfma_f32_32x32x16_bf16 v[48:63], v[92:95], v[156:159], v[48:63]
    s_waitcnt vmcnt(0)
    s_barrier
    s_setprio 0
    s_add_u32 m0, s66, 69632
    s_add_u32 s69, s27, 0
    buffer_load_dwordx4 v3, s[36:39], s69 offen nt lds
    s_add_u32 m0, s66, 73792
    s_add_u32 s69, s27, 2048
    buffer_load_dwordx4 v3, s[36:39], s69 offen nt lds
    s_add_u32 m0, s66, 77952
    s_add_u32 s69, s27, 4096
    buffer_load_dwordx4 v3, s[36:39], s69 offen nt lds
    s_add_u32 m0, s66, 82112
    s_add_u32 s69, s27, 6144
    buffer_load_dwordx4 v3, s[36:39], s69 offen nt lds
    s_add_u32 m0, s66, 0
    s_add_u32 s69, s27, 16384
    buffer_load_dwordx4 v3, s[36:39], s69 offen nt lds
    s_add_u32 m0, s66, 4160
    s_add_u32 s69, s27, 18432
    buffer_load_dwordx4 v3, s[36:39], s69 offen nt lds
    s_add_u32 m0, s66, 8320
    s_add_u32 s69, s27, 20480
    buffer_load_dwordx4 v3, s[36:39], s69 offen nt lds
    s_add_u32 m0, s66, 12480
    s_add_u32 s69, s27, 22528
    buffer_load_dwordx4 v3, s[36:39], s69 offen nt lds
    v_max3_f32 v5, v48, v49, v50
    v_max3_f32 v6, v51, v52, v53
    v_max3_f32 v5, v5, v54, v55
    v_max3_f32 v6, v6, v56, v57
    v_max3_f32 v5, v5, v58, v59
    v_max3_f32 v6, v6, v60, v61
    v_max3_f32 v5, v5, v62, v63
    v_max_f32 v5, v5, v6
    v_cmp_gt_f32 vcc, v5, v7
    s_cbranch_vccz NR_200003
    s_call_b64 s[72:73], L_RARE
NR_200003:
    v_fma_f32 v48, v48, s68, -v8
    v_exp_f32 v48, v48
    v_fma_f32 v49, v49, s68, -v8
    v_exp_f32 v49, v49
    v_add_f32 v9, v9, v48
    v_fma_f32 v50, v50, s68, -v8
    v_exp_f32 v50, v50
    v_add_f32 v12, v12, v49
    v_cvt_pk_bf16_f32 v184, v48, v49
    v_fma_f32 v51, v51, s68, -v8
    v_exp_f32 v51, v51
    v_add_f32 v9, v9, v50
    v_fma_f32 v52, v52, s68, -v8
    v_exp_f32 v52, v52
    v_add_f32 v12, v12, v51
    v_cvt_pk_bf16_f32 v185, v50, v51
    v_fma_f32 v53, v53, s68, -v8
    v_exp_f32 v53, v53
    v_add_f32 v9, v9, v52
    v_fma_f32 v54, v54, s68, -v8
    v_exp_f32 v54, v54
    v_add_f32 v12, v12, v53
    v_cvt_pk_bf16_f32 v186, v52, v53
    v_fma_f32 v55, v55, s68, -v8
    v_exp_f32 v55, v55
    v_add_f32 v9, v9, v54
    v_fma_f32 v56, v56, s68, -v8
    v_exp_f32 v56, v56
    v_add_f32 v12, v12, v55
    v_cvt_pk_bf16_f32 v187, v54, v55
    v_fma_f32 v57, v57, s68, -v8
    v_exp_f32 v57, v57
    v_add_f32 v9, v9, v56
    v_fma_f32 v58, v58, s68, -v8
    v_exp_f32 v58, v58
    v_add_f32 v12, v12, v57
    v_cvt_pk_bf16_f32 v188, v56, v57
    v_fma_f32 v59, v59, s68, -v8
    v_exp_f32 v59, v59
    v_add_f32 v9, v9, v58
    v_fma_f32 v60, v60, s68, -v8
    v_exp_f32 v60, v60
    v_add_f32 v12, v12, v59
    v_cvt_pk_bf16_f32 v189, v58, v59
    v_fma_f32 v61, v61, s68, -v8
    v_exp_f32 v61, v61
    v_add_f32 v9, v9, v60
    v_fma_f32 v62, v62, s68, -v8
    v_exp_f32 v62, v62
    v_add_f32 v12, v12, v61
    v_cvt_pk_bf16_f32 v190, v60, v61
    v_fma_f32 v63, v63, s68, -v8
    v_exp_f32 v63, v63
    v_add_f32 v9, v9, v62
    v_add_f32 v12, v12, v63
    v_cvt_pk_bf16_f32 v191, v62, v63
    s_mul_i32 s70, s82, -34816
    s_add_u32 s70, s70, 139264
    v_add_u32 v22, s70, v17
    ds_read_b128 v[64:67], v22
    ds_read_b128 v[68:71], v22 offset:32
    ds_read_b128 v[72:75], v22 offset:64
    ds_read_b128 v[76:79], v22 offset:96
    ds_read_b128 v[80:83], v22 offset:128
    ds_read_b128 v[84:87], v22 offset:160
    s_barrier
    s_setprio 1
    s_waitcnt lgkmcnt(5)
    v_mfma_f32_32x32x16_bf16 v[32:47], v[64:67], v[96:99], 0
    ds_read_b128 v[88:91], v22 offset:192
    s_waitcnt lgkmcnt(5)
    v_mfma_f32_32x32x16_bf16 v[32:47], v[68:71], v[100:103], v[32:47]
    ds_read_b128 v[92:95], v22 offset:224
    s_waitcnt lgkmcnt(5)
    v_mfma_f32_32x32x16_bf16 v[32:47], v[72:75], v[104:107], v[32:47]
    ds_read_b128 v[64:67], v22 offset:256
    s_waitcnt lgkmcnt(5)
    v_mfma_f32_32x32x16_bf16 v[32:47], v[76:79], v[108:111], v[32:47]
    ds_read_b128 v[68:71], v22 offset:288
    s_waitcnt lgkmcnt(5)
    v_mfma_f32_32x32x16_bf16 v[32:47], v[80:83], v[112:115], v[32:47]
    ds_read_b128 v[72:75], v22 offset:320
    s_waitcnt lgkmcnt(5)
    v_mfma_f32_32x32x16_bf16 v[32:47], v[84:87], v[116:119], v[32:47]
    ds_read_b128 v[76:79], v22 offset:352
    s_waitcnt lgkmcnt(5)
    v_mfma_f32_32x32x16_bf16 v[32:47], v[88:91], v[120:123], v[32:47]
    ds_read_b128 v[80:83], v22 offset:384
    s_waitcnt lgkmcnt(5)
    v_mfma_f32_32x32x16_bf16 v[32:47], v[92:95], v[124:127], v[32:47]
    ds_read_b128 v[84:87], v22 offset:416
    s_waitcnt lgkmcnt(5)
    v_mfma_f32_32x32x16_bf16 v[32:47], v[64:67], v[128:131], v[32:47]
    ds_read_b128 v[88:91], v22 offset:448
    s_waitcnt lgkmcnt(5)
    v_mfma_f32_32x32x16_bf16 v[32:47], v[68:71], v[132:135], v[32:47]
    ds_read_b128 v[92:95], v22 offset:480
    s_waitcnt lgkmcnt(5)
    v_mfma_f32_32x32x16_bf16 v[32:47], v[72:75], v[136:139], v[32:47]
    s_waitcnt lgkmcnt(4)
    v_mfma_f32_32x32x16_bf16 v[32:47], v[76:79], v[140:143], v[32:47]
    s_waitcnt lgkmcnt(3)
    v_mfma_f32_32x32x16_bf16 v[32:47], v[80:83], v[144:147], v[32:47]
    s_waitcnt lgkmcnt(2)
    v_mfma_f32_32x32x16_bf16 v[32:47], v[84:87], v[148:151], v[32:47]
    s_waitcnt lgkmcnt(1)
    v_mfma_f32_32x32x16_bf16 v[32:47], v[88:91], v[152:155], v[32:47]
    s_waitcnt lgkmcnt(0)
    v_mfma_f32_32x32x16_bf16 v[32:47], v[92:95], v[156:159], v[32:47]
    s_waitcnt vmcnt(0)
    s_barrier
    s_setprio 0
    s_add_u32 m0, s66, 139264
    s_add_u32 s69, s28, 0
    buffer_load_dwordx4 v3, s[36:39], s69 offen nt lds
    s_add_u32 m0, s66, 143424
    s_add_u32 s69, s28, 2048
    buffer_load_dwordx4 v3, s[36:39], s69 offen nt lds
    s_add_u32 m0, s66, 147584
    s_add_u32 s69, s28, 4096
    buffer_load_dwordx4 v3, s[36:39], s69 offen nt lds
    s_add_u32 m0, s66, 151744
    s_add_u32 s69, s28, 6144
    buffer_load_dwordx4 v3, s[36:39], s69 offen nt lds
    s_add_u32 m0, s66, 104448
    s_add_u32 s69, s28, 16384
    buffer_load_dwordx4 v3, s[36:39], s69 offen nt lds
    s_add_u32 m0, s66, 108608
    s_add_u32 s69, s28, 18432
    buffer_load_dwordx4 v3, s[36:39], s69 offen nt lds
    s_add_u32 m0, s66, 112768
    s_add_u32 s69, s28, 20480
    buffer_load_dwordx4 v3, s[36:39], s69 offen nt lds
    s_add_u32 m0, s66, 116928
    s_add_u32 s69, s28, 22528
    buffer_load_dwordx4 v3, s[36:39], s69 offen nt lds
    v_max3_f32 v5, v32, v33, v34
    v_max3_f32 v6, v35, v36, v37
    v_max3_f32 v5, v5, v38, v39
    v_max3_f32 v6, v6, v40, v41
    v_max3_f32 v5, v5, v42, v43
    v_max3_f32 v6, v6, v44, v45
    v_max3_f32 v5, v5, v46, v47
    v_max_f32 v5, v5, v6
    v_cmp_gt_f32 vcc, v5, v7
    s_cbranch_vccz NR_200004
    s_call_b64 s[72:73], L_RARE
NR_200004:
    v_fma_f32 v32, v32, s68, -v8
    v_exp_f32 v32, v32
    v_fma_f32 v33, v33, s68, -v8
    v_exp_f32 v33, v33
    v_add_f32 v9, v9, v32
    v_fma_f32 v34, v34, s68, -v8
    v_exp_f32 v34, v34
    v_add_f32 v12, v12, v33
    v_cvt_pk_bf16_f32 v192, v32, v33
    v_fma_f32 v35, v35, s68, -v8
    v_exp_f32 v35, v35
    v_add_f32 v9, v9, v34
    v_fma_f32 v36, v36, s68, -v8
    v_exp_f32 v36, v36
    v_add_f32 v12, v12, v35
    v_cvt_pk_bf16_f32 v193, v34, v35
    v_fma_f32 v37, v37, s68, -v8
    v_exp_f32 v37, v37
    v_add_f32 v9, v9, v36
    v_fma_f32 v38, v38, s68, -v8
    v_exp_f32 v38, v38
    v_add_f32 v12, v12, v37
    v_cvt_pk_bf16_f32 v194, v36, v37
    v_fma_f32 v39, v39, s68, -v8
    v_exp_f32 v39, v39
    v_add_f32 v9, v9, v38
    v_fma_f32 v40, v40, s68, -v8
    v_exp_f32 v40, v40
    v_add_f32 v12, v12, v39
    v_cvt_pk_bf16_f32 v195, v38, v39
    v_fma_f32 v41, v41, s68, -v8
    v_exp_f32 v41, v41
    v_add_f32 v9, v9, v40
    v_fma_f32 v42, v42, s68, -v8
    v_exp_f32 v42, v42
    v_add_f32 v12, v12, v41
    v_cvt_pk_bf16_f32 v196, v40, v41
    v_fma_f32 v43, v43, s68, -v8
    v_exp_f32 v43, v43
    v_add_f32 v9, v9, v42
    v_fma_f32 v44, v44, s68, -v8
    v_exp_f32 v44, v44
    v_add_f32 v12, v12, v43
    v_cvt_pk_bf16_f32 v197, v42, v43
    v_fma_f32 v45, v45, s68, -v8
    v_exp_f32 v45, v45
    v_add_f32 v9, v9, v44
    v_fma_f32 v46, v46, s68, -v8
    v_exp_f32 v46, v46
    v_add_f32 v12, v12, v45
    v_cvt_pk_bf16_f32 v198, v44, v45
    v_fma_f32 v47, v47, s68, -v8
    v_exp_f32 v47, v47
    v_add_f32 v9, v9, v46
    v_add_f32 v12, v12, v47
    v_cvt_pk_bf16_f32 v199, v46, v47
    s_mul_i32 s70, s82, -69632
    s_add_u32 s70, s70, 69632
    v_add_u32 v22, s70, v17
    ds_read_b128 v[64:67], v22
    ds_read_b128 v[68:71], v22 offset:32
    ds_read_b128 v[72:75], v22 offset:64
    ds_read_b128 v[76:79], v22 offset:96
    ds_read_b128 v[80:83], v22 offset:128
    ds_read_b128 v[84:87], v22 offset:160
    s_barrier
    s_setprio 1
    s_waitcnt lgkmcnt(5)
    v_mfma_f32_32x32x16_bf16 v[48:63], v[64:67], v[96:99], 0
    ds_read_b128 v[88:91], v22 offset:192
    s_waitcnt lgkmcnt(5)
    v_mfma_f32_32x32x16_bf16 v[48:63], v[68:71], v[100:103], v[48:63]
    ds_read_b128 v[92:95], v22 offset:224
    s_waitcnt lgkmcnt(5)
    v_mfma_f32_32x32x16_bf16 v[48:63], v[72:75], v[104:107], v[48:63]
    ds_read_b128 v[64:67], v22 offset:256
    s_waitcnt lgkmcnt(5)
    v_mfma_f32_32x32x16_bf16 v[48:63], v[76:79], v[108:111], v[48:63]
    ds_read_b128 v[68:71], v22 offset:288
    s_waitcnt lgkmcnt(5)
    v_mfma_f32_32x32x16_bf16 v[48:63], v[80:83], v[112:115], v[48:63]
    ds_read_b128 v[72:75], v22 offset:320
    s_waitcnt lgkmcnt(5)
    v_mfma_f32_32x32x16_bf16 v[48:63], v[84:87], v[116:119], v[48:63]
    ds_read_b128 v[76:79], v22 offset:352
    s_waitcnt lgkmcnt(5)
    v_mfma_f32_32x32x16_bf16 v[48:63], v[88:91], v[120:123], v[48:63]
    ds_read_b128 v[80:83], v22 offset:384
    s_waitcnt lgkmcnt(5)
    v_mfma_f32_32x32x16_bf16 v[48:63], v[92:95], v[124:127], v[48:63]
    ds_read_b128 v[84:87], v22 offset:416
    s_waitcnt lgkmcnt(5)
    v_mfma_f32_32x32x16_bf16 v[48:63], v[64:67], v[128:131], v[48:63]
    ds_read_b128 v[88:91], v22 offset:448
    s_waitcnt lgkmcnt(5)
    v_mfma_f32_32x32x16_bf16 v[48:63], v[68:71], v[132:135], v[48:63]
    ds_read_b128 v[92:95], v22 offset:480
    s_waitcnt lgkmcnt(5)
    v_mfma_f32_32x32x16_bf16 v[48:63], v[72:75], v[136:139], v[48:63]
    s_waitcnt lgkmcnt(4)
    v_mfma_f32_32x32x16_bf16 v[48:63], v[76:79], v[140:143], v[48:63]
    s_waitcnt lgkmcnt(3)
    v_mfma_f32_32x32x16_bf16 v[48:63], v[80:83], v[144:147], v[48:63]
    s_waitcnt lgkmcnt(2)
    v_mfma_f32_32x32x16_bf16 v[48:63], v[84:87], v[148:151], v[48:63]
    s_waitcnt lgkmcnt(1)
    v_mfma_f32_32x32x16_bf16 v[48:63], v[88:91], v[152:155], v[48:63]
    s_waitcnt lgkmcnt(0)
    v_mfma_f32_32x32x16_bf16 v[48:63], v[92:95], v[156:159], v[48:63]
    s_waitcnt vmcnt(0)
    s_barrier
    s_setprio 0
    s_add_u32 m0, s66, 69632
    s_add_u32 s69, s29, 0
    buffer_load_dwordx4 v3, s[36:39], s69 offen nt lds
    s_add_u32 m0, s66, 73792
    s_add_u32 s69, s29, 2048
    buffer_load_dwordx4 v3, s[36:39], s69 offen nt lds
    s_add_u32 m0, s66, 77952
    s_add_u32 s69, s29, 4096
    buffer_load_dwordx4 v3, s[36:39], s69 offen nt lds
    s_add_u32 m0, s66, 82112
    s_add_u32 s69, s29, 6144
    buffer_load_dwordx4 v3, s[36:39], s69 offen nt lds
    s_add_u32 m0, s66, 0
    s_add_u32 s69, s29, 16384
    buffer_load_dwordx4 v3, s[36:39], s69 offen nt lds
    s_add_u32 m0, s66, 4160
    s_add_u32 s69, s29, 18432
    buffer_load_dwordx4 v3, s[36:39], s69 offen nt lds
    s_add_u32 m0, s66, 8320
    s_add_u32 s69, s29, 20480
    buffer_load_dwordx4 v3, s[36:39], s69 offen nt lds
    s_add_u32 m0, s66, 12480
    s_add_u32 s69, s29, 22528
    buffer_load_dwordx4 v3, s[36:39], s69 offen nt lds
    v_max3_f32 v5, v48, v49, v50
    v_max3_f32 v6, v51, v52, v53
    v_max3_f32 v5, v5, v54, v55
    v_max3_f32 v6, v6, v56, v57
    v_max3_f32 v5, v5, v58, v59
    v_max3_f32 v6, v6, v60, v61
    v_max3_f32 v5, v5, v62, v63
    v_max_f32 v5, v5, v6
    v_cmp_gt_f32 vcc, v5, v7
    s_cbranch_vccz NR_200005
    s_call_b64 s[72:73], L_RARE
NR_200005:
    v_fma_f32 v48, v48, s68, -v8
    v_exp_f32 v48, v48
    v_fma_f32 v49, v49, s68, -v8
    v_exp_f32 v49, v49
    v_add_f32 v9, v9, v48
    v_fma_f32 v50, v50, s68, -v8
    v_exp_f32 v50, v50
    v_add_f32 v12, v12, v49
    v_cvt_pk_bf16_f32 v200, v48, v49
    v_fma_f32 v51, v51, s68, -v8
    v_exp_f32 v51, v51
    v_add_f32 v9, v9, v50
    v_fma_f32 v52, v52, s68, -v8
    v_exp_f32 v52, v52
    v_add_f32 v12, v12, v51
    v_cvt_pk_bf16_f32 v201, v50, v51
    v_fma_f32 v53, v53, s68, -v8
    v_exp_f32 v53, v53
    v_add_f32 v9, v9, v52
    v_fma_f32 v54, v54, s68, -v8
    v_exp_f32 v54, v54
    v_add_f32 v12, v12, v53
    v_cvt_pk_bf16_f32 v202, v52, v53
    v_fma_f32 v55, v55, s68, -v8
    v_exp_f32 v55, v55
    v_add_f32 v9, v9, v54
    v_fma_f32 v56, v56, s68, -v8
    v_exp_f32 v56, v56
    v_add_f32 v12, v12, v55
    v_cvt_pk_bf16_f32 v203, v54, v55
    v_fma_f32 v57, v57, s68, -v8
    v_exp_f32 v57, v57
    v_add_f32 v9, v9, v56
    v_fma_f32 v58, v58, s68, -v8
    v_exp_f32 v58, v58
    v_add_f32 v12, v12, v57
    v_cvt_pk_bf16_f32 v204, v56, v57
    v_fma_f32 v59, v59, s68, -v8
    v_exp_f32 v59, v59
    v_add_f32 v9, v9, v58
    v_fma_f32 v60, v60, s68, -v8
    v_exp_f32 v60, v60
    v_add_f32 v12, v12, v59
    v_cvt_pk_bf16_f32 v205, v58, v59
    v_fma_f32 v61, v61, s68, -v8
    v_exp_f32 v61, v61
    v_add_f32 v9, v9, v60
    v_fma_f32 v62, v62, s68, -v8
    v_exp_f32 v62, v62
    v_add_f32 v12, v12, v61
    v_cvt_pk_bf16_f32 v206, v60, v61
    v_fma_f32 v63, v63, s68, -v8
    v_exp_f32 v63, v63
    v_add_f32 v9, v9, v62
    v_add_f32 v12, v12, v63
    v_cvt_pk_bf16_f32 v207, v62, v63
    s_mul_i32 s70, s82, -34816
    s_add_u32 s70, s70, 139264
    v_add_u32 v22, s70, v17
    ds_read_b128 v[64:67], v22
    ds_read_b128 v[68:71], v22 offset:32
    ds_read_b128 v[72:75], v22 offset:64
    ds_read_b128 v[76:79], v22 offset:96
    ds_read_b128 v[80:83], v22 offset:128
    ds_read_b128 v[84:87], v22 offset:160
    s_barrier
    s_setprio 1
    s_waitcnt lgkmcnt(5)
    v_mfma_f32_32x32x16_bf16 v[32:47], v[64:67], v[96:99], 0
    ds_read_b128 v[88:91], v22 offset:192
    s_waitcnt lgkmcnt(5)
    v_mfma_f32_32x32x16_bf16 v[32:47], v[68:71], v[100:103], v[32:47]
    ds_read_b128 v[92:95], v22 offset:224
    s_waitcnt lgkmcnt(5)
    v_mfma_f32_32x32x16_bf16 v[32:47], v[72:75], v[104:107], v[32:47]
    ds_read_b128 v[64:67], v22 offset:256
    s_waitcnt lgkmcnt(5)
    v_mfma_f32_32x32x16_bf16 v[32:47], v[76:79], v[108:111], v[32:47]
    ds_read_b128 v[68:71], v22 offset:288
    s_waitcnt lgkmcnt(5)
    v_mfma_f32_32x32x16_bf16 v[32:47], v[80:83], v[112:115], v[32:47]
    ds_read_b128 v[72:75], v22 offset:320
    s_waitcnt lgkmcnt(5)
    v_mfma_f32_32x32x16_bf16 v[32:47], v[84:87], v[116:119], v[32:47]
    ds_read_b128 v[76:79], v22 offset:352
    s_waitcnt lgkmcnt(5)
    v_mfma_f32_32x32x16_bf16 v[32:47], v[88:91], v[120:123], v[32:47]
    ds_read_b128 v[80:83], v22 offset:384
    s_waitcnt lgkmcnt(5)
    v_mfma_f32_32x32x16_bf16 v[32:47], v[92:95], v[124:127], v[32:47]
    ds_read_b128 v[84:87], v22 offset:416
    s_waitcnt lgkmcnt(5)
    v_mfma_f32_32x32x16_bf16 v[32:47], v[64:67], v[128:131], v[32:47]
    ds_read_b128 v[88:91], v22 offset:448
    s_waitcnt lgkmcnt(5)
    v_mfma_f32_32x32x16_bf16 v[32:47], v[68:71], v[132:135], v[32:47]
    ds_read_b128 v[92:95], v22 offset:480
    s_waitcnt lgkmcnt(5)
    v_mfma_f32_32x32x16_bf16 v[32:47], v[72:75], v[136:139], v[32:47]
    s_waitcnt lgkmcnt(4)
    v_mfma_f32_32x32x16_bf16 v[32:47], v[76:79], v[140:143], v[32:47]
    s_waitcnt lgkmcnt(3)
    v_mfma_f32_32x32x16_bf16 v[32:47], v[80:83], v[144:147], v[32:47]
    s_waitcnt lgkmcnt(2)
    v_mfma_f32_32x32x16_bf16 v[32:47], v[84:87], v[148:151], v[32:47]
    s_waitcnt lgkmcnt(1)
    v_mfma_f32_32x32x16_bf16 v[32:47], v[88:91], v[152:155], v[32:47]
    s_waitcnt lgkmcnt(0)
    v_mfma_f32_32x32x16_bf16 v[32:47], v[92:95], v[156:159], v[32:47]
    s_waitcnt vmcnt(0)
    s_barrier
    s_setprio 0
    s_add_u32 m0, s65, 139264
    s_add_u32 s69, s22, 0
    buffer_load_dwordx4 v4, s[40:43], s69 offen nt lds
    s_add_u32 m0, s65, 143616
    s_add_u32 s69, s22, 8192
    buffer_load_dwordx4 v4, s[40:43], s69 offen nt lds
    s_add_u32 m0, s65, 147968
    s_add_u32 s69, s23, 0
    buffer_load_dwordx4 v4, s[40:43], s69 offen nt lds
    s_add_u32 m0, s65, 152320
    s_add_u32 s69, s23, 8192
    buffer_load_dwordx4 v4, s[40:43], s69 offen nt lds
    s_add_u32 m0, s65, 104448
    s_add_u32 s69, s22, 16384
    buffer_load_dwordx4 v4, s[40:43], s69 offen nt lds
    s_add_u32 m0, s65, 108800
    s_add_u32 s69, s22, 24576
    buffer_load_dwordx4 v4, s[40:43], s69 offen nt lds
    s_add_u32 m0, s65, 113152
    s_add_u32 s69, s23, 16384
    buffer_load_dwordx4 v4, s[40:43], s69 offen nt lds
    s_add_u32 m0, s65, 117504
    s_add_u32 s69, s23, 24576
    buffer_load_dwordx4 v4, s[40:43], s69 offen nt lds
    v_max3_f32 v5, v32, v33, v34
    v_max3_f32 v6, v35, v36, v37
    v_max3_f32 v5, v5, v38, v39
    v_max3_f32 v6, v6, v40, v41
    v_max3_f32 v5, v5, v42, v43
    v_max3_f32 v6, v6, v44, v45
    v_max3_f32 v5, v5, v46, v47
    v_max_f32 v5, v5, v6
    v_cmp_gt_f32 vcc, v5, v7
    s_cbranch_vccz NR_200006
    s_call_b64 s[72:73], L_RARE
NR_200006:
    v_fma_f32 v32, v32, s68, -v8
    v_exp_f32 v32, v32
    v_fma_f32 v33, v33, s68, -v8
    v_exp_f32 v33, v33
    v_add_f32 v9, v9, v32
    v_fma_f32 v34, v34, s68, -v8
    v_exp_f32 v34, v34
    v_add_f32 v12, v12, v33
    v_cvt_pk_bf16_f32 v208, v32, v33
    v_fma_f32 v35, v35, s68, -v8
    v_exp_f32 v35, v35
    v_add_f32 v9, v9, v34
    v_fma_f32 v36, v36, s68, -v8
    v_exp_f32 v36, v36
    v_add_f32 v12, v12, v35
    v_cvt_pk_bf16_f32 v209, v34, v35
    v_fma_f32 v37, v37, s68, -v8
    v_exp_f32 v37, v37
    v_add_f32 v9, v9, v36
    v_fma_f32 v38, v38, s68, -v8
    v_exp_f32 v38, v38
    v_add_f32 v12, v12, v37
    v_cvt_pk_bf16_f32 v210, v36, v37
    v_fma_f32 v39, v39, s68, -v8
    v_exp_f32 v39, v39
    v_add_f32 v9, v9, v38
    v_fma_f32 v40, v40, s68, -v8
    v_exp_f32 v40, v40
    v_add_f32 v12, v12, v39
    v_cvt_pk_bf16_f32 v211, v38, v39
    v_fma_f32 v41, v41, s68, -v8
    v_exp_f32 v41, v41
    v_add_f32 v9, v9, v40
    v_fma_f32 v42, v42, s68, -v8
    v_exp_f32 v42, v42
    v_add_f32 v12, v12, v41
    v_cvt_pk_bf16_f32 v212, v40, v41
    v_fma_f32 v43, v43, s68, -v8
    v_exp_f32 v43, v43
    v_add_f32 v9, v9, v42
    v_fma_f32 v44, v44, s68, -v8
    v_exp_f32 v44, v44
    v_add_f32 v12, v12, v43
    v_cvt_pk_bf16_f32 v213, v42, v43
    v_fma_f32 v45, v45, s68, -v8
    v_exp_f32 v45, v45
    v_add_f32 v9, v9, v44
    v_fma_f32 v46, v46, s68, -v8
    v_exp_f32 v46, v46
    v_add_f32 v12, v12, v45
    v_cvt_pk_bf16_f32 v214, v44, v45
    v_fma_f32 v47, v47, s68, -v8
    v_exp_f32 v47, v47
    v_add_f32 v9, v9, v46
    v_add_f32 v12, v12, v47
    v_cvt_pk_bf16_f32 v215, v46, v47
    s_mul_i32 s70, s82, -69632
    s_add_u32 s70, s70, 69632
    v_add_u32 v22, s70, v17
    ds_read_b128 v[64:67], v22
    ds_read_b128 v[68:71], v22 offset:32
    ds_read_b128 v[72:75], v22 offset:64
    ds_read_b128 v[76:79], v22 offset:96
    ds_read_b128 v[80:83], v22 offset:128
    ds_read_b128 v[84:87], v22 offset:160
    s_barrier
    s_setprio 1
    s_waitcnt lgkmcnt(5)
    v_mfma_f32_32x32x16_bf16 v[48:63], v[64:67], v[96:99], 0
    ds_read_b128 v[88:91], v22 offset:192
    s_waitcnt lgkmcnt(5)
    v_mfma_f32_32x32x16_bf16 v[48:63], v[68:71], v[100:103], v[48:63]
    ds_read_b128 v[92:95], v22 offset:224
    s_waitcnt lgkmcnt(5)
    v_mfma_f32_32x32x16_bf16 v[48:63], v[72:75], v[104:107], v[48:63]
    ds_read_b128 v[64:67], v22 offset:256
    s_waitcnt lgkmcnt(5)
    v_mfma_f32_32x32x16_bf16 v[48:63], v[76:79], v[108:111], v[48:63]
    ds_read_b128 v[68:71], v22 offset:288
    s_waitcnt lgkmcnt(5)
    v_mfma_f32_32x32x16_bf16 v[48:63], v[80:83], v[112:115], v[48:63]
    ds_read_b128 v[72:75], v22 offset:320
    s_waitcnt lgkmcnt(5)
    v_mfma_f32_32x32x16_bf16 v[48:63], v[84:87], v[116:119], v[48:63]
    ds_read_b128 v[76:79], v22 offset:352
    s_waitcnt lgkmcnt(5)
    v_mfma_f32_32x32x16_bf16 v[48:63], v[88:91], v[120:123], v[48:63]
    ds_read_b128 v[80:83], v22 offset:384
    s_waitcnt lgkmcnt(5)
    v_mfma_f32_32x32x16_bf16 v[48:63], v[92:95], v[124:127], v[48:63]
    ds_read_b128 v[84:87], v22 offset:416
    s_waitcnt lgkmcnt(5)
    v_mfma_f32_32x32x16_bf16 v[48:63], v[64:67], v[128:131], v[48:63]
    ds_read_b128 v[88:91], v22 offset:448
    s_waitcnt lgkmcnt(5)
    v_mfma_f32_32x32x16_bf16 v[48:63], v[68:71], v[132:135], v[48:63]
    ds_read_b128 v[92:95], v22 offset:480
    s_waitcnt lgkmcnt(5)
    v_mfma_f32_32x32x16_bf16 v[48:63], v[72:75], v[136:139], v[48:63]
    s_waitcnt lgkmcnt(4)
    v_mfma_f32_32x32x16_bf16 v[48:63], v[76:79], v[140:143], v[48:63]
    s_waitcnt lgkmcnt(3)
    v_mfma_f32_32x32x16_bf16 v[48:63], v[80:83], v[144:147], v[48:63]
    s_waitcnt lgkmcnt(2)
    v_mfma_f32_32x32x16_bf16 v[48:63], v[84:87], v[148:151], v[48:63]
    s_waitcnt lgkmcnt(1)
    v_mfma_f32_32x32x16_bf16 v[48:63], v[88:91], v[152:155], v[48:63]
    s_waitcnt lgkmcnt(0)
    v_mfma_f32_32x32x16_bf16 v[48:63], v[92:95], v[156:159], v[48:63]
    s_waitcnt vmcnt(0)
    s_barrier
    s_setprio 0
    s_add_u32 m0, s65, 69632
    s_add_u32 s69, s24, 0
    buffer_load_dwordx4 v4, s[40:43], s69 offen nt lds
    s_add_u32 m0, s65, 73984
    s_add_u32 s69, s24, 8192
    buffer_load_dwordx4 v4, s[40:43], s69 offen nt lds
    s_add_u32 m0, s65, 78336
    s_add_u32 s69, s25, 0
    buffer_load_dwordx4 v4, s[40:43], s69 offen nt lds
    s_add_u32 m0, s65, 82688
    s_add_u32 s69, s25, 8192
    buffer_load_dwordx4 v4, s[40:43], s69 offen nt lds
    s_add_u32 m0, s65, 0
    s_add_u32 s69, s24, 16384
    buffer_load_dwordx4 v4, s[40:43], s69 offen nt lds
    s_add_u32 m0, s65, 4352
    s_add_u32 s69, s24, 24576
    buffer_load_dwordx4 v4, s[40:43], s69 offen nt lds
    s_add_u32 m0, s65, 8704
    s_add_u32 s69, s25, 16384
    buffer_load_dwordx4 v4, s[40:43], s69 offen nt lds
    s_add_u32 m0, s65, 13056
    s_add_u32 s69, s25, 24576
    buffer_load_dwordx4 v4, s[40:43], s69 offen nt lds
    v_max3_f32 v5, v48, v49, v50
    v_max3_f32 v6, v51, v52, v53
    v_max3_f32 v5, v5, v54, v55
    v_max3_f32 v6, v6, v56, v57
    v_max3_f32 v5, v5, v58, v59
    v_max3_f32 v6, v6, v60, v61
    v_max3_f32 v5, v5, v62, v63
    v_max_f32 v5, v5, v6
    v_cmp_gt_f32 vcc, v5, v7
    s_cbranch_vccz NR_200007
    s_call_b64 s[72:73], L_RARE
NR_200007:
    v_fma_f32 v48, v48, s68, -v8
    v_exp_f32 v48, v48
    v_fma_f32 v49, v49, s68, -v8
    v_exp_f32 v49, v49
    v_add_f32 v9, v9, v48
    v_fma_f32 v50, v50, s68, -v8
    v_exp_f32 v50, v50
    v_add_f32 v12, v12, v49
    v_cvt_pk_bf16_f32 v216, v48, v49
    v_fma_f32 v51, v51, s68, -v8
    v_exp_f32 v51, v51
    v_add_f32 v9, v9, v50
    v_fma_f32 v52, v52, s68, -v8
    v_exp_f32 v52, v52
    v_add_f32 v12, v12, v51
    v_cvt_pk_bf16_f32 v217, v50, v51
    v_fma_f32 v53, v53, s68, -v8
    v_exp_f32 v53, v53
    v_add_f32 v9, v9, v52
    v_fma_f32 v54, v54, s68, -v8
    v_exp_f32 v54, v54
    v_add_f32 v12, v12, v53
    v_cvt_pk_bf16_f32 v218, v52, v53
    v_fma_f32 v55, v55, s68, -v8
    v_exp_f32 v55, v55
    v_add_f32 v9, v9, v54
    v_fma_f32 v56, v56, s68, -v8
    v_exp_f32 v56, v56
    v_add_f32 v12, v12, v55
    v_cvt_pk_bf16_f32 v219, v54, v55
    v_fma_f32 v57, v57, s68, -v8
    v_exp_f32 v57, v57
    v_add_f32 v9, v9, v56
    v_fma_f32 v58, v58, s68, -v8
    v_exp_f32 v58, v58
    v_add_f32 v12, v12, v57
    v_cvt_pk_bf16_f32 v220, v56, v57
    v_fma_f32 v59, v59, s68, -v8
    v_exp_f32 v59, v59
    v_add_f32 v9, v9, v58
    v_fma_f32 v60, v60, s68, -v8
    v_exp_f32 v60, v60
    v_add_f32 v12, v12, v59
    v_cvt_pk_bf16_f32 v221, v58, v59
    v_fma_f32 v61, v61, s68, -v8
    v_exp_f32 v61, v61
    v_add_f32 v9, v9, v60
    v_fma_f32 v62, v62, s68, -v8
    v_exp_f32 v62, v62
    v_add_f32 v12, v12, v61
    v_cvt_pk_bf16_f32 v222, v60, v61
    v_fma_f32 v63, v63, s68, -v8
    v_exp_f32 v63, v63
    v_add_f32 v9, v9, v62
    v_add_f32 v12, v12, v63
    v_cvt_pk_bf16_f32 v223, v62, v63
    v_add_f32 v9, v9, v12
    v_mov_b32 v6, v9
    s_nop 1
    v_permlane32_swap_b32 v9, v6
    v_add_f32 v9, v9, v6
    v_and_b32 v26, 31, v0
    s_lshl_b32 s70, s64, 8
    v_lshl_add_u32 v29, v26, 3, s70
    v_add_u32 v27, 156672, v29
    ds_write_b64 v27, v[8:9]
    s_mul_i32 s70, s82, -34816
    s_add_u32 s70, s70, 139264
    v_add_u32 v22, s70, v16
    v_add_u32 v23, s70, v30
    ds_read_b64_tr_b16 v[128:129], v22 offset:64
    ds_read_b64_tr_b16 v[130:131], v22 offset:576
    ds_read_b64_tr_b16 v[132:133], v22
    ds_read_b64_tr_b16 v[134:135], v22 offset:512
    ds_read_b64_tr_b16 v[136:137], v23 offset:64
    ds_read_b64_tr_b16 v[138:139], v23 offset:576
    ds_read_b64_tr_b16 v[140:141], v23
    ds_read_b64_tr_b16 v[142:143], v23 offset:512
    ds_read_b64_tr_b16 v[144:145], v22 offset:4416
    ds_read_b64_tr_b16 v[146:147], v22 offset:4928
    ds_read_b64_tr_b16 v[148:149], v22 offset:4352
    ds_read_b64_tr_b16 v[150:151], v22 offset:4864
    s_waitcnt lgkmcnt(12)
    s_barrier
    s_setprio 1
    s_waitcnt lgkmcnt(10)
    v_mfma_f32_32x32x16_bf16 v[96:111], v[128:131], v[160:163], 0
    ds_read_b64_tr_b16 v[152:153], v23 offset:4416
    ds_read_b64_tr_b16 v[154:155], v23 offset:4928
    s_waitcnt lgkmcnt(10)
    v_mfma_f32_32x32x16_bf16 v[48:63], v[132:135], v[160:163], 0
    ds_read_b64_tr_b16 v[156:157], v23 offset:4352
    ds_read_b64_tr_b16 v[158:159], v23 offset:4864
    s_waitcnt lgkmcnt(10)
    v_mfma_f32_32x32x16_bf16 v[64:79], v[136:139], v[160:163], 0
    ds_read_b64_tr_b16 v[128:129], v22 offset:8768
    ds_read_b64_tr_b16 v[130:131], v22 offset:9280
    s_waitcnt lgkmcnt(10)
    v_mfma_f32_32x32x16_bf16 v[80:95], v[140:143], v[160:163], 0
    ds_read_b64_tr_b16 v[132:133], v22 offset:8704
    ds_read_b64_tr_b16 v[134:135], v22 offset:9216
    s_waitcnt lgkmcnt(10)
    v_mfma_f32_32x32x16_bf16 v[96:111], v[144:147], v[164:167], v[96:111]
    ds_read_b64_tr_b16 v[136:137], v23 offset:8768
    ds_read_b64_tr_b16 v[138:139], v23 offset:9280
    s_waitcnt lgkmcnt(10)
    v_mfma_f32_32x32x16_bf16 v[48:63], v[148:151], v[164:167], v[48:63]
    ds_read_b64_tr_b16 v[140:141], v23 offset:8704
    ds_read_b64_tr_b16 v[142:143], v23 offset:9216
    s_waitcnt lgkmcnt(10)
    v_mfma_f32_32x32x16_bf16 v[64:79], v[152:155], v[164:167], v[64:79]
    ds_read_b64_tr_b16 v[144:145], v22 offset:13120
    ds_read_b64_tr_b16 v[146:147], v22 offset:13632
    s_waitcnt lgkmcnt(10)
    v_mfma_f32_32x32x16_bf16 v[80:95], v[156:159], v[164:167], v[80:95]
    ds_read_b64_tr_b16 v[148:149], v22 offset:13056
    ds_read_b64_tr_b16 v[150:151], v22 offset:13568
    s_waitcnt lgkmcnt(10)
    v_mfma_f32_32x32x16_bf16 v[96:111], v[128:131], v[168:171], v[96:111]
    ds_read_b64_tr_b16 v[152:153], v23 offset:13120
    ds_read_b64_tr_b16 v[154:155], v23 offset:13632
    s_waitcnt lgkmcnt(10)
    v_mfma_f32_32x32x16_bf16 v[48:63], v[132:135], v[168:171], v[48:63]
    ds_read_b64_tr_b16 v[156:157], v23 offset:13056
    ds_read_b64_tr_b16 v[158:159], v23 offset:13568
    s_waitcnt lgkmcnt(10)
    v_mfma_f32_32x32x16_bf16 v[64:79], v[136:139], v[168:171], v[64:79]
    s_waitcnt lgkmcnt(8)
    v_mfma_f32_32x32x16_bf16 v[80:95], v[140:143], v[168:171], v[80:95]
    s_waitcnt lgkmcnt(6)
    v_mfma_f32_32x32x16_bf16 v[96:111], v[144:147], v[172:175], v[96:111]
    s_waitcnt lgkmcnt(4)
    v_mfma_f32_32x32x16_bf16 v[48:63], v[148:151], v[172:175], v[48:63]
    s_waitcnt lgkmcnt(2)
    v_mfma_f32_32x32x16_bf16 v[64:79], v[152:155], v[172:175], v[64:79]
    s_waitcnt lgkmcnt(0)
    v_mfma_f32_32x32x16_bf16 v[80:95], v[156:159], v[172:175], v[80:95]
    s_waitcnt vmcnt(0)
    s_barrier
    s_setprio 0
    s_add_u32 m0, s65, 139264
    s_add_u32 s69, s26, 0
    buffer_load_dwordx4 v4, s[40:43], s69 offen nt lds
    s_add_u32 m0, s65, 143616
    s_add_u32 s69, s26, 8192
    buffer_load_dwordx4 v4, s[40:43], s69 offen nt lds
    s_add_u32 m0, s65, 147968
    s_add_u32 s69, s27, 0
    buffer_load_dwordx4 v4, s[40:43], s69 offen nt lds
    s_add_u32 m0, s65, 152320
    s_add_u32 s69, s27, 8192
    buffer_load_dwordx4 v4, s[40:43], s69 offen nt lds
    s_add_u32 m0, s65, 104448
    s_add_u32 s69, s26, 16384
    buffer_load_dwordx4 v4, s[40:43], s69 offen nt lds
    s_add_u32 m0, s65, 108800
    s_add_u32 s69, s26, 24576
    buffer_load_dwordx4 v4, s[40:43], s69 offen nt lds
    s_add_u32 m0, s65, 113152
    s_add_u32 s69, s27, 16384
    buffer_load_dwordx4 v4, s[40:43], s69 offen nt lds
    s_add_u32 m0, s65, 117504
    s_add_u32 s69, s27, 24576
    buffer_load_dwordx4 v4, s[40:43], s69 offen nt lds
    v_xor_b32 v5, 1024, v29
    v_add_u32 v5, 156672, v5
    ds_read_b64 v[232:233], v5
    v_xor_b32 v5, 512, v29
    v_add_u32 v5, 156672, v5
    ds_read_b64 v[234:235], v5
    v_xor_b32 v5, 1536, v29
    v_add_u32 v5, 156672, v5
    ds_read_b64 v[236:237], v5
    s_waitcnt lgkmcnt(0)
    v_max3_f32 v238, v232, v234, v236
    v_max_f32 v238, v238, v8
    v_sub_f32 v8, v8, v238
    v_exp_f32 v8, v8
    v_sub_f32 v232, v232, v238
    v_exp_f32 v232, v232
    v_sub_f32 v234, v234, v238
    v_exp_f32 v234, v234
    v_sub_f32 v236, v236, v238
    v_exp_f32 v236, v236
    v_mul_f32 v9, v9, v8
    v_fmac_f32 v9, v232, v233
    v_fmac_f32 v9, v234, v235
    v_fmac_f32 v9, v236, v237
    v_rcp_f32 v9, v9
    s_nop 0
    v_mul_f32 v13, v8, v9
    v_mul_f32 v24, v232, v9
    v_mul_f32 v25, v234, v9
    v_mul_f32 v12, v236, v9
    s_mul_i32 s70, s82, -69632
    s_add_u32 s70, s70, 69632
    v_add_u32 v22, s70, v16
    v_add_u32 v23, s70, v30
    ds_read_b64_tr_b16 v[128:129], v22 offset:64
    ds_read_b64_tr_b16 v[130:131], v22 offset:576
    ds_read_b64_tr_b16 v[132:133], v22
    ds_read_b64_tr_b16 v[134:135], v22 offset:512
    ds_read_b64_tr_b16 v[136:137], v23 offset:64
    ds_read_b64_tr_b16 v[138:139], v23 offset:576
    ds_read_b64_tr_b16 v[140:141], v23
    ds_read_b64_tr_b16 v[142:143], v23 offset:512
    ds_read_b64_tr_b16 v[144:145], v22 offset:4416
    ds_read_b64_tr_b16 v[146:147], v22 offset:4928
    ds_read_b64_tr_b16 v[148:149], v22 offset:4352
    ds_read_b64_tr_b16 v[150:151], v22 offset:4864
    s_barrier
    s_setprio 1
    s_waitcnt lgkmcnt(10)
    v_mfma_f32_32x32x16_bf16 v[96:111], v[128:131], v[176:179], v[96:111]
    ds_read_b64_tr_b16 v[152:153], v23 offset:4416
    ds_read_b64_tr_b16 v[154:155], v23 offset:4928
    s_waitcnt lgkmcnt(10)
    v_mfma_f32_32x32x16_bf16 v[48:63], v[132:135], v[176:179], v[48:63]
    ds_read_b64_tr_b16 v[156:157], v23 offset:4352
    ds_read_b64_tr_b16 v[158:159], v23 offset:4864
    s_waitcnt lgkmcnt(10)
    v_mfma_f32_32x32x16_bf16 v[64:79], v[136:139], v[176:179], v[64:79]
    ds_read_b64_tr_b16 v[128:129], v22 offset:8768
    ds_read_b64_tr_b16 v[130:131], v22 offset:9280
    s_waitcnt lgkmcnt(10)
    v_mfma_f32_32x32x16_bf16 v[80:95], v[140:143], v[176:179], v[80:95]
    ds_read_b64_tr_b16 v[132:133], v22 offset:8704
    ds_read_b64_tr_b16 v[134:135], v22 offset:9216
    s_waitcnt lgkmcnt(10)
    v_mfma_f32_32x32x16_bf16 v[96:111], v[144:147], v[180:183], v[96:111]
    ds_read_b64_tr_b16 v[136:137], v23 offset:8768
    ds_read_b64_tr_b16 v[138:139], v23 offset:9280
    s_waitcnt lgkmcnt(10)
    v_mfma_f32_32x32x16_bf16 v[48:63], v[148:151], v[180:183], v[48:63]
    ds_read_b64_tr_b16 v[140:141], v23 offset:8704
    ds_read_b64_tr_b16 v[142:143], v23 offset:9216
    s_waitcnt lgkmcnt(10)
    v_mfma_f32_32x32x16_bf16 v[64:79], v[152:155], v[180:183], v[64:79]
    ds_read_b64_tr_b16 v[144:145], v22 offset:13120
    ds_read_b64_tr_b16 v[146:147], v22 offset:13632
    s_waitcnt lgkmcnt(10)
    v_mfma_f32_32x32x16_bf16 v[80:95], v[156:159], v[180:183], v[80:95]
    ds_read_b64_tr_b16 v[148:149], v22 offset:13056
    ds_read_b64_tr_b16 v[150:151], v22 offset:13568
    s_waitcnt lgkmcnt(10)
    v_mfma_f32_32x32x16_bf16 v[96:111], v[128:131], v[184:187], v[96:111]
    ds_read_b64_tr_b16 v[152:153], v23 offset:13120
    ds_read_b64_tr_b16 v[154:155], v23 offset:13632
    s_waitcnt lgkmcnt(10)
    v_mfma_f32_32x32x16_bf16 v[48:63], v[132:135], v[184:187], v[48:63]
    ds_read_b64_tr_b16 v[156:157], v23 offset:13056
    ds_read_b64_tr_b16 v[158:159], v23 offset:13568
    s_waitcnt lgkmcnt(10)
    v_mfma_f32_32x32x16_bf16 v[64:79], v[136:139], v[184:187], v[64:79]
    s_waitcnt lgkmcnt(8)
    v_mfma_f32_32x32x16_bf16 v[80:95], v[140:143], v[184:187], v[80:95]
    s_waitcnt lgkmcnt(6)
    v_mfma_f32_32x32x16_bf16 v[96:111], v[144:147], v[188:191], v[96:111]
    s_waitcnt lgkmcnt(4)
    v_mfma_f32_32x32x16_bf16 v[48:63], v[148:151], v[188:191], v[48:63]
    s_waitcnt lgkmcnt(2)
    v_mfma_f32_32x32x16_bf16 v[64:79], v[152:155], v[188:191], v[64:79]
    s_waitcnt lgkmcnt(0)
    v_mfma_f32_32x32x16_bf16 v[80:95], v[156:159], v[188:191], v[80:95]
    s_waitcnt vmcnt(0)
    s_barrier
    s_setprio 0
    s_add_u32 m0, s65, 0
    s_add_u32 s69, s28, 0
    buffer_load_dwordx4 v4, s[40:43], s69 offen nt lds
    s_add_u32 m0, s65, 4352
    s_add_u32 s69, s28, 8192
    buffer_load_dwordx4 v4, s[40:43], s69 offen nt lds
    s_add_u32 m0, s65, 8704
    s_add_u32 s69, s29, 0
    buffer_load_dwordx4 v4, s[40:43], s69 offen nt lds
    s_add_u32 m0, s65, 13056
    s_add_u32 s69, s29, 8192
    buffer_load_dwordx4 v4, s[40:43], s69 offen nt lds
    s_add_u32 m0, s65, 69632
    s_add_u32 s69, s28, 16384
    buffer_load_dwordx4 v4, s[40:43], s69 offen nt lds
    s_add_u32 m0, s65, 73984
    s_add_u32 s69, s28, 24576
    buffer_load_dwordx4 v4, s[40:43], s69 offen nt lds
    s_add_u32 m0, s65, 78336
    s_add_u32 s69, s29, 16384
    buffer_load_dwordx4 v4, s[40:43], s69 offen nt lds
    s_add_u32 m0, s65, 82688
    s_add_u32 s69, s29, 24576
    buffer_load_dwordx4 v4, s[40:43], s69 offen nt lds
    s_mul_i32 s70, s82, -34816
    s_add_u32 s70, s70, 139264
    v_add_u32 v22, s70, v16
    v_add_u32 v23, s70, v30
    ds_read_b64_tr_b16 v[128:129], v22 offset:64
    ds_read_b64_tr_b16 v[130:131], v22 offset:576
    ds_read_b64_tr_b16 v[132:133], v22
    ds_read_b64_tr_b16 v[134:135], v22 offset:512
    ds_read_b64_tr_b16 v[136:137], v23 offset:64
    ds_read_b64_tr_b16 v[138:139], v23 offset:576
    ds_read_b64_tr_b16 v[140:141], v23
    ds_read_b64_tr_b16 v[142:143], v23 offset:512
    ds_read_b64_tr_b16 v[144:145], v22 offset:4416
    ds_read_b64_tr_b16 v[146:147], v22 offset:4928
    ds_read_b64_tr_b16 v[148:149], v22 offset:4352
    ds_read_b64_tr_b16 v[150:151], v22 offset:4864
    s_barrier
    s_setprio 1
    s_waitcnt lgkmcnt(10)
    v_mfma_f32_32x32x16_bf16 v[96:111], v[128:131], v[192:195], v[96:111]
    ds_read_b64_tr_b16 v[152:153], v23 offset:4416
    ds_read_b64_tr_b16 v[154:155], v23 offset:4928
    s_waitcnt lgkmcnt(10)
    v_mfma_f32_32x32x16_bf16 v[48:63], v[132:135], v[192:195], v[48:63]
    ds_read_b64_tr_b16 v[156:157], v23 offset:4352
    ds_read_b64_tr_b16 v[158:159], v23 offset:4864
    s_waitcnt lgkmcnt(10)
    v_mfma_f32_32x32x16_bf16 v[64:79], v[136:139], v[192:195], v[64:79]
    ds_read_b64_tr_b16 v[128:129], v22 offset:8768
    ds_read_b64_tr_b16 v[130:131], v22 offset:9280
    s_waitcnt lgkmcnt(10)
    v_mfma_f32_32x32x16_bf16 v[80:95], v[140:143], v[192:195], v[80:95]
    ds_read_b64_tr_b16 v[132:133], v22 offset:8704
    ds_read_b64_tr_b16 v[134:135], v22 offset:9216
    s_waitcnt lgkmcnt(10)
    v_mfma_f32_32x32x16_bf16 v[96:111], v[144:147], v[196:199], v[96:111]
    ds_read_b64_tr_b16 v[136:137], v23 offset:8768
    ds_read_b64_tr_b16 v[138:139], v23 offset:9280
    s_waitcnt lgkmcnt(10)
    v_mfma_f32_32x32x16_bf16 v[48:63], v[148:151], v[196:199], v[48:63]
    ds_read_b64_tr_b16 v[140:141], v23 offset:8704
    ds_read_b64_tr_b16 v[142:143], v23 offset:9216
    s_waitcnt lgkmcnt(10)
    v_mfma_f32_32x32x16_bf16 v[64:79], v[152:155], v[196:199], v[64:79]
    ds_read_b64_tr_b16 v[144:145], v22 offset:13120
    ds_read_b64_tr_b16 v[146:147], v22 offset:13632
    s_waitcnt lgkmcnt(10)
    v_mfma_f32_32x32x16_bf16 v[80:95], v[156:159], v[196:199], v[80:95]
    ds_read_b64_tr_b16 v[148:149], v22 offset:13056
    ds_read_b64_tr_b16 v[150:151], v22 offset:13568
    s_waitcnt lgkmcnt(10)
    v_mfma_f32_32x32x16_bf16 v[96:111], v[128:131], v[200:203], v[96:111]
    ds_read_b64_tr_b16 v[152:153], v23 offset:13120
    ds_read_b64_tr_b16 v[154:155], v23 offset:13632
    s_waitcnt lgkmcnt(10)
    v_mfma_f32_32x32x16_bf16 v[48:63], v[132:135], v[200:203], v[48:63]
    ds_read_b64_tr_b16 v[156:157], v23 offset:13056
    ds_read_b64_tr_b16 v[158:159], v23 offset:13568
    s_waitcnt lgkmcnt(10)
    v_mfma_f32_32x32x16_bf16 v[64:79], v[136:139], v[200:203], v[64:79]
    s_waitcnt lgkmcnt(8)
    v_mfma_f32_32x32x16_bf16 v[80:95], v[140:143], v[200:203], v[80:95]
    s_waitcnt lgkmcnt(6)
    v_mfma_f32_32x32x16_bf16 v[96:111], v[144:147], v[204:207], v[96:111]
    s_waitcnt lgkmcnt(4)
    v_mfma_f32_32x32x16_bf16 v[48:63], v[148:151], v[204:207], v[48:63]
    s_waitcnt lgkmcnt(2)
    v_mfma_f32_32x32x16_bf16 v[64:79], v[152:155], v[204:207], v[64:79]
    s_waitcnt lgkmcnt(0)
    v_mfma_f32_32x32x16_bf16 v[80:95], v[156:159], v[204:207], v[80:95]
    s_waitcnt vmcnt(0)
    s_barrier
    s_setprio 0
    s_mul_i32 s70, s82, 69632
    s_add_u32 s70, s70, 0
    v_add_u32 v22, s70, v16
    v_add_u32 v23, s70, v30
    ds_read_b64_tr_b16 v[128:129], v22 offset:64
    ds_read_b64_tr_b16 v[130:131], v22 offset:576
    ds_read_b64_tr_b16 v[132:133], v22
    ds_read_b64_tr_b16 v[134:135], v22 offset:512
    ds_read_b64_tr_b16 v[136:137], v23 offset:64
    ds_read_b64_tr_b16 v[138:139], v23 offset:576
    ds_read_b64_tr_b16 v[140:141], v23
    ds_read_b64_tr_b16 v[142:143], v23 offset:512
    ds_read_b64_tr_b16 v[144:145], v22 offset:4416
    ds_read_b64_tr_b16 v[146:147], v22 offset:4928
    ds_read_b64_tr_b16 v[148:149], v22 offset:4352
    ds_read_b64_tr_b16 v[150:151], v22 offset:4864
    s_barrier
    s_setprio 1
    s_waitcnt lgkmcnt(10)
    v_mfma_f32_32x32x16_bf16 v[96:111], v[128:131], v[208:211], v[96:111]
    ds_read_b64_tr_b16 v[152:153], v23 offset:4416
    ds_read_b64_tr_b16 v[154:155], v23 offset:4928
    s_waitcnt lgkmcnt(10)
    v_mfma_f32_32x32x16_bf16 v[48:63], v[132:135], v[208:211], v[48:63]
    ds_read_b64_tr_b16 v[156:157], v23 offset:4352
    ds_read_b64_tr_b16 v[158:159], v23 offset:4864
    s_waitcnt lgkmcnt(10)
    v_mfma_f32_32x32x16_bf16 v[64:79], v[136:139], v[208:211], v[64:79]
    ds_read_b64_tr_b16 v[128:129], v22 offset:8768
    ds_read_b64_tr_b16 v[130:131], v22 offset:9280
    s_waitcnt lgkmcnt(10)
    v_mfma_f32_32x32x16_bf16 v[80:95], v[140:143], v[208:211], v[80:95]
    ds_read_b64_tr_b16 v[132:133], v22 offset:8704
    ds_read_b64_tr_b16 v[134:135], v22 offset:9216
    s_waitcnt lgkmcnt(10)
    v_mfma_f32_32x32x16_bf16 v[96:111], v[144:147], v[212:215], v[96:111]
    ds_read_b64_tr_b16 v[136:137], v23 offset:8768
    ds_read_b64_tr_b16 v[138:139], v23 offset:9280
    s_waitcnt lgkmcnt(10)
    v_mfma_f32_32x32x16_bf16 v[48:63], v[148:151], v[212:215], v[48:63]
    ds_read_b64_tr_b16 v[140:141], v23 offset:8704
    ds_read_b64_tr_b16 v[142:143], v23 offset:9216
    s_waitcnt lgkmcnt(10)
    v_mfma_f32_32x32x16_bf16 v[64:79], v[152:155], v[212:215], v[64:79]
    ds_read_b64_tr_b16 v[144:145], v22 offset:13120
    ds_read_b64_tr_b16 v[146:147], v22 offset:13632
    s_waitcnt lgkmcnt(10)
    v_mfma_f32_32x32x16_bf16 v[80:95], v[156:159], v[212:215], v[80:95]
    ds_read_b64_tr_b16 v[148:149], v22 offset:13056
    ds_read_b64_tr_b16 v[150:151], v22 offset:13568
    s_waitcnt lgkmcnt(10)
    v_mfma_f32_32x32x16_bf16 v[96:111], v[128:131], v[216:219], v[96:111]
    ds_read_b64_tr_b16 v[152:153], v23 offset:13120
    ds_read_b64_tr_b16 v[154:155], v23 offset:13632
    s_waitcnt lgkmcnt(10)
    v_mfma_f32_32x32x16_bf16 v[48:63], v[132:135], v[216:219], v[48:63]
    ds_read_b64_tr_b16 v[156:157], v23 offset:13056
    ds_read_b64_tr_b16 v[158:159], v23 offset:13568
    s_waitcnt lgkmcnt(10)
    v_mfma_f32_32x32x16_bf16 v[64:79], v[136:139], v[216:219], v[64:79]
    s_waitcnt lgkmcnt(8)
    v_mfma_f32_32x32x16_bf16 v[80:95], v[140:143], v[216:219], v[80:95]
    s_waitcnt lgkmcnt(6)
    v_mfma_f32_32x32x16_bf16 v[96:111], v[144:147], v[220:223], v[96:111]
    s_waitcnt lgkmcnt(4)
    v_mfma_f32_32x32x16_bf16 v[48:63], v[148:151], v[220:223], v[48:63]
    s_waitcnt lgkmcnt(2)
    v_mfma_f32_32x32x16_bf16 v[64:79], v[152:155], v[220:223], v[64:79]
    s_waitcnt lgkmcnt(0)
    v_mfma_f32_32x32x16_bf16 v[80:95], v[156:159], v[220:223], v[80:95]
    s_add_u32 m0, s65, 17408
    s_add_u32 s69, s22, 256
    buffer_load_dwordx4 v4, s[40:43], s69 offen nt lds
    s_add_u32 m0, s65, 21760
    s_add_u32 s69, s22, 8448
    buffer_load_dwordx4 v4, s[40:43], s69 offen nt lds
    s_add_u32 m0, s65, 26112
    s_add_u32 s69, s23, 256
    buffer_load_dwordx4 v4, s[40:43], s69 offen nt lds
    s_add_u32 m0, s65, 30464
    s_add_u32 s69, s23, 8448
    buffer_load_dwordx4 v4, s[40:43], s69 offen nt lds
    s_add_u32 m0, s65, 52224
    s_add_u32 s69, s22, 16640
    buffer_load_dwordx4 v4, s[40:43], s69 offen nt lds
    s_add_u32 m0, s65, 56576
    s_add_u32 s69, s22, 24832
    buffer_load_dwordx4 v4, s[40:43], s69 offen nt lds
    s_add_u32 m0, s65, 60928
    s_add_u32 s69, s23, 16640
    buffer_load_dwordx4 v4, s[40:43], s69 offen nt lds
    s_add_u32 m0, s65, 65280
    s_add_u32 s69, s23, 24832
    buffer_load_dwordx4 v4, s[40:43], s69 offen nt lds
    s_barrier
    s_setprio 0
    s_xor_b32 s70, s64, 4
    s_mul_i32 s70, s70, 6144
    s_add_u32 s70, s70, 104448
    v_add_u32 v6, s70, v18
    v_cvt_pk_bf16_f32 v48, v48, v49
    v_cvt_pk_bf16_f32 v49, v50, v51
    v_cvt_pk_bf16_f32 v50, v52, v53
    v_cvt_pk_bf16_f32 v51, v54, v55
    ds_write_b128 v6, v[48:51]
    v_cvt_pk_bf16_f32 v52, v56, v57
    v_cvt_pk_bf16_f32 v53, v58, v59
    v_cvt_pk_bf16_f32 v54, v60, v61
    v_cvt_pk_bf16_f32 v55, v62, v63
    ds_write_b128 v6, v[52:55] offset:1024
    s_xor_b32 s70, s64, 2
    s_mul_i32 s70, s70, 6144
    s_add_u32 s70, s70, 106496
    v_add_u32 v6, s70, v18
    v_cvt_pk_bf16_f32 v64, v64, v65
    v_cvt_pk_bf16_f32 v65, v66, v67
    v_cvt_pk_bf16_f32 v66, v68, v69
    v_cvt_pk_bf16_f32 v67, v70, v71
    ds_write_b128 v6, v[64:67]
    v_cvt_pk_bf16_f32 v68, v72, v73
    v_cvt_pk_bf16_f32 v69, v74, v75
    v_cvt_pk_bf16_f32 v70, v76, v77
    v_cvt_pk_bf16_f32 v71, v78, v79
    ds_write_b128 v6, v[68:71] offset:1024
    s_xor_b32 s70, s64, 6
    s_mul_i32 s70, s70, 6144
    s_add_u32 s70, s70, 108544
    v_add_u32 v6, s70, v18
    v_cvt_pk_bf16_f32 v80, v80, v81
    v_cvt_pk_bf16_f32 v81, v82, v83
    v_cvt_pk_bf16_f32 v82, v84, v85
    v_cvt_pk_bf16_f32 v83, v86, v87
    ds_write_b128 v6, v[80:83]
    v_cvt_pk_bf16_f32 v84, v88, v89
    v_cvt_pk_bf16_f32 v85, v90, v91
    v_cvt_pk_bf16_f32 v86, v92, v93
    v_cvt_pk_bf16_f32 v87, v94, v95
    ds_write_b128 v6, v[84:87] offset:1024
    s_waitcnt vmcnt(0) lgkmcnt(0)
    s_barrier
    s_setprio 1
    s_mul_i32 s70, s82, 34816
    s_add_u32 s70, s70, 17408
    v_add_u32 v22, s70, v16
    v_add_u32 v23, s70, v30
    ds_read_b64_tr_b16 v[128:129], v22 offset:64
    ds_read_b64_tr_b16 v[130:131], v22 offset:576
    ds_read_b64_tr_b16 v[132:133], v22
    ds_read_b64_tr_b16 v[134:135], v22 offset:512
    ds_read_b64_tr_b16 v[136:137], v23 offset:64
    ds_read_b64_tr_b16 v[138:139], v23 offset:576
    ds_read_b64_tr_b16 v[140:141], v23
    ds_read_b64_tr_b16 v[142:143], v23 offset:512
    ds_read_b64_tr_b16 v[144:145], v22 offset:4416
    ds_read_b64_tr_b16 v[146:147], v22 offset:4928
    ds_read_b64_tr_b16 v[148:149], v22 offset:4352
    ds_read_b64_tr_b16 v[150:151], v22 offset:4864
    s_waitcnt lgkmcnt(10)
    v_mfma_f32_32x32x16_bf16 v[32:47], v[128:131], v[160:163], 0
    ds_read_b64_tr_b16 v[152:153], v23 offset:4416
    ds_read_b64_tr_b16 v[154:155], v23 offset:4928
    s_waitcnt lgkmcnt(10)
    v_mfma_f32_32x32x16_bf16 v[48:63], v[132:135], v[160:163], 0
    ds_read_b64_tr_b16 v[156:157], v23 offset:4352
    ds_read_b64_tr_b16 v[158:159], v23 offset:4864
    s_waitcnt lgkmcnt(10)
    v_mfma_f32_32x32x16_bf16 v[64:79], v[136:139], v[160:163], 0
    ds_read_b64_tr_b16 v[128:129], v22 offset:8768
    ds_read_b64_tr_b16 v[130:131], v22 offset:9280
    s_waitcnt lgkmcnt(10)
    v_mfma_f32_32x32x16_bf16 v[80:95], v[140:143], v[160:163], 0
    ds_read_b64_tr_b16 v[132:133], v22 offset:8704
    ds_read_b64_tr_b16 v[134:135], v22 offset:9216
    s_waitcnt lgkmcnt(10)
    v_mfma_f32_32x32x16_bf16 v[32:47], v[144:147], v[164:167], v[32:47]
    ds_read_b64_tr_b16 v[136:137], v23 offset:8768
    ds_read_b64_tr_b16 v[138:139], v23 offset:9280
    s_waitcnt lgkmcnt(10)
    v_mfma_f32_32x32x16_bf16 v[48:63], v[148:151], v[164:167], v[48:63]
    ds_read_b64_tr_b16 v[140:141], v23 offset:8704
    ds_read_b64_tr_b16 v[142:143], v23 offset:9216
    s_waitcnt lgkmcnt(10)
    v_mfma_f32_32x32x16_bf16 v[64:79], v[152:155], v[164:167], v[64:79]
    ds_read_b64_tr_b16 v[144:145], v22 offset:13120
    ds_read_b64_tr_b16 v[146:147], v22 offset:13632
    s_waitcnt lgkmcnt(10)
    v_mfma_f32_32x32x16_bf16 v[80:95], v[156:159], v[164:167], v[80:95]
    ds_read_b64_tr_b16 v[148:149], v22 offset:13056
    ds_read_b64_tr_b16 v[150:151], v22 offset:13568
    s_waitcnt lgkmcnt(10)
    v_mfma_f32_32x32x16_bf16 v[32:47], v[128:131], v[168:171], v[32:47]
    ds_read_b64_tr_b16 v[152:153], v23 offset:13120
    ds_read_b64_tr_b16 v[154:155], v23 offset:13632
    s_waitcnt lgkmcnt(10)
    v_mfma_f32_32x32x16_bf16 v[48:63], v[132:135], v[168:171], v[48:63]
    ds_read_b64_tr_b16 v[156:157], v23 offset:13056
    ds_read_b64_tr_b16 v[158:159], v23 offset:13568
    s_waitcnt lgkmcnt(10)
    v_mfma_f32_32x32x16_bf16 v[64:79], v[136:139], v[168:171], v[64:79]
    s_waitcnt lgkmcnt(8)
    v_mfma_f32_32x32x16_bf16 v[80:95], v[140:143], v[168:171], v[80:95]
    s_waitcnt lgkmcnt(6)
    v_mfma_f32_32x32x16_bf16 v[32:47], v[144:147], v[172:175], v[32:47]
    s_waitcnt lgkmcnt(4)
    v_mfma_f32_32x32x16_bf16 v[48:63], v[148:151], v[172:175], v[48:63]
    s_waitcnt lgkmcnt(2)
    v_mfma_f32_32x32x16_bf16 v[64:79], v[152:155], v[172:175], v[64:79]
    s_waitcnt lgkmcnt(0)
    v_mfma_f32_32x32x16_bf16 v[80:95], v[156:159], v[172:175], v[80:95]
    s_add_u32 m0, s65, 34816
    s_add_u32 s69, s24, 256
    buffer_load_dwordx4 v4, s[40:43], s69 offen nt lds
    s_add_u32 m0, s65, 39168
    s_add_u32 s69, s24, 8448
    buffer_load_dwordx4 v4, s[40:43], s69 offen nt lds
    s_add_u32 m0, s65, 43520
    s_add_u32 s69, s25, 256
    buffer_load_dwordx4 v4, s[40:43], s69 offen nt lds
    s_add_u32 m0, s65, 47872
    s_add_u32 s69, s25, 8448
    buffer_load_dwordx4 v4, s[40:43], s69 offen nt lds
    s_add_u32 m0, s65, 87040
    s_add_u32 s69, s24, 16640
    buffer_load_dwordx4 v4, s[40:43], s69 offen nt lds
    s_add_u32 m0, s65, 91392
    s_add_u32 s69, s24, 24832
    buffer_load_dwordx4 v4, s[40:43], s69 offen nt lds
    s_add_u32 m0, s65, 95744
    s_add_u32 s69, s25, 16640
    buffer_load_dwordx4 v4, s[40:43], s69 offen nt lds
    s_add_u32 m0, s65, 100096
    s_add_u32 s69, s25, 24832
    buffer_load_dwordx4 v4, s[40:43], s69 offen nt lds
    s_barrier
    s_setprio 0
    ds_read_b128 v[232:235], v31
    ds_read_b128 v[240:243], v31 offset:2048
    ds_read_b128 v[248:251], v31 offset:4096
    ds_read_b128 v[236:239], v31 offset:1024
    ds_read_b128 v[244:247], v31 offset:3072
    ds_read_b128 v[252:255], v31 offset:5120
    v_mul_f32 v96, v13, v96
    v_mul_f32 v97, v13, v97
    v_mul_f32 v98, v13, v98
    v_mul_f32 v99, v13, v99
    v_mul_f32 v100, v13, v100
    v_mul_f32 v101, v13, v101
    v_mul_f32 v102, v13, v102
    v_mul_f32 v103, v13, v103
    v_mul_f32 v104, v13, v104
    v_mul_f32 v105, v13, v105
    v_mul_f32 v106, v13, v106
    v_mul_f32 v107, v13, v107
    v_mul_f32 v108, v13, v108
    v_mul_f32 v109, v13, v109
    v_mul_f32 v110, v13, v110
    v_mul_f32 v111, v13, v111
    s_waitcnt lgkmcnt(3)
    v_lshlrev_b32 v5, 16, v232
    v_and_b32 v6, 4294901760, v232
    v_fmac_f32 v96, v5, v24
    v_fmac_f32 v97, v6, v24
    v_lshlrev_b32 v5, 16, v240
    v_and_b32 v6, 4294901760, v240
    v_fmac_f32 v96, v5, v25
    v_fmac_f32 v97, v6, v25
    v_lshlrev_b32 v5, 16, v248
    v_and_b32 v6, 4294901760, v248
    v_fmac_f32 v96, v5, v12
    v_fmac_f32 v97, v6, v12
    v_cvt_pk_bf16_f32 v224, v96, v97
    v_lshlrev_b32 v5, 16, v233
    v_and_b32 v6, 4294901760, v233
    v_fmac_f32 v98, v5, v24
    v_fmac_f32 v99, v6, v24
    v_lshlrev_b32 v5, 16, v241
    v_and_b32 v6, 4294901760, v241
    v_fmac_f32 v98, v5, v25
    v_fmac_f32 v99, v6, v25
    v_lshlrev_b32 v5, 16, v249
    v_and_b32 v6, 4294901760, v249
    v_fmac_f32 v98, v5, v12
    v_fmac_f32 v99, v6, v12
    v_cvt_pk_bf16_f32 v225, v98, v99
    v_lshlrev_b32 v5, 16, v234
    v_and_b32 v6, 4294901760, v234
    v_fmac_f32 v100, v5, v24
    v_fmac_f32 v101, v6, v24
    v_lshlrev_b32 v5, 16, v242
    v_and_b32 v6, 4294901760, v242
    v_fmac_f32 v100, v5, v25
    v_fmac_f32 v101, v6, v25
    v_lshlrev_b32 v5, 16, v250
    v_and_b32 v6, 4294901760, v250
    v_fmac_f32 v100, v5, v12
    v_fmac_f32 v101, v6, v12
    v_cvt_pk_bf16_f32 v226, v100, v101
    v_lshlrev_b32 v5, 16, v235
    v_and_b32 v6, 4294901760, v235
    v_fmac_f32 v102, v5, v24
    v_fmac_f32 v103, v6, v24
    v_lshlrev_b32 v5, 16, v243
    v_and_b32 v6, 4294901760, v243
    v_fmac_f32 v102, v5, v25
    v_fmac_f32 v103, v6, v25
    v_lshlrev_b32 v5, 16, v251
    v_and_b32 v6, 4294901760, v251
    v_fmac_f32 v102, v5, v12
    v_fmac_f32 v103, v6, v12
    v_cvt_pk_bf16_f32 v227, v102, v103
    s_waitcnt lgkmcnt(0)
    v_lshlrev_b32 v5, 16, v236
    v_and_b32 v6, 4294901760, v236
    v_fmac_f32 v104, v5, v24
    v_fmac_f32 v105, v6, v24
    v_lshlrev_b32 v5, 16, v244
    v_and_b32 v6, 4294901760, v244
    v_fmac_f32 v104, v5, v25
    v_fmac_f32 v105, v6, v25
    v_lshlrev_b32 v5, 16, v252
    v_and_b32 v6, 4294901760, v252
    v_fmac_f32 v104, v5, v12
    v_fmac_f32 v105, v6, v12
    v_cvt_pk_bf16_f32 v228, v104, v105
    v_lshlrev_b32 v5, 16, v237
    v_and_b32 v6, 4294901760, v237
    v_fmac_f32 v106, v5, v24
    v_fmac_f32 v107, v6, v24
    v_lshlrev_b32 v5, 16, v245
    v_and_b32 v6, 4294901760, v245
    v_fmac_f32 v106, v5, v25
    v_fmac_f32 v107, v6, v25
    v_lshlrev_b32 v5, 16, v253
    v_and_b32 v6, 4294901760, v253
    v_fmac_f32 v106, v5, v12
    v_fmac_f32 v107, v6, v12
    v_cvt_pk_bf16_f32 v229, v106, v107
    v_lshlrev_b32 v5, 16, v238
    v_and_b32 v6, 4294901760, v238
    v_fmac_f32 v108, v5, v24
    v_fmac_f32 v109, v6, v24
    v_lshlrev_b32 v5, 16, v246
    v_and_b32 v6, 4294901760, v246
    v_fmac_f32 v108, v5, v25
    v_fmac_f32 v109, v6, v25
    v_lshlrev_b32 v5, 16, v254
    v_and_b32 v6, 4294901760, v254
    v_fmac_f32 v108, v5, v12
    v_fmac_f32 v109, v6, v12
    v_cvt_pk_bf16_f32 v230, v108, v109
    v_lshlrev_b32 v5, 16, v239
    v_and_b32 v6, 4294901760, v239
    v_fmac_f32 v110, v5, v24
    v_fmac_f32 v111, v6, v24
    v_lshlrev_b32 v5, 16, v247
    v_and_b32 v6, 4294901760, v247
    v_fmac_f32 v110, v5, v25
    v_fmac_f32 v111, v6, v25
    v_lshlrev_b32 v5, 16, v255
    v_and_b32 v6, 4294901760, v255
    v_fmac_f32 v110, v5, v12
    v_fmac_f32 v111, v6, v12
    v_cvt_pk_bf16_f32 v231, v110, v111
    ds_write_b128 v31, v[224:227]
    ds_write_b128 v31, v[228:231] offset:1024
    s_waitcnt vmcnt(0) lgkmcnt(0)
    s_barrier
    s_setprio 1
    s_mul_i32 s70, s82, 52224
    s_add_u32 s70, s70, 34816
    v_add_u32 v22, s70, v16
    v_add_u32 v23, s70, v30
    ds_read_b64_tr_b16 v[128:129], v22 offset:64
    ds_read_b64_tr_b16 v[130:131], v22 offset:576
    ds_read_b64_tr_b16 v[132:133], v22
    ds_read_b64_tr_b16 v[134:135], v22 offset:512
    ds_read_b64_tr_b16 v[136:137], v23 offset:64
    ds_read_b64_tr_b16 v[138:139], v23 offset:576
    ds_read_b64_tr_b16 v[140:141], v23
    ds_read_b64_tr_b16 v[142:143], v23 offset:512
    ds_read_b64_tr_b16 v[144:145], v22 offset:4416
    ds_read_b64_tr_b16 v[146:147], v22 offset:4928
    ds_read_b64_tr_b16 v[148:149], v22 offset:4352
    ds_read_b64_tr_b16 v[150:151], v22 offset:4864
    s_waitcnt lgkmcnt(10)
    v_mfma_f32_32x32x16_bf16 v[32:47], v[128:131], v[176:179], v[32:47]
    ds_read_b64_tr_b16 v[152:153], v23 offset:4416
    ds_read_b64_tr_b16 v[154:155], v23 offset:4928
    s_waitcnt lgkmcnt(10)
    v_mfma_f32_32x32x16_bf16 v[48:63], v[132:135], v[176:179], v[48:63]
    ds_read_b64_tr_b16 v[156:157], v23 offset:4352
    ds_read_b64_tr_b16 v[158:159], v23 offset:4864
    s_waitcnt lgkmcnt(10)
    v_mfma_f32_32x32x16_bf16 v[64:79], v[136:139], v[176:179], v[64:79]
    ds_read_b64_tr_b16 v[128:129], v22 offset:8768
    ds_read_b64_tr_b16 v[130:131], v22 offset:9280
    s_waitcnt lgkmcnt(10)
    v_mfma_f32_32x32x16_bf16 v[80:95], v[140:143], v[176:179], v[80:95]
    ds_read_b64_tr_b16 v[132:133], v22 offset:8704
    ds_read_b64_tr_b16 v[134:135], v22 offset:9216
    s_waitcnt lgkmcnt(10)
    v_mfma_f32_32x32x16_bf16 v[32:47], v[144:147], v[180:183], v[32:47]
    ds_read_b64_tr_b16 v[136:137], v23 offset:8768
    ds_read_b64_tr_b16 v[138:139], v23 offset:9280
    s_waitcnt lgkmcnt(10)
    v_mfma_f32_32x32x16_bf16 v[48:63], v[148:151], v[180:183], v[48:63]
    ds_read_b64_tr_b16 v[140:141], v23 offset:8704
    ds_read_b64_tr_b16 v[142:143], v23 offset:9216
    s_waitcnt lgkmcnt(10)
    v_mfma_f32_32x32x16_bf16 v[64:79], v[152:155], v[180:183], v[64:79]
    ds_read_b64_tr_b16 v[144:145], v22 offset:13120
    ds_read_b64_tr_b16 v[146:147], v22 offset:13632
    s_waitcnt lgkmcnt(10)
    v_mfma_f32_32x32x16_bf16 v[80:95], v[156:159], v[180:183], v[80:95]
    ds_read_b64_tr_b16 v[148:149], v22 offset:13056
    ds_read_b64_tr_b16 v[150:151], v22 offset:13568
    s_waitcnt lgkmcnt(10)
    v_mfma_f32_32x32x16_bf16 v[32:47], v[128:131], v[184:187], v[32:47]
    ds_read_b64_tr_b16 v[152:153], v23 offset:13120
    ds_read_b64_tr_b16 v[154:155], v23 offset:13632
    s_waitcnt lgkmcnt(10)
    v_mfma_f32_32x32x16_bf16 v[48:63], v[132:135], v[184:187], v[48:63]
    ds_read_b64_tr_b16 v[156:157], v23 offset:13056
    ds_read_b64_tr_b16 v[158:159], v23 offset:13568
    s_waitcnt lgkmcnt(10)
    v_mfma_f32_32x32x16_bf16 v[64:79], v[136:139], v[184:187], v[64:79]
    s_waitcnt lgkmcnt(8)
    v_mfma_f32_32x32x16_bf16 v[80:95], v[140:143], v[184:187], v[80:95]
    s_waitcnt lgkmcnt(6)
    v_mfma_f32_32x32x16_bf16 v[32:47], v[144:147], v[188:191], v[32:47]
    s_waitcnt lgkmcnt(4)
    v_mfma_f32_32x32x16_bf16 v[48:63], v[148:151], v[188:191], v[48:63]
    s_waitcnt lgkmcnt(2)
    v_mfma_f32_32x32x16_bf16 v[64:79], v[152:155], v[188:191], v[64:79]
    s_waitcnt lgkmcnt(0)
    v_mfma_f32_32x32x16_bf16 v[80:95], v[156:159], v[188:191], v[80:95]
    s_add_u32 m0, s65, 0
    s_add_u32 s69, s26, 256
    buffer_load_dwordx4 v4, s[40:43], s69 offen nt lds
    s_add_u32 m0, s65, 4352
    s_add_u32 s69, s26, 8448
    buffer_load_dwordx4 v4, s[40:43], s69 offen nt lds
    s_add_u32 m0, s65, 8704
    s_add_u32 s69, s27, 256
    buffer_load_dwordx4 v4, s[40:43], s69 offen nt lds
    s_add_u32 m0, s65, 13056
    s_add_u32 s69, s27, 8448
    buffer_load_dwordx4 v4, s[40:43], s69 offen nt lds
    s_add_u32 m0, s65, 69632
    s_add_u32 s69, s26, 16640
    buffer_load_dwordx4 v4, s[40:43], s69 offen nt lds
    s_add_u32 m0, s65, 73984
    s_add_u32 s69, s26, 24832
    buffer_load_dwordx4 v4, s[40:43], s69 offen nt lds
    s_add_u32 m0, s65, 78336
    s_add_u32 s69, s27, 16640
    buffer_load_dwordx4 v4, s[40:43], s69 offen nt lds
    s_add_u32 m0, s65, 82688
    s_add_u32 s69, s27, 24832
    buffer_load_dwordx4 v4, s[40:43], s69 offen nt lds
    s_barrier
    s_setprio 0
    ds_read_b128 v[96:99], v19
    ds_read_b128 v[100:103], v19 offset:1024
    ds_read_b128 v[104:107], v19 offset:24576
    ds_read_b128 v[108:111], v19 offset:25600
    ds_read_b128 v[112:115], v19 offset:12288
    ds_read_b128 v[116:119], v19 offset:13312
    ds_read_b128 v[120:123], v19 offset:36864
    ds_read_b128 v[124:127], v19 offset:37888
    s_waitcnt vmcnt(0) lgkmcnt(0)
    s_barrier
    s_setprio 1
    s_mul_i32 s70, s82, 69632
    s_add_u32 s70, s70, 0
    v_add_u32 v22, s70, v16
    v_add_u32 v23, s70, v30
    ds_read_b64_tr_b16 v[128:129], v22 offset:64
    ds_read_b64_tr_b16 v[130:131], v22 offset:576
    ds_read_b64_tr_b16 v[132:133], v22
    ds_read_b64_tr_b16 v[134:135], v22 offset:512
    ds_read_b64_tr_b16 v[136:137], v23 offset:64
    ds_read_b64_tr_b16 v[138:139], v23 offset:576
    ds_read_b64_tr_b16 v[140:141], v23
    ds_read_b64_tr_b16 v[142:143], v23 offset:512
    ds_read_b64_tr_b16 v[144:145], v22 offset:4416
    ds_read_b64_tr_b16 v[146:147], v22 offset:4928
    ds_read_b64_tr_b16 v[148:149], v22 offset:4352
    ds_read_b64_tr_b16 v[150:151], v22 offset:4864
    s_waitcnt lgkmcnt(10)
    v_mfma_f32_32x32x16_bf16 v[32:47], v[128:131], v[192:195], v[32:47]
    ds_read_b64_tr_b16 v[152:153], v23 offset:4416
    ds_read_b64_tr_b16 v[154:155], v23 offset:4928
    s_waitcnt lgkmcnt(10)
    v_mfma_f32_32x32x16_bf16 v[48:63], v[132:135], v[192:195], v[48:63]
    ds_read_b64_tr_b16 v[156:157], v23 offset:4352
    ds_read_b64_tr_b16 v[158:159], v23 offset:4864
    s_waitcnt lgkmcnt(10)
    v_mfma_f32_32x32x16_bf16 v[64:79], v[136:139], v[192:195], v[64:79]
    ds_read_b64_tr_b16 v[128:129], v22 offset:8768
    ds_read_b64_tr_b16 v[130:131], v22 offset:9280
    s_waitcnt lgkmcnt(10)
    v_mfma_f32_32x32x16_bf16 v[80:95], v[140:143], v[192:195], v[80:95]
    ds_read_b64_tr_b16 v[132:133], v22 offset:8704
    ds_read_b64_tr_b16 v[134:135], v22 offset:9216
    s_waitcnt lgkmcnt(10)
    v_mfma_f32_32x32x16_bf16 v[32:47], v[144:147], v[196:199], v[32:47]
    ds_read_b64_tr_b16 v[136:137], v23 offset:8768
    ds_read_b64_tr_b16 v[138:139], v23 offset:9280
    s_waitcnt lgkmcnt(10)
    v_mfma_f32_32x32x16_bf16 v[48:63], v[148:151], v[196:199], v[48:63]
    ds_read_b64_tr_b16 v[140:141], v23 offset:8704
    ds_read_b64_tr_b16 v[142:143], v23 offset:9216
    s_waitcnt lgkmcnt(10)
    v_mfma_f32_32x32x16_bf16 v[64:79], v[152:155], v[196:199], v[64:79]
    ds_read_b64_tr_b16 v[144:145], v22 offset:13120
    ds_read_b64_tr_b16 v[146:147], v22 offset:13632
    s_waitcnt lgkmcnt(10)
    v_mfma_f32_32x32x16_bf16 v[80:95], v[156:159], v[196:199], v[80:95]
    ds_read_b64_tr_b16 v[148:149], v22 offset:13056
    ds_read_b64_tr_b16 v[150:151], v22 offset:13568
    s_waitcnt lgkmcnt(10)
    v_mfma_f32_32x32x16_bf16 v[32:47], v[128:131], v[200:203], v[32:47]
    ds_read_b64_tr_b16 v[152:153], v23 offset:13120
    ds_read_b64_tr_b16 v[154:155], v23 offset:13632
    s_waitcnt lgkmcnt(10)
    v_mfma_f32_32x32x16_bf16 v[48:63], v[132:135], v[200:203], v[48:63]
    ds_read_b64_tr_b16 v[156:157], v23 offset:13056
    ds_read_b64_tr_b16 v[158:159], v23 offset:13568
    s_waitcnt lgkmcnt(10)
    v_mfma_f32_32x32x16_bf16 v[64:79], v[136:139], v[200:203], v[64:79]
    s_waitcnt lgkmcnt(8)
    v_mfma_f32_32x32x16_bf16 v[80:95], v[140:143], v[200:203], v[80:95]
    s_waitcnt lgkmcnt(6)
    v_mfma_f32_32x32x16_bf16 v[32:47], v[144:147], v[204:207], v[32:47]
    s_waitcnt lgkmcnt(4)
    v_mfma_f32_32x32x16_bf16 v[48:63], v[148:151], v[204:207], v[48:63]
    s_waitcnt lgkmcnt(2)
    v_mfma_f32_32x32x16_bf16 v[64:79], v[152:155], v[204:207], v[64:79]
    s_waitcnt lgkmcnt(0)
    v_mfma_f32_32x32x16_bf16 v[80:95], v[156:159], v[204:207], v[80:95]
    s_add_u32 m0, s65, 17408
    s_add_u32 s69, s28, 256
    buffer_load_dwordx4 v4, s[40:43], s69 offen nt lds
    s_add_u32 m0, s65, 21760
    s_add_u32 s69, s28, 8448
    buffer_load_dwordx4 v4, s[40:43], s69 offen nt lds
    s_add_u32 m0, s65, 26112
    s_add_u32 s69, s29, 256
    buffer_load_dwordx4 v4, s[40:43], s69 offen nt lds
    s_add_u32 m0, s65, 30464
    s_add_u32 s69, s29, 8448
    buffer_load_dwordx4 v4, s[40:43], s69 offen nt lds
    s_add_u32 m0, s65, 52224
    s_add_u32 s69, s28, 16640
    buffer_load_dwordx4 v4, s[40:43], s69 offen nt lds
    s_add_u32 m0, s65, 56576
    s_add_u32 s69, s28, 24832
    buffer_load_dwordx4 v4, s[40:43], s69 offen nt lds
    s_add_u32 m0, s65, 60928
    s_add_u32 s69, s29, 16640
    buffer_load_dwordx4 v4, s[40:43], s69 offen nt lds
    s_add_u32 m0, s65, 65280
    s_add_u32 s69, s29, 24832
    buffer_load_dwordx4 v4, s[40:43], s69 offen nt lds
    s_add_u32 m0, s65, 139264
    s_mov_b32 s69, 512
    buffer_load_dwordx4 v1, s[48:51], s69 offen lds
    s_add_u32 m0, s65, 143616
    s_mov_b32 s69, 29184
    buffer_load_dwordx4 v1, s[48:51], s69 offen lds
    s_add_u32 m0, s65, 147968
    s_mov_b32 s69, 57856
    buffer_load_dwordx4 v1, s[48:51], s69 offen lds
    s_add_u32 m0, s65, 152320
    s_mov_b32 s69, 86528
    buffer_load_dwordx4 v1, s[48:51], s69 offen lds
    s_barrier
    s_setprio 0
    s_waitcnt vmcnt(4)
    s_barrier
    s_setprio 1
    s_mul_i32 s70, s82, 34816
    s_add_u32 s70, s70, 17408
    v_add_u32 v22, s70, v16
    v_add_u32 v23, s70, v30
    ds_read_b64_tr_b16 v[128:129], v22 offset:64
    ds_read_b64_tr_b16 v[130:131], v22 offset:576
    ds_read_b64_tr_b16 v[132:133], v22
    ds_read_b64_tr_b16 v[134:135], v22 offset:512
    ds_read_b64_tr_b16 v[136:137], v23 offset:64
    ds_read_b64_tr_b16 v[138:139], v23 offset:576
    ds_read_b64_tr_b16 v[140:141], v23
    ds_read_b64_tr_b16 v[142:143], v23 offset:512
    ds_read_b64_tr_b16 v[144:145], v22 offset:4416
    ds_read_b64_tr_b16 v[146:147], v22 offset:4928
    ds_read_b64_tr_b16 v[148:149], v22 offset:4352
    ds_read_b64_tr_b16 v[150:151], v22 offset:4864
    s_waitcnt lgkmcnt(10)
    v_mfma_f32_32x32x16_bf16 v[32:47], v[128:131], v[208:211], v[32:47]
    ds_read_b64_tr_b16 v[152:153], v23 offset:4416
    ds_read_b64_tr_b16 v[154:155], v23 offset:4928
    s_waitcnt lgkmcnt(10)
    v_mfma_f32_32x32x16_bf16 v[48:63], v[132:135], v[208:211], v[48:63]
    ds_read_b64_tr_b16 v[156:157], v23 offset:4352
    ds_read_b64_tr_b16 v[158:159], v23 offset:4864
    s_waitcnt lgkmcnt(10)
    v_mfma_f32_32x32x16_bf16 v[64:79], v[136:139], v[208:211], v[64:79]
    ds_read_b64_tr_b16 v[128:129], v22 offset:8768
    ds_read_b64_tr_b16 v[130:131], v22 offset:9280
    s_waitcnt lgkmcnt(10)
    v_mfma_f32_32x32x16_bf16 v[80:95], v[140:143], v[208:211], v[80:95]
    ds_read_b64_tr_b16 v[132:133], v22 offset:8704
    ds_read_b64_tr_b16 v[134:135], v22 offset:9216
    s_waitcnt lgkmcnt(10)
    v_mfma_f32_32x32x16_bf16 v[32:47], v[144:147], v[212:215], v[32:47]
    ds_read_b64_tr_b16 v[136:137], v23 offset:8768
    ds_read_b64_tr_b16 v[138:139], v23 offset:9280
    s_waitcnt lgkmcnt(10)
    v_mfma_f32_32x32x16_bf16 v[48:63], v[148:151], v[212:215], v[48:63]
    ds_read_b64_tr_b16 v[140:141], v23 offset:8704
    ds_read_b64_tr_b16 v[142:143], v23 offset:9216
    s_waitcnt lgkmcnt(10)
    v_mfma_f32_32x32x16_bf16 v[64:79], v[152:155], v[212:215], v[64:79]
    ds_read_b64_tr_b16 v[144:145], v22 offset:13120
    ds_read_b64_tr_b16 v[146:147], v22 offset:13632
    s_waitcnt lgkmcnt(10)
    v_mfma_f32_32x32x16_bf16 v[80:95], v[156:159], v[212:215], v[80:95]
    ds_read_b64_tr_b16 v[148:149], v22 offset:13056
    ds_read_b64_tr_b16 v[150:151], v22 offset:13568
    s_waitcnt lgkmcnt(10)
    v_mfma_f32_32x32x16_bf16 v[32:47], v[128:131], v[216:219], v[32:47]
    ds_read_b64_tr_b16 v[152:153], v23 offset:13120
    ds_read_b64_tr_b16 v[154:155], v23 offset:13632
    s_waitcnt lgkmcnt(10)
    v_mfma_f32_32x32x16_bf16 v[48:63], v[132:135], v[216:219], v[48:63]
    ds_read_b64_tr_b16 v[156:157], v23 offset:13056
    ds_read_b64_tr_b16 v[158:159], v23 offset:13568
    s_waitcnt lgkmcnt(10)
    v_mfma_f32_32x32x16_bf16 v[64:79], v[136:139], v[216:219], v[64:79]
    s_waitcnt lgkmcnt(8)
    v_mfma_f32_32x32x16_bf16 v[80:95], v[140:143], v[216:219], v[80:95]
    s_waitcnt lgkmcnt(6)
    v_mfma_f32_32x32x16_bf16 v[32:47], v[144:147], v[220:223], v[32:47]
    s_waitcnt lgkmcnt(4)
    v_mfma_f32_32x32x16_bf16 v[48:63], v[148:151], v[220:223], v[48:63]
    s_waitcnt lgkmcnt(2)
    v_mfma_f32_32x32x16_bf16 v[64:79], v[152:155], v[220:223], v[64:79]
    s_waitcnt lgkmcnt(0)
    v_mfma_f32_32x32x16_bf16 v[80:95], v[156:159], v[220:223], v[80:95]
    s_add_u32 m0, s65, 87040
    s_mov_b32 s69, 640
    buffer_load_dwordx4 v1, s[48:51], s69 offen lds
    s_add_u32 m0, s65, 91392
    s_mov_b32 s69, 29312
    buffer_load_dwordx4 v1, s[48:51], s69 offen lds
    s_add_u32 m0, s65, 95744
    s_mov_b32 s69, 57984
    buffer_load_dwordx4 v1, s[48:51], s69 offen lds
    s_add_u32 m0, s65, 100096
    s_mov_b32 s69, 86656
    buffer_load_dwordx4 v1, s[48:51], s69 offen lds
    s_waitcnt vmcnt(4)
    s_barrier
    s_setprio 0
    v_add_u32 v23, 139264, v15
    ds_read_b64_tr_b16 v[128:129], v23
    ds_read_b64_tr_b16 v[130:131], v23 offset:256
    ds_read_b64_tr_b16 v[132:133], v23 offset:512
    ds_read_b64_tr_b16 v[134:135], v23 offset:768
    ds_read_b64_tr_b16 v[136:137], v23 offset:4352
    ds_read_b64_tr_b16 v[138:139], v23 offset:4608
    ds_read_b64_tr_b16 v[140:141], v23 offset:4864
    ds_read_b64_tr_b16 v[142:143], v23 offset:5120
    ds_read_b64_tr_b16 v[144:145], v23 offset:8704
    ds_read_b64_tr_b16 v[146:147], v23 offset:8960
    ds_read_b64_tr_b16 v[148:149], v23 offset:9216
    ds_read_b64_tr_b16 v[150:151], v23 offset:9472
    ds_read_b64_tr_b16 v[152:153], v23 offset:13056
    ds_read_b64_tr_b16 v[154:155], v23 offset:13312
    ds_read_b64_tr_b16 v[156:157], v23 offset:13568
    ds_read_b64_tr_b16 v[158:159], v23 offset:13824
    s_add_u32 m0, s65, 17408
    s_mov_b32 s69, 768
    buffer_load_dwordx4 v1, s[48:51], s69 offen lds
    s_add_u32 m0, s65, 21760
    s_mov_b32 s69, 29440
    buffer_load_dwordx4 v1, s[48:51], s69 offen lds
    s_add_u32 m0, s65, 26112
    s_mov_b32 s69, 58112
    buffer_load_dwordx4 v1, s[48:51], s69 offen lds
    s_add_u32 m0, s65, 30464
    s_mov_b32 s69, 86784
    buffer_load_dwordx4 v1, s[48:51], s69 offen lds
    s_add_u32 m0, s65, 52224
    s_mov_b32 s69, 115200
    buffer_load_dwordx4 v1, s[48:51], s69 offen lds
    s_add_u32 m0, s65, 56576
    s_mov_b32 s69, 143872
    buffer_load_dwordx4 v1, s[48:51], s69 offen lds
    s_add_u32 m0, s65, 60928
    s_mov_b32 s69, 172544
    buffer_load_dwordx4 v1, s[48:51], s69 offen lds
    s_add_u32 m0, s65, 65280
    s_mov_b32 s69, 201216
    buffer_load_dwordx4 v1, s[48:51], s69 offen lds
    s_waitcnt vmcnt(8) lgkmcnt(0)
    s_barrier
    s_setprio 1
    v_add_u32 v23, 87040, v15
    v_mfma_f32_32x32x16_bf16 v[192:207], v[128:131], v[96:99], 0
    ds_read_b64_tr_b16 v[128:129], v23
    ds_read_b64_tr_b16 v[130:131], v23 offset:256
    v_mfma_f32_32x32x16_bf16 v[192:207], v[132:135], v[100:103], v[192:207]
    ds_read_b64_tr_b16 v[132:133], v23 offset:512
    ds_read_b64_tr_b16 v[134:135], v23 offset:768
    v_mfma_f32_32x32x16_bf16 v[192:207], v[136:139], v[104:107], v[192:207]
    ds_read_b64_tr_b16 v[136:137], v23 offset:4352
    ds_read_b64_tr_b16 v[138:139], v23 offset:4608
    v_mfma_f32_32x32x16_bf16 v[192:207], v[140:143], v[108:111], v[192:207]
    ds_read_b64_tr_b16 v[140:141], v23 offset:4864
    ds_read_b64_tr_b16 v[142:143], v23 offset:5120
    v_mfma_f32_32x32x16_bf16 v[192:207], v[144:147], v[112:115], v[192:207]
    ds_read_b64_tr_b16 v[144:145], v23 offset:8704
    ds_read_b64_tr_b16 v[146:147], v23 offset:8960
    v_mfma_f32_32x32x16_bf16 v[192:207], v[148:151], v[116:119], v[192:207]
    ds_read_b64_tr_b16 v[148:149], v23 offset:9216
    ds_read_b64_tr_b16 v[150:151], v23 offset:9472
    v_mfma_f32_32x32x16_bf16 v[192:207], v[152:155], v[120:123], v[192:207]
    ds_read_b64_tr_b16 v[152:153], v23 offset:13056
    ds_read_b64_tr_b16 v[154:155], v23 offset:13312
    v_mfma_f32_32x32x16_bf16 v[192:207], v[156:159], v[124:127], v[192:207]
    ds_read_b64_tr_b16 v[156:157], v23 offset:13568
    ds_read_b64_tr_b16 v[158:159], v23 offset:13824
    s_barrier
    s_setprio 0
    s_xor_b32 s70, s64, 4
    s_mul_i32 s70, s70, 6144
    s_add_u32 s70, s70, 104448
    v_add_u32 v6, s70, v18
    v_cvt_pk_bf16_f32 v48, v48, v49
    v_cvt_pk_bf16_f32 v49, v50, v51
    v_cvt_pk_bf16_f32 v50, v52, v53
    v_cvt_pk_bf16_f32 v51, v54, v55
    ds_write_b128 v6, v[48:51]
    v_cvt_pk_bf16_f32 v52, v56, v57
    v_cvt_pk_bf16_f32 v53, v58, v59
    v_cvt_pk_bf16_f32 v54, v60, v61
    v_cvt_pk_bf16_f32 v55, v62, v63
    ds_write_b128 v6, v[52:55] offset:1024
    s_xor_b32 s70, s64, 2
    s_mul_i32 s70, s70, 6144
    s_add_u32 s70, s70, 106496
    v_add_u32 v6, s70, v18
    v_cvt_pk_bf16_f32 v64, v64, v65
    v_cvt_pk_bf16_f32 v65, v66, v67
    v_cvt_pk_bf16_f32 v66, v68, v69
    v_cvt_pk_bf16_f32 v67, v70, v71
    ds_write_b128 v6, v[64:67]
    v_cvt_pk_bf16_f32 v68, v72, v73
    v_cvt_pk_bf16_f32 v69, v74, v75
    v_cvt_pk_bf16_f32 v70, v76, v77
    v_cvt_pk_bf16_f32 v71, v78, v79
    ds_write_b128 v6, v[68:71] offset:1024
    s_xor_b32 s70, s64, 6
    s_mul_i32 s70, s70, 6144
    s_add_u32 s70, s70, 108544
    v_add_u32 v6, s70, v18
    v_cvt_pk_bf16_f32 v80, v80, v81
    v_cvt_pk_bf16_f32 v81, v82, v83
    v_cvt_pk_bf16_f32 v82, v84, v85
    v_cvt_pk_bf16_f32 v83, v86, v87
    ds_write_b128 v6, v[80:83]
    v_cvt_pk_bf16_f32 v84, v88, v89
    v_cvt_pk_bf16_f32 v85, v90, v91
    v_cvt_pk_bf16_f32 v86, v92, v93
    v_cvt_pk_bf16_f32 v87, v94, v95
    ds_write_b128 v6, v[84:87] offset:1024
    s_waitcnt vmcnt(4) lgkmcnt(0)
    s_barrier
    s_setprio 1
    v_add_u32 v23, 17408, v15
    v_mfma_f32_32x32x16_bf16 v[208:223], v[128:131], v[96:99], 0
    ds_read_b64_tr_b16 v[128:129], v23
    ds_read_b64_tr_b16 v[130:131], v23 offset:256
    v_mfma_f32_32x32x16_bf16 v[208:223], v[132:135], v[100:103], v[208:223]
    ds_read_b64_tr_b16 v[132:133], v23 offset:512
    ds_read_b64_tr_b16 v[134:135], v23 offset:768
    v_mfma_f32_32x32x16_bf16 v[208:223], v[136:139], v[104:107], v[208:223]
    ds_read_b64_tr_b16 v[136:137], v23 offset:4352
    ds_read_b64_tr_b16 v[138:139], v23 offset:4608
    v_mfma_f32_32x32x16_bf16 v[208:223], v[140:143], v[108:111], v[208:223]
    ds_read_b64_tr_b16 v[140:141], v23 offset:4864
    ds_read_b64_tr_b16 v[142:143], v23 offset:5120
    v_mfma_f32_32x32x16_bf16 v[208:223], v[144:147], v[112:115], v[208:223]
    ds_read_b64_tr_b16 v[144:145], v23 offset:8704
    ds_read_b64_tr_b16 v[146:147], v23 offset:8960
    v_mfma_f32_32x32x16_bf16 v[208:223], v[148:151], v[116:119], v[208:223]
    ds_read_b64_tr_b16 v[148:149], v23 offset:9216
    ds_read_b64_tr_b16 v[150:151], v23 offset:9472
    v_mfma_f32_32x32x16_bf16 v[208:223], v[152:155], v[120:123], v[208:223]
    ds_read_b64_tr_b16 v[152:153], v23 offset:13056
    ds_read_b64_tr_b16 v[154:155], v23 offset:13312
    v_mfma_f32_32x32x16_bf16 v[208:223], v[156:159], v[124:127], v[208:223]
    ds_read_b64_tr_b16 v[156:157], v23 offset:13568
    ds_read_b64_tr_b16 v[158:159], v23 offset:13824
    s_barrier
    s_setprio 0
    s_add_u32 m0, s65, 0
    s_mov_b32 s69, 115328
    buffer_load_dwordx4 v1, s[48:51], s69 offen lds
    s_add_u32 m0, s65, 4352
    s_mov_b32 s69, 144000
    buffer_load_dwordx4 v1, s[48:51], s69 offen lds
    s_add_u32 m0, s65, 8704
    s_mov_b32 s69, 172672
    buffer_load_dwordx4 v1, s[48:51], s69 offen lds
    s_add_u32 m0, s65, 13056
    s_mov_b32 s69, 201344
    buffer_load_dwordx4 v1, s[48:51], s69 offen lds
    ds_read_b128 v[232:235], v31
    ds_read_b128 v[240:243], v31 offset:2048
    ds_read_b128 v[248:251], v31 offset:4096
    ds_read_b128 v[236:239], v31 offset:1024
    ds_read_b128 v[244:247], v31 offset:3072
    ds_read_b128 v[252:255], v31 offset:5120
    v_mul_f32 v32, v13, v32
    v_mul_f32 v33, v13, v33
    v_mul_f32 v34, v13, v34
    v_mul_f32 v35, v13, v35
    v_mul_f32 v36, v13, v36
    v_mul_f32 v37, v13, v37
    v_mul_f32 v38, v13, v38
    v_mul_f32 v39, v13, v39
    v_mul_f32 v40, v13, v40
    v_mul_f32 v41, v13, v41
    v_mul_f32 v42, v13, v42
    v_mul_f32 v43, v13, v43
    v_mul_f32 v44, v13, v44
    v_mul_f32 v45, v13, v45
    v_mul_f32 v46, v13, v46
    v_mul_f32 v47, v13, v47
    s_waitcnt lgkmcnt(3)
    v_lshlrev_b32 v5, 16, v232
    v_and_b32 v6, 4294901760, v232
    v_fmac_f32 v32, v5, v24
    v_fmac_f32 v33, v6, v24
    v_lshlrev_b32 v5, 16, v240
    v_and_b32 v6, 4294901760, v240
    v_fmac_f32 v32, v5, v25
    v_fmac_f32 v33, v6, v25
    v_lshlrev_b32 v5, 16, v248
    v_and_b32 v6, 4294901760, v248
    v_fmac_f32 v32, v5, v12
    v_fmac_f32 v33, v6, v12
    v_cvt_pk_bf16_f32 v224, v32, v33
    v_lshlrev_b32 v5, 16, v233
    v_and_b32 v6, 4294901760, v233
    v_fmac_f32 v34, v5, v24
    v_fmac_f32 v35, v6, v24
    v_lshlrev_b32 v5, 16, v241
    v_and_b32 v6, 4294901760, v241
    v_fmac_f32 v34, v5, v25
    v_fmac_f32 v35, v6, v25
    v_lshlrev_b32 v5, 16, v249
    v_and_b32 v6, 4294901760, v249
    v_fmac_f32 v34, v5, v12
    v_fmac_f32 v35, v6, v12
    v_cvt_pk_bf16_f32 v225, v34, v35
    v_lshlrev_b32 v5, 16, v234
    v_and_b32 v6, 4294901760, v234
    v_fmac_f32 v36, v5, v24
    v_fmac_f32 v37, v6, v24
    v_lshlrev_b32 v5, 16, v242
    v_and_b32 v6, 4294901760, v242
    v_fmac_f32 v36, v5, v25
    v_fmac_f32 v37, v6, v25
    v_lshlrev_b32 v5, 16, v250
    v_and_b32 v6, 4294901760, v250
    v_fmac_f32 v36, v5, v12
    v_fmac_f32 v37, v6, v12
    v_cvt_pk_bf16_f32 v226, v36, v37
    v_lshlrev_b32 v5, 16, v235
    v_and_b32 v6, 4294901760, v235
    v_fmac_f32 v38, v5, v24
    v_fmac_f32 v39, v6, v24
    v_lshlrev_b32 v5, 16, v243
    v_and_b32 v6, 4294901760, v243
    v_fmac_f32 v38, v5, v25
    v_fmac_f32 v39, v6, v25
    v_lshlrev_b32 v5, 16, v251
    v_and_b32 v6, 4294901760, v251
    v_fmac_f32 v38, v5, v12
    v_fmac_f32 v39, v6, v12
    v_cvt_pk_bf16_f32 v227, v38, v39
    s_waitcnt lgkmcnt(0)
    v_lshlrev_b32 v5, 16, v236
    v_and_b32 v6, 4294901760, v236
    v_fmac_f32 v40, v5, v24
    v_fmac_f32 v41, v6, v24
    v_lshlrev_b32 v5, 16, v244
    v_and_b32 v6, 4294901760, v244
    v_fmac_f32 v40, v5, v25
    v_fmac_f32 v41, v6, v25
    v_lshlrev_b32 v5, 16, v252
    v_and_b32 v6, 4294901760, v252
    v_fmac_f32 v40, v5, v12
    v_fmac_f32 v41, v6, v12
    v_cvt_pk_bf16_f32 v228, v40, v41
    v_lshlrev_b32 v5, 16, v237
    v_and_b32 v6, 4294901760, v237
    v_fmac_f32 v42, v5, v24
    v_fmac_f32 v43, v6, v24
    v_lshlrev_b32 v5, 16, v245
    v_and_b32 v6, 4294901760, v245
    v_fmac_f32 v42, v5, v25
    v_fmac_f32 v43, v6, v25
    v_lshlrev_b32 v5, 16, v253
    v_and_b32 v6, 4294901760, v253
    v_fmac_f32 v42, v5, v12
    v_fmac_f32 v43, v6, v12
    v_cvt_pk_bf16_f32 v229, v42, v43
    v_lshlrev_b32 v5, 16, v238
    v_and_b32 v6, 4294901760, v238
    v_fmac_f32 v44, v5, v24
    v_fmac_f32 v45, v6, v24
    v_lshlrev_b32 v5, 16, v246
    v_and_b32 v6, 4294901760, v246
    v_fmac_f32 v44, v5, v25
    v_fmac_f32 v45, v6, v25
    v_lshlrev_b32 v5, 16, v254
    v_and_b32 v6, 4294901760, v254
    v_fmac_f32 v44, v5, v12
    v_fmac_f32 v45, v6, v12
    v_cvt_pk_bf16_f32 v230, v44, v45
    v_lshlrev_b32 v5, 16, v239
    v_and_b32 v6, 4294901760, v239
    v_fmac_f32 v46, v5, v24
    v_fmac_f32 v47, v6, v24
    v_lshlrev_b32 v5, 16, v247
    v_and_b32 v6, 4294901760, v247
    v_fmac_f32 v46, v5, v25
    v_fmac_f32 v47, v6, v25
    v_lshlrev_b32 v5, 16, v255
    v_and_b32 v6, 4294901760, v255
    v_fmac_f32 v46, v5, v12
    v_fmac_f32 v47, v6, v12
    v_cvt_pk_bf16_f32 v231, v46, v47
    ds_write_b128 v31, v[224:227]
    ds_write_b128 v31, v[228:231] offset:1024
    s_waitcnt vmcnt(4) lgkmcnt(0)
    s_barrier
    s_setprio 1
    v_add_u32 v23, 52224, v15
    v_mfma_f32_32x32x16_bf16 v[48:63], v[128:131], v[96:99], 0
    ds_read_b64_tr_b16 v[128:129], v23
    ds_read_b64_tr_b16 v[130:131], v23 offset:256
    v_mfma_f32_32x32x16_bf16 v[48:63], v[132:135], v[100:103], v[48:63]
    ds_read_b64_tr_b16 v[132:133], v23 offset:512
    ds_read_b64_tr_b16 v[134:135], v23 offset:768
    v_mfma_f32_32x32x16_bf16 v[48:63], v[136:139], v[104:107], v[48:63]
    ds_read_b64_tr_b16 v[136:137], v23 offset:4352
    ds_read_b64_tr_b16 v[138:139], v23 offset:4608
    v_mfma_f32_32x32x16_bf16 v[48:63], v[140:143], v[108:111], v[48:63]
    ds_read_b64_tr_b16 v[140:141], v23 offset:4864
    ds_read_b64_tr_b16 v[142:143], v23 offset:5120
    v_mfma_f32_32x32x16_bf16 v[48:63], v[144:147], v[112:115], v[48:63]
    ds_read_b64_tr_b16 v[144:145], v23 offset:8704
    ds_read_b64_tr_b16 v[146:147], v23 offset:8960
    v_mfma_f32_32x32x16_bf16 v[48:63], v[148:151], v[116:119], v[48:63]
    ds_read_b64_tr_b16 v[148:149], v23 offset:9216
    ds_read_b64_tr_b16 v[150:151], v23 offset:9472
    v_mfma_f32_32x32x16_bf16 v[48:63], v[152:155], v[120:123], v[48:63]
    ds_read_b64_tr_b16 v[152:153], v23 offset:13056
    ds_read_b64_tr_b16 v[154:155], v23 offset:13312
    v_mfma_f32_32x32x16_bf16 v[48:63], v[156:159], v[124:127], v[48:63]
    ds_read_b64_tr_b16 v[156:157], v23 offset:13568
    ds_read_b64_tr_b16 v[158:159], v23 offset:13824
    s_barrier
    s_setprio 0
    ds_read_b128 v[160:163], v19
    ds_read_b128 v[164:167], v19 offset:1024
    ds_read_b128 v[168:171], v19 offset:24576
    ds_read_b128 v[172:175], v19 offset:25600
    ds_read_b128 v[176:179], v19 offset:12288
    ds_read_b128 v[180:183], v19 offset:13312
    ds_read_b128 v[184:187], v19 offset:36864
    ds_read_b128 v[188:191], v19 offset:37888
    s_add_u32 m0, s65, 69632
    s_mov_b32 s69, 115456
    buffer_load_dwordx4 v1, s[48:51], s69 offen lds
    s_add_u32 m0, s65, 73984
    s_mov_b32 s69, 144128
    buffer_load_dwordx4 v1, s[48:51], s69 offen lds
    s_add_u32 m0, s65, 78336
    s_mov_b32 s69, 172800
    buffer_load_dwordx4 v1, s[48:51], s69 offen lds
    s_add_u32 m0, s65, 82688
    s_mov_b32 s69, 201472
    buffer_load_dwordx4 v1, s[48:51], s69 offen lds
    s_waitcnt vmcnt(4) lgkmcnt(0)
    s_barrier
    s_setprio 1
    v_add_u32 v23, 0, v15
    v_mfma_f32_32x32x16_bf16 v[192:207], v[128:131], v[160:163], v[192:207]
    ds_read_b64_tr_b16 v[128:129], v23
    ds_read_b64_tr_b16 v[130:131], v23 offset:256
    v_mfma_f32_32x32x16_bf16 v[192:207], v[132:135], v[164:167], v[192:207]
    ds_read_b64_tr_b16 v[132:133], v23 offset:512
    ds_read_b64_tr_b16 v[134:135], v23 offset:768
    v_mfma_f32_32x32x16_bf16 v[192:207], v[136:139], v[168:171], v[192:207]
    ds_read_b64_tr_b16 v[136:137], v23 offset:4352
    ds_read_b64_tr_b16 v[138:139], v23 offset:4608
    v_mfma_f32_32x32x16_bf16 v[192:207], v[140:143], v[172:175], v[192:207]
    ds_read_b64_tr_b16 v[140:141], v23 offset:4864
    ds_read_b64_tr_b16 v[142:143], v23 offset:5120
    v_mfma_f32_32x32x16_bf16 v[192:207], v[144:147], v[176:179], v[192:207]
    ds_read_b64_tr_b16 v[144:145], v23 offset:8704
    ds_read_b64_tr_b16 v[146:147], v23 offset:8960
    v_mfma_f32_32x32x16_bf16 v[192:207], v[148:151], v[180:183], v[192:207]
    ds_read_b64_tr_b16 v[148:149], v23 offset:9216
    ds_read_b64_tr_b16 v[150:151], v23 offset:9472
    v_mfma_f32_32x32x16_bf16 v[192:207], v[152:155], v[184:187], v[192:207]
    ds_read_b64_tr_b16 v[152:153], v23 offset:13056
    ds_read_b64_tr_b16 v[154:155], v23 offset:13312
    v_mfma_f32_32x32x16_bf16 v[192:207], v[156:159], v[188:191], v[192:207]
    ds_read_b64_tr_b16 v[156:157], v23 offset:13568
    ds_read_b64_tr_b16 v[158:159], v23 offset:13824
    s_barrier
    s_setprio 0
    s_mov_b32 s69, 32768
    s_nop 6
    v_cvt_pk_bf16_f32 v224, v192, v193
    v_cvt_pk_bf16_f32 v225, v194, v195
    v_cvt_pk_bf16_f32 v226, v196, v197
    v_cvt_pk_bf16_f32 v227, v198, v199
    buffer_store_dwordx4 v[224:227], v21, s[52:55], s69 offen sc1
    v_cvt_pk_bf16_f32 v228, v200, v201
    v_cvt_pk_bf16_f32 v229, v202, v203
    v_cvt_pk_bf16_f32 v230, v204, v205
    v_cvt_pk_bf16_f32 v231, v206, v207
    buffer_store_dwordx4 v[228:231], v21, s[52:55], s69 offen offset:1024 sc1
    s_waitcnt vmcnt(2) lgkmcnt(0)
    s_barrier
    s_setprio 1
    v_add_u32 v23, 69632, v15
    v_mfma_f32_32x32x16_bf16 v[208:223], v[128:131], v[160:163], v[208:223]
    ds_read_b64_tr_b16 v[128:129], v23
    ds_read_b64_tr_b16 v[130:131], v23 offset:256
    v_mfma_f32_32x32x16_bf16 v[208:223], v[132:135], v[164:167], v[208:223]
    ds_read_b64_tr_b16 v[132:133], v23 offset:512
    ds_read_b64_tr_b16 v[134:135], v23 offset:768
    v_mfma_f32_32x32x16_bf16 v[208:223], v[136:139], v[168:171], v[208:223]
    ds_read_b64_tr_b16 v[136:137], v23 offset:4352
    ds_read_b64_tr_b16 v[138:139], v23 offset:4608
    v_mfma_f32_32x32x16_bf16 v[208:223], v[140:143], v[172:175], v[208:223]
    ds_read_b64_tr_b16 v[140:141], v23 offset:4864
    ds_read_b64_tr_b16 v[142:143], v23 offset:5120
    v_mfma_f32_32x32x16_bf16 v[208:223], v[144:147], v[176:179], v[208:223]
    ds_read_b64_tr_b16 v[144:145], v23 offset:8704
    ds_read_b64_tr_b16 v[146:147], v23 offset:8960
    v_mfma_f32_32x32x16_bf16 v[208:223], v[148:151], v[180:183], v[208:223]
    ds_read_b64_tr_b16 v[148:149], v23 offset:9216
    ds_read_b64_tr_b16 v[150:151], v23 offset:9472
    v_mfma_f32_32x32x16_bf16 v[208:223], v[152:155], v[184:187], v[208:223]
    ds_read_b64_tr_b16 v[152:153], v23 offset:13056
    ds_read_b64_tr_b16 v[154:155], v23 offset:13312
    v_mfma_f32_32x32x16_bf16 v[208:223], v[156:159], v[188:191], v[208:223]
    ds_read_b64_tr_b16 v[156:157], v23 offset:13568
    ds_read_b64_tr_b16 v[158:159], v23 offset:13824
    s_barrier
    s_setprio 0
    s_mov_b32 s69, 40960
    s_nop 6
    v_cvt_pk_bf16_f32 v232, v208, v209
    v_cvt_pk_bf16_f32 v233, v210, v211
    v_cvt_pk_bf16_f32 v234, v212, v213
    v_cvt_pk_bf16_f32 v235, v214, v215
    buffer_store_dwordx4 v[232:235], v21, s[52:55], s69 offen sc1
    v_cvt_pk_bf16_f32 v236, v216, v217
    v_cvt_pk_bf16_f32 v237, v218, v219
    v_cvt_pk_bf16_f32 v238, v220, v221
    v_cvt_pk_bf16_f32 v239, v222, v223
    buffer_store_dwordx4 v[236:239], v21, s[52:55], s69 offen offset:1024 sc1
    s_waitcnt lgkmcnt(0)
    s_barrier
    s_setprio 1
    v_mfma_f32_32x32x16_bf16 v[48:63], v[128:131], v[160:163], v[48:63]
    v_mfma_f32_32x32x16_bf16 v[48:63], v[132:135], v[164:167], v[48:63]
    v_mfma_f32_32x32x16_bf16 v[48:63], v[136:139], v[168:171], v[48:63]
    v_mfma_f32_32x32x16_bf16 v[48:63], v[140:143], v[172:175], v[48:63]
    v_mfma_f32_32x32x16_bf16 v[48:63], v[144:147], v[176:179], v[48:63]
    v_mfma_f32_32x32x16_bf16 v[48:63], v[148:151], v[180:183], v[48:63]
    v_mfma_f32_32x32x16_bf16 v[48:63], v[152:155], v[184:187], v[48:63]
    v_mfma_f32_32x32x16_bf16 v[48:63], v[156:159], v[188:191], v[48:63]
    s_barrier
    s_setprio 0
    s_mov_b32 s69, 49152
    s_nop 8
    v_cvt_pk_bf16_f32 v224, v48, v49
    v_cvt_pk_bf16_f32 v225, v50, v51
    v_cvt_pk_bf16_f32 v226, v52, v53
    v_cvt_pk_bf16_f32 v227, v54, v55
    buffer_store_dwordx4 v[224:227], v21, s[52:55], s69 offen sc1
    v_cvt_pk_bf16_f32 v228, v56, v57
    v_cvt_pk_bf16_f32 v229, v58, v59
    v_cvt_pk_bf16_f32 v230, v60, v61
    v_cvt_pk_bf16_f32 v231, v62, v63
    buffer_store_dwordx4 v[228:231], v21, s[52:55], s69 offen offset:1024 sc1
    s_barrier
    s_setprio 0
    s_branch L_TAIL
L_TAIL:
    v_and_b32 v26, 31, v0
    s_mul_i32 s70, s80, 224
    s_lshl_b32 s71, s64, 5
    s_add_u32 s70, s70, s71
    v_add_u32 v26, s70, v26
    v_lshrrev_b32 v29, 5, v0
    s_mul_i32 s70, s79, 917504
    v_lshl_add_u32 v27, v26, 4, s70
    s_mov_b32 s71, 458752
    v_mad_u32_u24 v27, v29, s71, v27
    v_bfe_u32 v5, v26, 7, 1
    v_and_b32 v6, 31, v26
    v_lshl_add_u32 v5, v5, 5, v6
    s_lshl_b32 s70, s76, 6
    v_add_u32 v5, s70, v5
    v_mul_u32_u24 v5, 1792, v5
    v_lshrrev_b32 v6, 8, v26
    v_lshl_add_u32 v5, v6, 6, v5
    v_bfe_u32 v6, v26, 5, 2
    v_lshl_add_u32 v5, v6, 4, v5
    v_lshl_add_u32 v5, v29, 3, v5
    s_mul_i32 s70, s74, 896
    v_add_u32 v28, s70, v5
    s_lshl_b32 s70, s79, 7
    s_add_u32 s70, s70, 25165824
    v_and_b32 v5, 15, v0
    v_lshl_add_u32 v22, v5, 3, s70
    s_lshl_b32 s71, s80, 3
    s_add_u32 s70, s70, s71
    v_mov_b32 v23, 1073741824
    v_mov_b32 v5, s70
    v_cmp_eq_u32 vcc, 0, v0
    s_nop 1
    v_cndmask_b32 v23, v23, v5, vcc
    s_waitcnt vmcnt(0)
    s_barrier
    s_cmp_lg_u32 s64, 0
    s_cbranch_scc1 SK_901
    buffer_store_dwordx2 v[10:11], v23, s[52:55], 0 offen sc1
    s_mov_b32 s85, 0
L_FPOLL:
    buffer_load_dwordx2 v[14:15], v22, s[52:55], 0 offen sc1
    s_waitcnt vmcnt(0)
    v_cmp_ne_u64 vcc, v[14:15], v[10:11]
    s_cbranch_vccz L_FPOLL_OK
    s_add_u32 s85, s85, 1
    s_cmp_gt_u32 s85, 200000
    s_cbranch_scc0 L_FPOLL
L_FPOLL_OK:
    s_lshl_b32 s70, s79, 7
    s_add_u32 s70, s70, 26214400
    s_cmp_eq_u32 s80, 0
    s_cselect_b32 s70, s70, 1073741824
    v_mov_b32 v5, s70
    v_mov_b32 v6, 1073741824
    v_cmp_eq_u32 vcc, 0, v0
    s_nop 1
    v_cndmask_b32 v5, v6, v5, vcc
    buffer_store_dwordx2 v[10:11], v5, s[52:55], 0 offen sc1
SK_901:
    s_barrier
    s_cmp_ge_u32 s64, 7
    s_cbranch_scc1 L_DONE
    s_mov_b32 s69, 0
    buffer_load_dwordx4 v[32:35], v27, s[52:55], s69 offen sc1
    s_mov_b32 s69, 57344
    buffer_load_dwordx4 v[36:39], v27, s[52:55], s69 offen sc1
    s_mov_b32 s69, 114688
    buffer_load_dwordx4 v[40:43], v27, s[52:55], s69 offen sc1
    s_mov_b32 s69, 172032
    buffer_load_dwordx4 v[44:47], v27, s[52:55], s69 offen sc1
    s_mov_b32 s69, 229376
    buffer_load_dwordx4 v[48:51], v27, s[52:55], s69 offen sc1
    s_mov_b32 s69, 286720
    buffer_load_dwordx4 v[52:55], v27, s[52:55], s69 offen sc1
    s_mov_b32 s69, 344064
    buffer_load_dwordx4 v[56:59], v27, s[52:55], s69 offen sc1
    s_mov_b32 s69, 401408
    buffer_load_dwordx4 v[60:63], v27, s[52:55], s69 offen sc1
    s_waitcnt vmcnt(7)
    v_lshlrev_b32 v64, 16, v32
    v_and_b32 v65, 4294901760, v32
    v_lshlrev_b32 v66, 16, v33
    v_and_b32 v67, 4294901760, v33
    v_lshlrev_b32 v68, 16, v34
    v_and_b32 v69, 4294901760, v34
    v_lshlrev_b32 v70, 16, v35
    v_and_b32 v71, 4294901760, v35
    s_waitcnt vmcnt(6)
    v_lshlrev_b32 v5, 16, v36
    v_and_b32 v6, 4294901760, v36
    v_add_f32 v64, v64, v5
    v_add_f32 v65, v65, v6
    v_lshlrev_b32 v5, 16, v37
    v_and_b32 v6, 4294901760, v37
    v_add_f32 v66, v66, v5
    v_add_f32 v67, v67, v6
    v_lshlrev_b32 v5, 16, v38
    v_and_b32 v6, 4294901760, v38
    v_add_f32 v68, v68, v5
    v_add_f32 v69, v69, v6
    v_lshlrev_b32 v5, 16, v39
    v_and_b32 v6, 4294901760, v39
    v_add_f32 v70, v70, v5
    v_add_f32 v71, v71, v6
    s_waitcnt vmcnt(5)
    v_lshlrev_b32 v5, 16, v40
    v_and_b32 v6, 4294901760, v40
    v_add_f32 v64, v64, v5
    v_add_f32 v65, v65, v6
    v_lshlrev_b32 v5, 16, v41
    v_and_b32 v6, 4294901760, v41
    v_add_f32 v66, v66, v5
    v_add_f32 v67, v67, v6
    v_lshlrev_b32 v5, 16, v42
    v_and_b32 v6, 4294901760, v42
    v_add_f32 v68, v68, v5
    v_add_f32 v69, v69, v6
    v_lshlrev_b32 v5, 16, v43
    v_and_b32 v6, 4294901760, v43
    v_add_f32 v70, v70, v5
    v_add_f32 v71, v71, v6
    s_waitcnt vmcnt(4)
    v_lshlrev_b32 v5, 16, v44
    v_and_b32 v6, 4294901760, v44
    v_add_f32 v64, v64, v5
    v_add_f32 v65, v65, v6
    v_lshlrev_b32 v5, 16, v45
    v_and_b32 v6, 4294901760, v45
    v_add_f32 v66, v66, v5
    v_add_f32 v67, v67, v6
    v_lshlrev_b32 v5, 16, v46
    v_and_b32 v6, 4294901760, v46
    v_add_f32 v68, v68, v5
    v_add_f32 v69, v69, v6
    v_lshlrev_b32 v5, 16, v47
    v_and_b32 v6, 4294901760, v47
    v_add_f32 v70, v70, v5
    v_add_f32 v71, v71, v6
    s_waitcnt vmcnt(3)
    v_lshlrev_b32 v5, 16, v48
    v_and_b32 v6, 4294901760, v48
    v_add_f32 v64, v64, v5
    v_add_f32 v65, v65, v6
    v_lshlrev_b32 v5, 16, v49
    v_and_b32 v6, 4294901760, v49
    v_add_f32 v66, v66, v5
    v_add_f32 v67, v67, v6
    v_lshlrev_b32 v5, 16, v50
    v_and_b32 v6, 4294901760, v50
    v_add_f32 v68, v68, v5
    v_add_f32 v69, v69, v6
    v_lshlrev_b32 v5, 16, v51
    v_and_b32 v6, 4294901760, v51
    v_add_f32 v70, v70, v5
    v_add_f32 v71, v71, v6
    s_waitcnt vmcnt(2)
    v_lshlrev_b32 v5, 16, v52
    v_and_b32 v6, 4294901760, v52
    v_add_f32 v64, v64, v5
    v_add_f32 v65, v65, v6
    v_lshlrev_b32 v5, 16, v53
    v_and_b32 v6, 4294901760, v53
    v_add_f32 v66, v66, v5
    v_add_f32 v67, v67, v6
    v_lshlrev_b32 v5, 16, v54
    v_and_b32 v6, 4294901760, v54
    v_add_f32 v68, v68, v5
    v_add_f32 v69, v69, v6
    v_lshlrev_b32 v5, 16, v55
    v_and_b32 v6, 4294901760, v55
    v_add_f32 v70, v70, v5
    v_add_f32 v71, v71, v6
    s_waitcnt vmcnt(1)
    v_lshlrev_b32 v5, 16, v56
    v_and_b32 v6, 4294901760, v56
    v_add_f32 v64, v64, v5
    v_add_f32 v65, v65, v6
    v_lshlrev_b32 v5, 16, v57
    v_and_b32 v6, 4294901760, v57
    v_add_f32 v66, v66, v5
    v_add_f32 v67, v67, v6
    v_lshlrev_b32 v5, 16, v58
    v_and_b32 v6, 4294901760, v58
    v_add_f32 v68, v68, v5
    v_add_f32 v69, v69, v6
    v_lshlrev_b32 v5, 16, v59
    v_and_b32 v6, 4294901760, v59
    v_add_f32 v70, v70, v5
    v_add_f32 v71, v71, v6
    s_waitcnt vmcnt(0)
    v_lshlrev_b32 v5, 16, v60
    v_and_b32 v6, 4294901760, v60
    v_add_f32 v64, v64, v5
    v_add_f32 v65, v65, v6
    v_lshlrev_b32 v5, 16, v61
    v_and_b32 v6, 4294901760, v61
    v_add_f32 v66, v66, v5
    v_add_f32 v67, v67, v6
    v_lshlrev_b32 v5, 16, v62
    v_and_b32 v6, 4294901760, v62
    v_add_f32 v68, v68, v5
    v_add_f32 v69, v69, v6
    v_lshlrev_b32 v5, 16, v63
    v_and_b32 v6, 4294901760, v63
    v_add_f32 v70, v70, v5
    v_add_f32 v71, v71, v6
    v_permlane32_swap_b32 v64, v68
    v_permlane32_swap_b32 v65, v69
    v_permlane32_swap_b32 v66, v70
    v_permlane32_swap_b32 v67, v71
    v_add_f32 v64, v64, v68
    v_add_f32 v65, v65, v69
    v_add_f32 v66, v66, v70
    v_add_f32 v67, v67, v71
    v_cvt_pk_bf16_f32 v72, v64, v65
    v_cvt_pk_bf16_f32 v73, v66, v67
    buffer_store_dwordx2 v[72:73], v28, s[56:59], 0 offen
L_DONE:
L_END:
    s_endpgm
L_CODE_REAL_END:
.if (L_CODE_REAL_END - L_PC) > 49216
.error "code larger than the touched window"
.endif
.fill (49216 - (L_CODE_REAL_END - L_PC)) / 4, 4, 0xBF810000
L_CODE_END:
.section .rodata,"a"
.p2align 6
.amdhsa_kernel concat_heads__gqa_block_cached__gqa_block_cached__near_ridge_kernel
  .amdhsa_next_free_vgpr 256
  .amdhsa_next_free_sgpr 102
  .amdhsa_accum_offset 256
  .amdhsa_group_segment_fixed_size 0
  .amdhsa_kernarg_size 104
  .amdhsa_user_sgpr_count 2
  .amdhsa_user_sgpr_kernarg_segment_ptr 1
  .amdhsa_system_sgpr_workgroup_id_x 1
.end_amdhsa_kernel
```
